```python
import torch

def _softmax(x, axis=-1):
    return torch.softmax(x, dim=axis)
def _gelu(x):
    return torch.nn.functional.gelu(x, approximate="tanh")
def _silu(x):
    return torch.nn.functional.silu(x)
def _sigmoid(x):
    return torch.sigmoid(x)
def _layernorm(x, axis=-1, eps=1e-5):
    m = x.mean(dim=axis, keepdim=True)
    v = x.var(dim=axis, keepdim=True, unbiased=False)
    return (x - m) / torch.sqrt(v + eps)
def _scatter_add(tgt, idx, src, axis=0):
    return tgt.clone().index_add_(axis, idx, src)
def _segment_sum(src, seg, n):
    out = torch.zeros((n,) + src.shape[1:], dtype=src.dtype)
    return out.index_add_(0, seg, src)
def _pad(x, pw):
    flat = tuple(v for pair in reversed(pw) for v in pair)
    return torch.nn.functional.pad(x, flat)

kernel_name = 'interleave_layers__linear_attn_block__glu_gated_glu__prompt'

def setup_inputs():

    _w = (lambda a: (lambda t: t.to(torch.bfloat16) if t.is_floating_point() else t)(torch.as_tensor(a)))
    def _A_setup():
        B, S, D = 1, 2048, 512
        return {
            "x": _w((lambda *s: torch.randn(*s, dtype=torch.bfloat16) * 0.05)(B, S, D)),
            "wqkv": _w((lambda *s: torch.randn(*s, dtype=torch.bfloat16) * 0.05)(D, 3 * D)),
            "wo": _w((lambda *s: torch.randn(*s, dtype=torch.bfloat16) * 0.05)(D, D)),
        }
    _A_in = _A_setup()

    def _B_setup():
        B, S, D, F = 1, 2048, 512, 1792
        return {
            "x": _w((lambda *s: torch.randn(*s, dtype=torch.bfloat16) * 0.05)(B, S, D)),
            "w_gate": _w((lambda *s: torch.randn(*s, dtype=torch.bfloat16) * 0.05)(D, F)),
            "w_up": _w((lambda *s: torch.randn(*s, dtype=torch.bfloat16) * 0.05)(D, F)),
            "w_down": _w((lambda *s: torch.randn(*s, dtype=torch.bfloat16) * 0.05)(F, D)),
        }
    _B_in = _B_setup()

    return {
        "A_x": _A_in["x"],
        "A_wqkv": _A_in["wqkv"],
        "A_wo": _A_in["wo"],
        "B_x": _B_in["x"],
        "B_w_gate": _B_in["w_gate"],
        "B_w_up": _B_in["w_up"],
        "B_w_down": _B_in["w_down"],
    }

def reference(A_x, A_wqkv, A_wo, B_x, B_w_gate, B_w_up, B_w_down):
    def _A_ref(x, wqkv, wo):
        B, S, D = x.shape
        H = 32; Dh = D // H
        qkv = (lambda x, *d: x.permute(*d))((x @ wqkv).reshape(B, S, 3, H, Dh), 2, 0, 3, 1, 4)
        q, k, v = qkv[0], qkv[1], qkv[2]
        phi = lambda t: torch.where(t > 0, t + 1, torch.exp(t)) + 1e-6
        pq, pk = phi(q), phi(k)
        kv = torch.einsum("bhsd,bhse->bhde", pk, v)
        z = torch.einsum("bhsd->bhd", pk)
        num = torch.einsum("bhqd,bhde->bhqe", pq, kv)
        den = torch.einsum("bhqd,bhd->bhq", pq, z)[..., None] + 1e-6
        o = num / den
        return (lambda x, *d: x.permute(*d))(o, 0, 2, 1, 3).reshape(B, S, D) @ wo

    def _B_ref(x, w_gate, w_up, w_down):
        g = torch.einsum("bsd,df->bsf", x, w_gate)
        u = torch.einsum("bsd,df->bsf", x, w_up)
        h = _sigmoid(g) * u
        return torch.einsum("bsf,fd->bsd", h, w_down)

    x = A_x
    x = x + _A_ref(_layernorm(x, axis=-1), A_wqkv, A_wo)
    x = x + _B_ref(_layernorm(x, axis=-1), B_w_gate, B_w_up, B_w_down)
    x = x + _A_ref(_layernorm(x, axis=-1), A_wqkv, A_wo)
    x = x + _B_ref(_layernorm(x, axis=-1), B_w_gate, B_w_up, B_w_down)
    return x
```

```asm
; @launch grid=(256,1,1) block=(512,1,1) lds=163840
.amdgcn_target "amdgcn-amd-amdhsa--gfx950"
.text
.p2align 12
.fill 832, 4, 0xbf810000
.globl interleave_layers__linear_attn_block__glu_gated_glu__prompt_kernel
.p2align 8
.type interleave_layers__linear_attn_block__glu_gated_glu__prompt_kernel,@function
interleave_layers__linear_attn_block__glu_gated_glu__prompt_kernel:
s_cmp_ge_u32 s2, 256
s_cbranch_scc0 L_go
s_endpgm
L_go:
s_load_dwordx16 s[84:99], s[0:1], 0
s_load_dwordx4 s[80:83], s[0:1], 64
s_getpc_b64 s[76:77]
L_pc:
s_bfe_u32 s3, s2, 0x30003
s_mul_i32 s3, s3, 9216
v_lshrrev_b32 v2, 6, v0
v_mul_u32_u24 v2, 9, v2
v_and_b32 v3, 15, v0
v_add_u32 v2, v2, v3
v_lshl_add_u32 v2, v2, 7, s3
v_min_u32 v2, (L_code_end - L_pc - 4) & 0xffffff80, v2
s_mov_b64 exec, 0x1ff
global_load_dword v6, v2, s[76:77]
s_mov_b64 exec, -1
v_lshrrev_b32 v2, 6, v0
v_and_b32 v0, 63, v0
v_lshlrev_b32 v1, 4, v0
v_readfirstlane_b32 s3, v2
s_and_b32 s36, s2, 7
s_lshr_b32 s37, s2, 3
s_mov_b32 s66, 0
s_and_b32 s40, s37, 15
s_lshr_b32 s41, s37, 4
s_and_b32 s42, s37, 7
s_lshr_b32 s43, s37, 3
s_and_b32 s38, s3, 3
s_cmp_ge_u32 s3, 4
s_cbranch_scc0 L_consumer
L_code_begin:
L_loader:
s_lshl_b32 s72, s38, 10
s_lshl_b32 s73, s38, 12
v_lshrrev_b32 v4, 3, v0
v_lshrrev_b32 v5, 4, v0
v_and_b32 v10, 7, v0
v_xor_b32 v10, v10, v5
v_lshlrev_b32 v10, 4, v10
v_lshl_add_u32 v2, v4, 10, v10
v_xor_b32 v3, 64, v2
s_lshl_b32 s55, s36, 8
s_lshl_b32 s48, s41, 7
s_add_u32 s55, s55, s48
s_lshl_b32 s48, s38, 5
s_add_u32 s55, s55, s48
s_lshl_b32 s55, s55, 10
s_movk_i32 s48, 3072
v_mul_lo_u32 v4, v4, s48
v_bfe_u32 v5, v0, 1, 2
v_bfe_u32 v10, v0, 4, 1
v_xor_b32 v5, v5, v10
v_lshrrev_b32 v10, 1, v5
v_lshl_add_u32 v4, v10, 10, v4
v_and_b32 v5, 1, v5
v_lshl_add_u32 v4, v5, 5, v4
v_and_b32 v5, 1, v0
v_lshl_add_u32 v4, v5, 4, v4
s_lshl_b32 s49, s40, 6
s_add_u32 s50, s49, 1024
v_add_u32 v14, s50, v4
v_lshlrev_b32 v10, 11, v10
v_sub_u32 v7, v14, v10
v_add_u32 v7, 1024, v7
s_mul_i32 s56, s38, 98304
s_lshl_b32 s57, s56, 1
v_lshrrev_b32 v4, 2, v0
v_mul_lo_u32 v4, v4, s48
v_bfe_u32 v5, v0, 1, 1
v_lshrrev_b32 v10, 5, v0
v_xor_b32 v5, v5, v10
v_lshl_add_u32 v4, v5, 5, v4
v_and_b32 v5, 1, v0
v_lshl_add_u32 v4, v5, 4, v4
v_add_u32 v13, s49, v4
s_and_b32 s48, s36, 1
s_lshl_b32 s49, s48, 9
s_sub_u32 s74, s55, s49
s_add_u32 s55, s55, s49
s_mul_i32 s49, s48, 786432
s_sub_u32 s75, s56, s49
s_add_u32 s56, s56, s49
s_sub_u32 s67, s57, s49
s_add_u32 s57, s57, s49
s_waitcnt lgkmcnt(0)
s_mov_b32 s8, s84
s_mov_b32 s9, s85
s_mov_b32 s10, 0x200000
s_mov_b32 s11, 0x20000
s_mov_b32 s24, s86
s_mov_b32 s25, s87
s_mov_b32 s26, 0x180000
s_mov_b32 s27, 0x20000
s_add_u32 m0, s73, 0x0
s_add_u32 s48, s55, 0x0
buffer_load_dwordx4 v2, s[8:11], s48 offen offset:0 lds
s_add_u32 s48, s55, 0x1c00
buffer_load_dwordx4 v3, s[8:11], s48 offen offset:1024 lds
s_add_u32 s48, s55, 0x3800
buffer_load_dwordx4 v2, s[8:11], s48 offen offset:2048 lds
s_add_u32 s48, s55, 0x5400
buffer_load_dwordx4 v3, s[8:11], s48 offen offset:3072 lds
s_add_u32 m0, s73, 0x4000
s_add_u32 s48, s56, 0x0
buffer_load_dwordx4 v14, s[24:27], s48 offen offset:0 lds
s_add_u32 s48, s56, 0x5c00
buffer_load_dwordx4 v7, s[24:27], s48 offen offset:1024 lds
s_add_u32 s48, s56, 0xb800
buffer_load_dwordx4 v14, s[24:27], s48 offen offset:2048 lds
s_add_u32 s48, s56, 0x11400
buffer_load_dwordx4 v7, s[24:27], s48 offen offset:3072 lds
s_add_u32 m0, s73, 0x8000
s_add_u32 s48, s55, 0x80
buffer_load_dwordx4 v2, s[8:11], s48 offen offset:0 lds
s_add_u32 s48, s55, 0x1c80
buffer_load_dwordx4 v3, s[8:11], s48 offen offset:1024 lds
s_add_u32 s48, s55, 0x3880
buffer_load_dwordx4 v2, s[8:11], s48 offen offset:2048 lds
s_add_u32 s48, s55, 0x5480
buffer_load_dwordx4 v3, s[8:11], s48 offen offset:3072 lds
s_add_u32 m0, s73, 0xc000
s_add_u32 s48, s55, 0x100
buffer_load_dwordx4 v2, s[8:11], s48 offen offset:0 lds
s_add_u32 s48, s55, 0x1d00
buffer_load_dwordx4 v3, s[8:11], s48 offen offset:1024 lds
s_add_u32 s48, s55, 0x3900
buffer_load_dwordx4 v2, s[8:11], s48 offen offset:2048 lds
s_add_u32 s48, s55, 0x5500
buffer_load_dwordx4 v3, s[8:11], s48 offen offset:3072 lds
s_mov_b32 s4, s82
s_mov_b32 s5, s83
s_mov_b32 s6, 0x10000000
s_mov_b32 s7, 0x20000
s_mov_b32 s32, s80
s_mov_b32 s33, s81
s_mov_b32 s34, 0x100
s_mov_b32 s35, 0x20000
s_getreg_b32 s47, hwreg(HW_REG_XCC_ID, 0, 3)
s_sub_u32 s68, s37, 24
s_lshl_b32 s68, s68, 2
s_and_b32 s69, s36, 3
s_add_u32 s48, s68, s69
s_add_u32 s68, s48, 192
s_cmp_lt_u32 s2, 192
s_cselect_b32 s68, s2, s68
s_cselect_b32 s69, 4, s36
s_cmp_lt_u32 s69, 4
s_cbranch_scc1 L_l_t2_4
L_l_t3_1:
s_and_b32 s49, s68, 3
s_lshr_b32 s68, s68, 2
s_mov_b32 s64, 1
s_lshl_b32 s65, s68, 10
s_add_u32 s65, s65, 0x12d0000
s_lshl_b32 s58, s49, 8
s_add_u32 s58, s58, s65
s_lshl_b32 s59, s68, 2
s_add_u32 s59, s59, s49
s_lshl_b32 s59, s59, 5
s_add_u32 s59, s59, s38
s_lshl_b32 s59, s59, 2
s_add_u32 s59, s59, 0x12e6000
s_lshl_b32 s49, s49, 2
s_add_u32 s49, s49, s38
s_lshl_b32 s50, s49, 5
s_mov_b32 s53, 0
s_cmp_lt_u32 s68, 28
s_cselect_b32 s28, s92, s94
s_cselect_b32 s29, s93, s95
s_cselect_b32 s69, 0, 28
s_cselect_b32 s70, 0, 1024
s_sub_u32 s48, s68, s69
s_movk_i32 s51, 3584
s_lshl_b32 s52, s48, 7
s_mov_b32 s30, 1835008
s_lshl_b32 s68, s48, 2
s_add_u32 s68, s68, 0
s_mul_i32 s69, s68, 147
s_lshr_b32 s69, s69, 10
s_mov_b32 s76, s49
s_mul_i32 s71, s69, 7
s_sub_u32 s68, s68, s71
s_mul_i32 s69, s69, 229376
s_lshr_b32 s71, s68, 1
s_lshl_b32 s71, s71, 16
s_add_u32 s69, s69, s71
s_and_b32 s71, s68, 1
s_lshl_b32 s71, s71, 11
s_add_u32 s69, s69, s71
s_cmp_lt_u32 s68, 6
s_cselect_b32 s71, 12, 11
s_lshl_b32 s71, s76, s71
s_add_u32 s69, s69, s71
s_add_u32 s69, s69, s70
s_add_u32 s60, s69, 0x180000
s_lshl_b32 s68, s48, 2
s_add_u32 s68, s68, 1
s_mul_i32 s69, s68, 147
s_lshr_b32 s69, s69, 10
s_mov_b32 s76, s49
s_mul_i32 s71, s69, 7
s_sub_u32 s68, s68, s71
s_mul_i32 s69, s69, 229376
s_lshr_b32 s71, s68, 1
s_lshl_b32 s71, s71, 16
s_add_u32 s69, s69, s71
s_and_b32 s71, s68, 1
s_lshl_b32 s71, s71, 11
s_add_u32 s69, s69, s71
s_cmp_lt_u32 s68, 6
s_cselect_b32 s71, 12, 11
s_lshl_b32 s71, s76, s71
s_add_u32 s69, s69, s71
s_add_u32 s69, s69, s70
s_add_u32 s61, s69, 0x180000
s_lshl_b32 s68, s48, 2
s_add_u32 s68, s68, 2
s_mul_i32 s69, s68, 147
s_lshr_b32 s69, s69, 10
s_mov_b32 s76, s49
s_mul_i32 s71, s69, 7
s_sub_u32 s68, s68, s71
s_mul_i32 s69, s69, 229376
s_lshr_b32 s71, s68, 1
s_lshl_b32 s71, s71, 16
s_add_u32 s69, s69, s71
s_and_b32 s71, s68, 1
s_lshl_b32 s71, s71, 11
s_add_u32 s69, s69, s71
s_cmp_lt_u32 s68, 6
s_cselect_b32 s71, 12, 11
s_lshl_b32 s71, s76, s71
s_add_u32 s69, s69, s71
s_add_u32 s69, s69, s70
s_add_u32 s62, s69, 0x180000
s_lshl_b32 s68, s48, 2
s_add_u32 s68, s68, 3
s_mul_i32 s69, s68, 147
s_lshr_b32 s69, s69, 10
s_mov_b32 s76, s49
s_mul_i32 s71, s69, 7
s_sub_u32 s68, s68, s71
s_mul_i32 s69, s69, 229376
s_lshr_b32 s71, s68, 1
s_lshl_b32 s71, s71, 16
s_add_u32 s69, s69, s71
s_and_b32 s71, s68, 1
s_lshl_b32 s71, s71, 11
s_add_u32 s69, s69, s71
s_cmp_lt_u32 s68, 6
s_cselect_b32 s71, 12, 11
s_lshl_b32 s71, s76, s71
s_add_u32 s69, s69, s71
s_add_u32 s69, s69, s70
s_add_u32 s63, s69, 0x180000
s_branch L_l_tl_5
L_l_t2_4:
s_and_b32 s68, s48, 7
s_lshr_b32 s69, s48, 3
s_mov_b32 s28, s88
s_mov_b32 s29, s89
s_mov_b32 s30, 524288
s_lshl_b32 s71, s69, 1
s_and_b32 s70, s38, 1
s_add_u32 s71, s71, s70
s_lshr_b32 s70, s38, 1
s_lshl_b32 s50, s70, 8
s_lshl_b32 s71, s71, 5
s_add_u32 s50, s50, s71
s_lshl_b32 s59, s68, 9
s_add_u32 s59, s59, 0x12f3800
s_lshl_b32 s71, s68, 16
s_add_u32 s71, s71, 0x6c0000
s_mov_b32 s53, 0
s_lshl_b32 s52, s68, 7
s_movk_i32 s51, 1024
s_mov_b32 s64, 0
s_lshl_b32 s68, s69, 5
s_add_u32 s68, s68, s38
s_lshl_b32 s68, s68, 2
s_add_u32 s59, s59, s68
s_lshl_b32 s69, s69, 2
s_add_u32 s69, s69, s38
s_lshl_b32 s69, s69, 12
s_add_u32 s71, s71, s69
s_lshl_b32 s70, s70, 11
s_xor_b32 s68, s70, 0
s_add_u32 s60, s71, s68
s_xor_b32 s68, s70, 1024
s_add_u32 s61, s71, s68
s_xor_b32 s68, s70, 2048
s_add_u32 s62, s71, s68
s_xor_b32 s68, s70, 3072
s_add_u32 s63, s71, s68
L_l_tl_5:
s_mov_b32 s31, 0x20000
v_lshrrev_b32 v96, 3, v0
v_mul_lo_u32 v96, v96, s51
v_bfe_u32 v97, v0, 1, 2
v_bfe_u32 v98, v0, 4, 2
v_xor_b32 v97, v97, v98
v_lshl_add_u32 v96, v97, 5, v96
v_and_b32 v97, 1, v0
v_lshl_add_u32 v96, v97, 4, v96
v_add_u32 v12, s52, v96
s_mul_i32 s68, s50, s51
s_lshl_b32 s71, s51, 3
s_add_u32 s69, s68, s71
s_add_u32 s53, s53, 16
s_mul_i32 s70, s53, s51
s_add_u32 s70, s70, s68
s_add_u32 s71, s70, s71
buffer_load_dwordx4 v[80:83], v12, s[28:31], s68 offen
buffer_load_dwordx4 v[84:87], v12, s[28:31], s69 offen
buffer_load_dwordx4 v[88:91], v12, s[28:31], s70 offen
buffer_load_dwordx4 v[92:95], v12, s[28:31], s71 offen
s_mov_b32 s90, 2
s_cmp_lt_u32 s2, 96
s_cbranch_scc1 L_l_t1_8
s_cmp_ge_u32 s2, 208
s_cbranch_scc1 L_l_n2_6
s_sub_u32 s48, s2, 96
s_branch L_l_t4_9
L_l_t1_8:
s_lshr_b32 s48, s2, 2
s_add_u32 s68, s48, 56
s_and_b32 s49, s2, 3
s_mov_b32 s90, 1
s_lshl_b32 s91, s68, 10
s_add_u32 s91, s91, 0x12d0000
s_lshl_b32 s84, s49, 8
s_add_u32 s84, s84, s91
s_lshl_b32 s85, s68, 2
s_add_u32 s85, s85, s49
s_lshl_b32 s85, s85, 5
s_add_u32 s85, s85, s38
s_lshl_b32 s85, s85, 2
s_add_u32 s85, s85, 0x12e6000
s_lshl_b32 s49, s49, 2
s_add_u32 s49, s49, s38
s_lshl_b32 s50, s49, 5
s_mov_b32 s53, 0
s_mov_b32 s28, s86
s_mov_b32 s29, s87
s_mov_b32 s30, 1572864
s_movk_i32 s51, 3072
s_lshl_b32 s52, s48, 7
s_lshr_b32 s68, s48, 3
s_and_b32 s69, s48, 7
s_mul_i32 s69, s69, 196608
s_cmp_eq_u32 s68, 2
s_cselect_b32 s70, 2048, 0
s_cmp_eq_u32 s68, 0
s_cselect_b32 s70, 0x10000, s70
s_cselect_b32 s71, 11, 12
s_add_u32 s69, s69, s70
s_and_b32 s70, s48, 7
s_lshl_b32 s70, s70, 1
s_mov_b32 s76, s49
s_lshl_b32 s76, s76, s71
s_add_u32 s76, s76, s69
s_add_u32 s92, s76, 0x0
s_add_u32 s93, s76, 0x400
s_mov_b32 s76, s49
s_lshl_b32 s76, s76, s71
s_add_u32 s76, s76, s69
s_add_u32 s94, s76, 0x18000
s_add_u32 s95, s76, 0x18400
s_branch L_l_tl_11
L_l_t4_9:
s_and_b32 s68, s48, 7
s_lshr_b32 s69, s48, 3
s_mov_b32 s28, s96
s_mov_b32 s29, s97
s_mov_b32 s30, 1835008
s_lshl_b32 s71, s69, 1
s_and_b32 s70, s38, 1
s_add_u32 s71, s71, s70
s_mov_b32 s76, s71
s_and_b32 s70, s76, 7
s_mul_i32 s70, s70, 112
s_lshr_b32 s50, s71, 3
s_lshl_b32 s50, s50, 5
s_add_u32 s50, s50, s70
s_and_b32 s70, s76, 3
s_mul_i32 s70, s70, 224
s_add_u32 s70, s70, 96
s_cmp_ge_u32 s71, 24
s_cselect_b32 s50, s70, s50
s_cselect_b32 s53, 96, 0
s_lshr_b32 s70, s38, 1
s_mul_i32 s71, s70, 896
s_add_u32 s50, s50, s71
s_mul_i32 s85, s68, 1792
s_add_u32 s85, s85, 0x12f0000
s_mul_i32 s71, s68, 229376
s_add_u32 s71, s71, 0x500000
s_lshl_b32 s52, s68, 7
s_movk_i32 s51, 1024
s_mov_b32 s90, 0
s_lshl_b32 s68, s69, 5
s_add_u32 s68, s68, s38
s_lshl_b32 s68, s68, 2
s_add_u32 s85, s85, s68
s_lshl_b32 s69, s69, 2
s_add_u32 s69, s69, s38
s_lshl_b32 s69, s69, 12
s_add_u32 s71, s71, s69
s_lshl_b32 s70, s70, 11
s_xor_b32 s68, s70, 0
s_add_u32 s92, s71, s68
s_xor_b32 s68, s70, 1024
s_add_u32 s93, s71, s68
s_xor_b32 s68, s70, 2048
s_add_u32 s94, s71, s68
s_xor_b32 s68, s70, 3072
s_add_u32 s95, s71, s68
L_l_tl_11:
s_mov_b32 s31, 0x20000
v_lshrrev_b32 v96, 3, v0
v_mul_lo_u32 v96, v96, s51
v_bfe_u32 v97, v0, 1, 2
v_bfe_u32 v98, v0, 4, 2
v_xor_b32 v97, v97, v98
v_lshl_add_u32 v96, v97, 5, v96
v_and_b32 v97, 1, v0
v_lshl_add_u32 v96, v97, 4, v96
v_add_u32 v12, s52, v96
s_mul_i32 s68, s50, s51
s_lshl_b32 s71, s51, 3
s_add_u32 s69, s68, s71
s_add_u32 s53, s53, 16
s_mul_i32 s70, s53, s51
s_add_u32 s70, s70, s68
s_add_u32 s71, s70, s71
buffer_load_dwordx4 v[32:35], v12, s[28:31], s68 offen
buffer_load_dwordx4 v[36:39], v12, s[28:31], s69 offen
buffer_load_dwordx4 v[40:43], v12, s[28:31], s70 offen
buffer_load_dwordx4 v[44:47], v12, s[28:31], s71 offen
L_l_n2_6:
s_mul_i32 s80, s40, 98304
s_add_u32 s80, s80, s73
s_mul_i32 s81, s40, 229376
s_add_u32 s81, s81, s73
s_mul_i32 s82, s42, 229376
s_add_u32 s82, s82, s73
s_lshl_b32 s83, s42, 16
s_add_u32 s83, s83, s73
s_branch L_loader2
L_consumer:
v_mov_b32 v7, 0
s_waitcnt lgkmcnt(0)
s_mov_b32 s8, s84
s_mov_b32 s9, s85
s_mov_b32 s10, 0x200000
s_mov_b32 s11, 0x20000
s_mov_b32 s24, s86
s_mov_b32 s25, s87
s_mov_b32 s26, 0x180000
s_mov_b32 s27, 0x20000
s_mov_b32 s4, s82
s_mov_b32 s5, s83
s_mov_b32 s6, 0x10000000
s_mov_b32 s7, 0x20000
s_sub_u32 s53, s2, 208
s_cmp_eq_u32 s38, 1
s_cselect_b32 s53, s53, 999
s_cmp_lt_u32 s53, 48
s_cbranch_scc0 L_c_ni_1
s_cmp_lt_u32 s53, 40
s_cselect_b32 s49, -1, 0
v_mov_b32 v12, s49
v_mov_b32 v13, s49
v_mov_b32 v14, s49
v_mov_b32 v15, s49
s_mul_i32 s48, s53, 10240
s_add_u32 s48, s48, 0x1280000
buffer_store_dwordx4 v[12:15], v1, s[4:7], s48 offen offset:0 sc1
buffer_store_dwordx4 v[12:15], v1, s[4:7], s48 offen offset:1024 sc1
buffer_store_dwordx4 v[12:15], v1, s[4:7], s48 offen offset:2048 sc1
buffer_store_dwordx4 v[12:15], v1, s[4:7], s48 offen offset:3072 sc1
s_add_u32 s48, s48, 4096
buffer_store_dwordx4 v[12:15], v1, s[4:7], s48 offen offset:0 sc1
buffer_store_dwordx4 v[12:15], v1, s[4:7], s48 offen offset:1024 sc1
buffer_store_dwordx4 v[12:15], v1, s[4:7], s48 offen offset:2048 sc1
buffer_store_dwordx4 v[12:15], v1, s[4:7], s48 offen offset:3072 sc1
s_add_u32 s48, s48, 4096
buffer_store_dwordx4 v[12:15], v1, s[4:7], s48 offen offset:0 sc1
buffer_store_dwordx4 v[12:15], v1, s[4:7], s48 offen offset:1024 sc1
L_c_ni_1:
s_lshl_b32 s48, s37, 2
s_add_u32 s48, s48, s38
s_lshl_b32 s49, s36, 7
s_add_u32 s49, s49, s48
s_lshl_b32 s49, s49, 11
v_lshlrev_b32 v2, 7, v0
s_mov_b64 exec, 0xffff
buffer_load_dword v6, v2, s[8:11], s49 offen
s_and_b32 s49, s36, 1
s_lshl_b32 s49, s49, 7
s_add_u32 s49, s49, s48
s_mul_i32 s49, s49, 6144
s_bfm_b64 exec, 32, 0
v_lshrrev_b32 v3, 4, v0
v_lshl_add_u32 v2, v3, 10, v2
buffer_load_dword v6, v2, s[24:27], s49 offen offset:1024
s_mov_b64 exec, -1
s_mov_b32 s32, s80
s_mov_b32 s33, s81
s_mov_b32 s34, 0x100
s_mov_b32 s35, 0x20000
s_mov_b32 s20, s98
s_mov_b32 s21, s99
s_mov_b32 s22, 0x200000
s_mov_b32 s23, 0x20000
s_cmp_lt_u32 s53, 48
s_cbranch_scc0 L_c_ng_2
v_mov_b32 v10, 1
s_waitcnt vmcnt(2)
s_mov_b64 exec, 1
buffer_atomic_add v10, off, s[32:35], 0
s_mov_b64 exec, -1
L_c_ng_2:
s_and_b32 s48, s38, 1
s_lshr_b32 s46, s38, 1
s_lshl_b32 s49, s36, 3
s_lshl_b32 s44, s41, 2
s_add_u32 s44, s44, s49
s_add_u32 s44, s44, s38
s_lshl_b32 s45, s43, 1
s_add_u32 s45, s45, s49
s_add_u32 s45, s45, s48
s_lshl_b32 s54, s44, 15
s_lshl_b32 s50, s45, 15
s_lshl_b32 s55, s46, 14
s_add_u32 s55, s55, s50
s_lshl_b32 s56, s44, 7
s_lshl_b32 s57, s45, 7
s_add_u32 s56, s56, 0x12e4000
s_add_u32 s57, s57, 0x12e4000
s_lshl_b32 s81, s40, 2
s_add_u32 s81, s81, s56
s_add_u32 s56, s56, 64
s_lshl_b32 s65, s42, 1
s_add_u32 s65, s65, s46
s_lshl_b32 s82, s65, 2
s_add_u32 s82, s82, s57
s_add_u32 s82, s82, 64
s_lshl_b32 s68, s40, 11
s_add_u32 s68, s68, s54
s_lshl_b32 s69, s65, 11
s_add_u32 s69, s69, s50
s_lshl_b32 s64, s65, 6
s_add_u32 s64, s64, s50
s_lshl_b32 s60, s44, 12
s_lshl_b32 s61, s45, 12
s_lshr_b32 s51, s65, 2
s_lshl_b32 s51, s51, 10
s_add_u32 s61, s61, s51
s_and_b32 s51, s65, 3
s_lshl_b32 s51, s51, 2
s_add_u32 s61, s61, s51
s_mul_i32 s51, s44, 114688
s_lshr_b32 s52, s40, 3
s_mul_i32 s52, s52, 57344
s_add_u32 s51, s51, s52
s_and_b32 s52, s40, 7
s_lshl_b32 s58, s52, 11
s_add_u32 s58, s58, s51
s_lshr_b32 s59, s52, 1
s_add_u32 s59, s59, 24
s_lshl_b32 s59, s59, 11
s_add_u32 s59, s59, s51
s_and_b32 s52, s52, 1
s_lshl_b32 s52, s52, 10
s_add_u32 s59, s59, s52
s_mul_i32 s83, s45, 114688
s_mul_i32 s52, s46, 57344
s_add_u32 s83, s83, s52
s_lshl_b32 s51, s38, 9
s_lshl_b32 s52, s38, 7
s_add_u32 s52, s52, 768
s_cmp_lt_u32 s38, 2
s_cselect_b32 s51, s51, s52
s_cselect_b64 vcc, -1, 0
s_mul_i32 s62, s40, 20480
s_add_u32 s62, s62, s51
s_lshl_b32 s63, s36, 1
s_add_u32 s63, s63, s41
s_mul_i32 s63, s63, 1280
s_add_u32 s63, s63, s62
s_lshl_b32 s72, s38, 10
s_lshl_b32 s73, s38, 12
s_add_u32 s73, s73, 0x24000
s_mov_b32 s74, 0x358637bd
s_mov_b32 s39, 0
s_lshl_b32 s70, s40, 11
s_lshl_b32 s71, s42, 11
v_add_u32 v2, 0x10000, v1
v_add_u32 v3, 0x20000, v1
v_and_b32 v4, 15, v0
v_lshlrev_b32 v127, 10, v4
v_lshlrev_b32 v4, 2, v4
v_lshrrev_b32 v126, 4, v0
v_lshlrev_b32 v126, 3, v126
v_add_u32 v127, v127, v126
v_lshlrev_b32 v5, 3, v0
v_cndmask_b32 v126, v126, v5, vcc
v_and_b32 v5, 7, v0
s_lshl_b32 s51, s46, 3
v_add_u32 v5, s51, v5
v_lshlrev_b32 v5, 2, v5
v_lshlrev_b32 v125, 7, v0
v_mov_b32 v118, -1
v_mov_b32 v119, -1
v_mov_b32 v120, -1
v_mov_b32 v121, -1
s_add_u32 s49, s63, 0x1300000
buffer_store_dwordx2 v[118:119], v126, s[4:7], s49 offen offset:0 sc1
v_mov_b32 v96, 0x3f803f80
v_mov_b32 v97, 0x3f803f80
v_mov_b32 v98, 0x3f803f80
v_mov_b32 v99, 0x3f803f80
v_and_b32 v116, 15, v0
s_lshl_b32 s48, s38, 5
v_add_u32 v116, s48, v116
v_lshlrev_b32 v116, 7, v116
v_bfe_u32 v117, v0, 1, 3
v_lshrrev_b32 v100, 4, v0
v_xor_b32 v117, v117, v100
v_lshl_add_u32 v100, v117, 4, v116
v_xor_b32 v101, 64, v100
v_lshrrev_b32 v116, 4, v0
v_lshlrev_b32 v116, 3, v116
v_bfe_u32 v117, v0, 2, 2
v_add_u32 v116, v116, v117
v_and_b32 v117, 3, v0
v_lshlrev_b32 v117, 3, v117
v_lshl_add_u32 v112, v116, 6, v117
v_lshl_add_u32 v117, v116, 7, v117
v_bfe_u32 v116, v0, 3, 2
v_xor_b32 v104, 0, v116
v_lshl_add_u32 v104, v104, 5, v117
v_add_u32 v108, 0x10000, v104
v_xor_b32 v105, 1, v116
v_lshl_add_u32 v105, v105, 5, v117
v_add_u32 v109, 0x10000, v105
v_xor_b32 v106, 2, v116
v_lshl_add_u32 v106, v106, 5, v117
v_add_u32 v110, 0x10000, v106
v_xor_b32 v107, 3, v116
v_lshl_add_u32 v107, v107, 5, v117
v_add_u32 v111, 0x10000, v107
v_bfe_u32 v116, v0, 4, 1
v_lshl_add_u32 v112, v116, 5, v112
v_xor_b32 v113, 32, v112
v_add_u32 v114, 0x10000, v112
v_add_u32 v115, 0x10000, v113
s_and_b32 s48, s43, 1
s_lshl_b32 s48, s48, 1
s_and_b32 s49, s38, 1
s_add_u32 s48, s48, s49
s_lshl_b32 s48, s48, 12
v_and_b32 v116, 15, v0
v_lshlrev_b32 v116, 7, v116
v_bfe_u32 v117, v0, 4, 1
v_lshl_add_u32 v116, v117, 3, v116
v_add_u32 v116, s48, v116
v_lshrrev_b32 v117, 5, v0
s_lshl_b32 s48, s46, 2
v_add_u32 v117, s48, v117
v_bfe_u32 v118, v0, 1, 3
v_xor_b32 v117, v117, v118
v_lshl_add_u32 v118, v117, 4, v116
v_xor_b32 v119, 32, v118
s_and_b32 s67, s36, 1
s_lshl_b32 s67, s67, 2
s_xor_b32 s67, s67, s42
s_lshl_b32 s48, s38, 5
v_xor_b32 v72, s48, v104
v_add_u32 v73, 0x10000, v72
s_branch L_cons2
L_loader2:
s_waitcnt vmcnt(12)
s_barrier
s_add_u32 m0, s73, 0x10000
s_add_u32 s48, s56, 0x60000
buffer_load_dwordx4 v14, s[24:27], s48 offen offset:0 lds
s_add_u32 s48, s56, 0x65c00
buffer_load_dwordx4 v7, s[24:27], s48 offen offset:1024 lds
s_add_u32 s48, s56, 0x6b800
buffer_load_dwordx4 v14, s[24:27], s48 offen offset:2048 lds
s_add_u32 s48, s56, 0x71400
buffer_load_dwordx4 v7, s[24:27], s48 offen offset:3072 lds
s_waitcnt vmcnt(12)
s_barrier
s_add_u32 s49, s73, 0x20000
v_lshrrev_b32 v96, 2, v0
v_lshlrev_b32 v97, 7, v96
v_and_b32 v100, 3, v0
v_lshl_add_u32 v97, v100, 3, v97
v_bfe_u32 v96, v96, 1, 2
v_add_u32 v97, s49, v97
v_xor_b32 v100, 0, v96
v_lshl_add_u32 v100, v100, 5, v97
v_xor_b32 v101, 1, v96
v_lshl_add_u32 v101, v101, 5, v97
v_xor_b32 v102, 2, v96
v_lshl_add_u32 v102, v102, 5, v97
v_xor_b32 v103, 3, v96
v_lshl_add_u32 v103, v103, 5, v97
v_add_u32 v104, s49, v1
s_mov_b32 s53, 0x3f803f80
s_waitcnt vmcnt(4)
ds_write_b128 v104, v[80:83] offset:16384
ds_write_b128 v104, v[84:87] offset:17408
ds_write_b128 v104, v[88:91] offset:18432
ds_write_b128 v104, v[92:95] offset:19456
ds_read_b64_tr_b16 v[64:65], v100 offset:16384
ds_read_b64_tr_b16 v[66:67], v100 offset:18432
ds_read_b64_tr_b16 v[68:69], v101 offset:16384
ds_read_b64_tr_b16 v[70:71], v101 offset:18432
ds_read_b64_tr_b16 v[72:73], v102 offset:16384
ds_read_b64_tr_b16 v[74:75], v102 offset:18432
ds_read_b64_tr_b16 v[76:77], v103 offset:16384
ds_read_b64_tr_b16 v[78:79], v103 offset:18432
s_waitcnt lgkmcnt(8)
ds_write_b128 v104, v[32:35] offset:0
ds_write_b128 v104, v[36:39] offset:1024
ds_write_b128 v104, v[40:43] offset:2048
ds_write_b128 v104, v[44:47] offset:3072
s_waitcnt lgkmcnt(4)
ds_read_b64_tr_b16 v[48:49], v100 offset:0
ds_read_b64_tr_b16 v[50:51], v100 offset:2048
ds_read_b64_tr_b16 v[52:53], v101 offset:0
ds_read_b64_tr_b16 v[54:55], v101 offset:2048
ds_read_b64_tr_b16 v[56:57], v102 offset:0
ds_read_b64_tr_b16 v[58:59], v102 offset:2048
ds_read_b64_tr_b16 v[60:61], v103 offset:0
ds_read_b64_tr_b16 v[62:63], v103 offset:2048
v_lshrrev_b32 v105, 2, v1
v_add_u32 v105, s49, v105
s_cmp_eq_u32 s64, 1
s_cbranch_scc1 L_l_cen_12
s_cmp_eq_u32 s64, 2
s_cbranch_scc1 L_l_p1e_13
buffer_store_dwordx4 v[64:67], v1, s[4:7], s60 offen sc1
buffer_store_dwordx4 v[68:71], v1, s[4:7], s61 offen sc1
buffer_store_dwordx4 v[72:75], v1, s[4:7], s62 offen sc1
buffer_store_dwordx4 v[76:79], v1, s[4:7], s63 offen sc1
s_branch L_l_p1e_13
L_l_cen_12:
v_dot2_f32_bf16 v108, v64, s53, 0
v_dot2_f32_bf16 v109, v68, s53, 0
v_dot2_f32_bf16 v110, v72, s53, 0
v_dot2_f32_bf16 v111, v76, s53, 0
v_dot2_f32_bf16 v108, v65, s53, v108
v_dot2_f32_bf16 v109, v69, s53, v109
v_dot2_f32_bf16 v110, v73, s53, v110
v_dot2_f32_bf16 v111, v77, s53, v111
v_dot2_f32_bf16 v108, v66, s53, v108
v_dot2_f32_bf16 v109, v70, s53, v109
v_dot2_f32_bf16 v110, v74, s53, v110
v_dot2_f32_bf16 v111, v78, s53, v111
v_dot2_f32_bf16 v108, v67, s53, v108
v_dot2_f32_bf16 v109, v71, s53, v109
v_dot2_f32_bf16 v110, v75, s53, v110
v_dot2_f32_bf16 v111, v79, s53, v111
s_nop 0
v_permlane32_swap_b32 v108, v109
s_nop 0
v_permlane32_swap_b32 v110, v111
v_add_f32 v108, v108, v109
v_add_f32 v110, v110, v111
s_nop 1
v_permlane16_swap_b32 v108, v110
v_add_f32 v108, v108, v110
ds_write_b32 v105, v108 offset:16384
L_l_p1e_13:
s_waitcnt lgkmcnt(0)
s_cmp_eq_u32 s90, 1
s_cbranch_scc1 L_l_cen_14
s_cmp_eq_u32 s90, 2
s_cbranch_scc1 L_l_p1e_15
buffer_store_dwordx4 v[48:51], v1, s[4:7], s92 offen sc1
buffer_store_dwordx4 v[52:55], v1, s[4:7], s93 offen sc1
buffer_store_dwordx4 v[56:59], v1, s[4:7], s94 offen sc1
buffer_store_dwordx4 v[60:63], v1, s[4:7], s95 offen sc1
s_branch L_l_p1e_15
L_l_cen_14:
v_dot2_f32_bf16 v108, v48, s53, 0
v_dot2_f32_bf16 v109, v52, s53, 0
v_dot2_f32_bf16 v110, v56, s53, 0
v_dot2_f32_bf16 v111, v60, s53, 0
v_dot2_f32_bf16 v108, v49, s53, v108
v_dot2_f32_bf16 v109, v53, s53, v109
v_dot2_f32_bf16 v110, v57, s53, v110
v_dot2_f32_bf16 v111, v61, s53, v111
v_dot2_f32_bf16 v108, v50, s53, v108
v_dot2_f32_bf16 v109, v54, s53, v109
v_dot2_f32_bf16 v110, v58, s53, v110
v_dot2_f32_bf16 v111, v62, s53, v111
v_dot2_f32_bf16 v108, v51, s53, v108
v_dot2_f32_bf16 v109, v55, s53, v109
v_dot2_f32_bf16 v110, v59, s53, v110
v_dot2_f32_bf16 v111, v63, s53, v111
s_nop 0
v_permlane32_swap_b32 v108, v109
s_nop 0
v_permlane32_swap_b32 v110, v111
v_add_f32 v108, v108, v109
v_add_f32 v110, v110, v111
s_nop 1
v_permlane16_swap_b32 v108, v110
v_add_f32 v108, v108, v110
ds_write_b32 v105, v108 offset:16640
L_l_p1e_15:
s_waitcnt lgkmcnt(0)
s_cmp_lg_u32 s38, 0
s_cbranch_scc1 L_l_gl_16
buffer_load_dword v8, off, s[32:35], 0
L_l_gl_16:
s_add_u32 m0, s73, 0x14000
s_add_u32 s48, s55, 0x180
buffer_load_dwordx4 v2, s[8:11], s48 offen offset:0 lds
s_add_u32 s48, s55, 0x1d80
buffer_load_dwordx4 v3, s[8:11], s48 offen offset:1024 lds
s_add_u32 s48, s55, 0x3980
buffer_load_dwordx4 v2, s[8:11], s48 offen offset:2048 lds
s_add_u32 s48, s55, 0x5580
buffer_load_dwordx4 v3, s[8:11], s48 offen offset:3072 lds
s_waitcnt vmcnt(4)
s_barrier
s_add_u32 m0, s73, 0x18000
s_add_u32 s48, s74, 0x200
buffer_load_dwordx4 v2, s[8:11], s48 offen offset:0 lds
s_add_u32 s48, s74, 0x1e00
buffer_load_dwordx4 v3, s[8:11], s48 offen offset:1024 lds
s_add_u32 s48, s74, 0x3a00
buffer_load_dwordx4 v2, s[8:11], s48 offen offset:2048 lds
s_add_u32 s48, s74, 0x5600
buffer_load_dwordx4 v3, s[8:11], s48 offen offset:3072 lds
s_add_u32 m0, s73, 0x1c000
s_add_u32 s48, s75, 0xc0000
buffer_load_dwordx4 v14, s[24:27], s48 offen offset:0 lds
s_add_u32 s48, s75, 0xc5c00
buffer_load_dwordx4 v7, s[24:27], s48 offen offset:1024 lds
s_add_u32 s48, s75, 0xcb800
buffer_load_dwordx4 v14, s[24:27], s48 offen offset:2048 lds
s_add_u32 s48, s75, 0xd1400
buffer_load_dwordx4 v7, s[24:27], s48 offen offset:3072 lds
s_cmp_lg_u32 s38, 0
s_cbranch_scc1 L_l_g_17_ok
s_waitcnt vmcnt(12)
L_l_g_17:
v_cmp_gt_u32 vcc, 48, v8
s_cbranch_vccz L_l_g_17_ok
s_sleep 24
buffer_load_dword v8, off, s[32:35], 0 sc1
s_add_u32 s66, s66, 1
s_cmp_lt_u32 s66, 0x800000
s_waitcnt vmcnt(0)
s_cbranch_scc1 L_l_g_17
L_l_g_17_ok:
s_cmp_eq_u32 s64, 0
s_cbranch_scc1 L_l_pbe_18
s_cmp_lg_u32 s38, 0
s_cbranch_scc1 L_l_pbe_18
v_lshlrev_b32 v96, 2, v0
v_add_u32 v97, 0x24000, v96
ds_read_b32 v108, v97 offset:0
ds_read_b32 v109, v97 offset:4096
ds_read_b32 v110, v97 offset:8192
ds_read_b32 v111, v97 offset:12288
s_waitcnt lgkmcnt(0)
v_add_f32 v108, v108, v109
v_add_f32 v110, v110, v111
v_add_f32 v108, v108, v110
v_min_u32 v108, -2, v108
buffer_store_dword v108, v96, s[4:7], s58 offen sc1
L_l_pbe_18:
s_cmp_eq_u32 s90, 2
s_cbranch_scc1 L_l_sk_19
s_cmp_eq_u32 s90, 0
s_cbranch_scc1 L_l_pbe_20
s_cmp_lg_u32 s38, 0
s_cbranch_scc1 L_l_pbe_20
v_lshlrev_b32 v96, 2, v0
v_add_u32 v97, 0x24100, v96
ds_read_b32 v108, v97 offset:0
ds_read_b32 v109, v97 offset:4096
ds_read_b32 v110, v97 offset:8192
ds_read_b32 v111, v97 offset:12288
s_waitcnt lgkmcnt(0)
v_add_f32 v108, v108, v109
v_add_f32 v110, v110, v111
v_add_f32 v108, v108, v110
v_min_u32 v108, -2, v108
buffer_store_dword v108, v96, s[4:7], s84 offen sc1
L_l_pbe_20:
L_l_sk_19:
s_waitcnt vmcnt(8)
s_barrier
s_add_u32 m0, s73, 0x20000
s_add_u32 s48, s74, 0x280
buffer_load_dwordx4 v2, s[8:11], s48 offen offset:0 lds
s_add_u32 s48, s74, 0x1e80
buffer_load_dwordx4 v3, s[8:11], s48 offen offset:1024 lds
s_add_u32 s48, s74, 0x3a80
buffer_load_dwordx4 v2, s[8:11], s48 offen offset:2048 lds
s_add_u32 s48, s74, 0x5680
buffer_load_dwordx4 v3, s[8:11], s48 offen offset:3072 lds
s_cmp_lg_u32 s64, 0
s_cbranch_scc1 L_l_sk_21
v_mov_b32 v96, 1
s_waitcnt vmcnt(16)
s_mov_b64 exec, 1
buffer_store_dword v96, off, s[4:7], s59 sc1
s_mov_b64 exec, -1
L_l_sk_21:
s_cmp_lg_u32 s90, 0
s_cbranch_scc1 L_l_sk_22
v_mov_b32 v96, 1
s_waitcnt vmcnt(16)
s_mov_b64 exec, 1
buffer_store_dword v96, off, s[4:7], s85 sc1
s_mov_b64 exec, -1
L_l_sk_22:
s_cmp_lg_u32 s38, 1
s_cbranch_scc1 L_l_v_23
s_lshl_b32 s48, s36, 5
s_add_u32 s48, s48, s37
s_lshl_b32 s48, s48, 2
s_add_u32 s48, s48, 0x12f4800
s_add_u32 s49, s47, 1
v_mov_b32 v9, s49
s_mov_b64 exec, 1
buffer_store_dword v9, off, s[4:7], s48
s_mov_b64 exec, -1
L_l_v_23:
s_waitcnt vmcnt(4)
s_barrier
s_add_u32 m0, s73, 0x0
s_add_u32 s48, s74, 0x300
buffer_load_dwordx4 v2, s[8:11], s48 offen offset:0 lds
s_add_u32 s48, s74, 0x1f00
buffer_load_dwordx4 v3, s[8:11], s48 offen offset:1024 lds
s_add_u32 s48, s74, 0x3b00
buffer_load_dwordx4 v2, s[8:11], s48 offen offset:2048 lds
s_add_u32 s48, s74, 0x5700
buffer_load_dwordx4 v3, s[8:11], s48 offen offset:3072 lds
s_add_u32 m0, s73, 0x4000
s_add_u32 s48, s75, 0x120000
buffer_load_dwordx4 v14, s[24:27], s48 offen offset:0 lds
s_add_u32 s48, s75, 0x125c00
buffer_load_dwordx4 v7, s[24:27], s48 offen offset:1024 lds
s_add_u32 s48, s75, 0x12b800
buffer_load_dwordx4 v14, s[24:27], s48 offen offset:2048 lds
s_add_u32 s48, s75, 0x131400
buffer_load_dwordx4 v7, s[24:27], s48 offen offset:3072 lds
s_waitcnt vmcnt(8)
s_barrier
s_add_u32 m0, s73, 0x8000
s_add_u32 s48, s74, 0x380
buffer_load_dwordx4 v2, s[8:11], s48 offen offset:0 lds
s_add_u32 s48, s74, 0x1f80
buffer_load_dwordx4 v3, s[8:11], s48 offen offset:1024 lds
s_add_u32 s48, s74, 0x3b80
buffer_load_dwordx4 v2, s[8:11], s48 offen offset:2048 lds
s_add_u32 s48, s74, 0x5780
buffer_load_dwordx4 v3, s[8:11], s48 offen offset:3072 lds
s_waitcnt vmcnt(4)
s_barrier
s_add_u32 m0, s73, 0xc000
s_add_u32 s48, s57, 0x0
buffer_load_dwordx4 v13, s[24:27], s48 offen offset:0 lds
s_add_u32 s48, s57, 0xbc00
buffer_load_dwordx4 v13, s[24:27], s48 offen offset:1024 lds
s_add_u32 s48, s57, 0x17800
buffer_load_dwordx4 v13, s[24:27], s48 offen offset:2048 lds
s_add_u32 s48, s57, 0x23400
buffer_load_dwordx4 v13, s[24:27], s48 offen offset:3072 lds
s_waitcnt vmcnt(4)
s_barrier
s_lshl_b32 s48, s38, 2
s_add_u32 s48, s48, 0x26210
v_mov_b32 v3, s48
v_mov_b32 v2, 0
ds_write_b32 v3, v2
s_add_u32 m0, s73, 0x10000
s_add_u32 s48, s67, 0xc0000
buffer_load_dwordx4 v13, s[24:27], s48 offen offset:0 lds
s_add_u32 s48, s67, 0xcbc00
buffer_load_dwordx4 v13, s[24:27], s48 offen offset:1024 lds
s_add_u32 s48, s67, 0xd7800
buffer_load_dwordx4 v13, s[24:27], s48 offen offset:2048 lds
s_add_u32 s48, s67, 0xe3400
buffer_load_dwordx4 v13, s[24:27], s48 offen offset:3072 lds
s_mul_i32 s48, s42, 14
s_add_u32 s48, s48, 320
s_lshl_b32 s50, s42, 2
s_add_u32 s50, s50, 432
v_min_u32 v4, 13, v0
v_add_u32 v4, s48, v4
v_and_b32 v5, 3, v0
v_add_u32 v5, s50, v5
v_cmp_le_u32 vcc, 32, v0
s_nop 1
v_cndmask_b32 v4, v4, v5, vcc
v_lshlrev_b32 v4, 7, v4
s_mov_b32 s49, 0x12e6000
buffer_load_dwordx4 v[8:11], v4, s[4:7], s49 offen
s_waitcnt lgkmcnt(0)
s_barrier
s_waitcnt vmcnt(1)
v_mov_b32 v2, 1
ds_write_b32 v3, v2
s_waitcnt vmcnt(0)
v_min3_u32 v8, v8, v9, v10
v_min_u32 v8, v8, v11
v_cmp_eq_u32 vcc, 0, v8
s_cbranch_vccz L_l_pf_25_ok
s_mov_b32 s49, 0x12e6000
L_l_pf_25:
buffer_load_dwordx4 v[8:11], v4, s[4:7], s49 offen sc1
s_add_u32 s66, s66, 1
s_waitcnt vmcnt(0)
v_min3_u32 v8, v8, v9, v10
v_min_u32 v8, v8, v11
v_cmp_eq_u32 vcc, 0, v8
s_cbranch_vccz L_l_pf_25_ok
s_sleep 12
s_cmp_lt_u32 s66, 0x800000
s_cbranch_scc1 L_l_pf_25
L_l_pf_25_ok:
s_add_u32 m0, s73, 0x14000
s_add_u32 s48, s83, 0x6c0000
buffer_load_dwordx4 v1, s[4:7], s48 offen offset:0 lds
buffer_load_dwordx4 v1, s[4:7], s48 offen offset:1024 lds
buffer_load_dwordx4 v1, s[4:7], s48 offen offset:2048 lds
buffer_load_dwordx4 v1, s[4:7], s48 offen offset:3072 lds
s_add_u32 m0, s73, 0x18000
s_add_u32 s48, s83, 0x6c4000
buffer_load_dwordx4 v1, s[4:7], s48 offen offset:0 lds
buffer_load_dwordx4 v1, s[4:7], s48 offen offset:1024 lds
buffer_load_dwordx4 v1, s[4:7], s48 offen offset:2048 lds
buffer_load_dwordx4 v1, s[4:7], s48 offen offset:3072 lds
s_add_u32 m0, s73, 0x1c000
s_add_u32 s48, s83, 0x6c8000
buffer_load_dwordx4 v1, s[4:7], s48 offen offset:0 lds
buffer_load_dwordx4 v1, s[4:7], s48 offen offset:1024 lds
buffer_load_dwordx4 v1, s[4:7], s48 offen offset:2048 lds
buffer_load_dwordx4 v1, s[4:7], s48 offen offset:3072 lds
s_add_u32 m0, s73, 0x20000
s_add_u32 s48, s83, 0x6cc000
buffer_load_dwordx4 v1, s[4:7], s48 offen offset:0 lds
buffer_load_dwordx4 v1, s[4:7], s48 offen offset:1024 lds
buffer_load_dwordx4 v1, s[4:7], s48 offen offset:2048 lds
buffer_load_dwordx4 v1, s[4:7], s48 offen offset:3072 lds
s_cmp_eq_u32 s64, 0
s_cbranch_scc1 L_l_p2f_26
v_lshlrev_b32 v96, 2, v0
L_l_p2p_27:
buffer_load_dword v108, v96, s[4:7], s65 offen offset:0 sc1
buffer_load_dword v109, v96, s[4:7], s65 offen offset:256 sc1
buffer_load_dword v110, v96, s[4:7], s65 offen offset:512 sc1
buffer_load_dword v111, v96, s[4:7], s65 offen offset:768 sc1
s_add_u32 s66, s66, 1
s_waitcnt vmcnt(0)
v_max3_u32 v97, v108, v109, v110
v_max_u32 v97, v97, v111
v_cmp_eq_u32 vcc, -1, v97
s_cbranch_vccz L_l_p2p_27_ok
s_sleep 12
s_cmp_lt_u32 s66, 0x800000
s_cbranch_scc1 L_l_p2p_27
L_l_p2p_27_ok:
v_add_f32 v108, v108, v109
v_add_f32 v110, v110, v111
v_add_f32 v108, v108, v110
v_mul_f32 v108, 0x3b000000, v108
v_mov_b32 v110, v108
s_nop 1
v_permlane16_swap_b32 v108, v110
v_mov_b32 v109, v108
v_mov_b32 v111, v110
s_nop 0
v_permlane32_swap_b32 v108, v109
v_permlane32_swap_b32 v110, v111
v_lshlrev_b32 v96, 16, v64
v_and_b32 v97, 0xffff0000, v64
v_lshlrev_b32 v98, 16, v68
v_and_b32 v99, 0xffff0000, v68
v_lshlrev_b32 v100, 16, v72
v_and_b32 v101, 0xffff0000, v72
v_lshlrev_b32 v102, 16, v76
v_and_b32 v103, 0xffff0000, v76
v_sub_f32 v96, v96, v108
v_sub_f32 v97, v97, v108
v_sub_f32 v98, v98, v109
v_sub_f32 v99, v99, v109
v_sub_f32 v100, v100, v110
v_sub_f32 v101, v101, v110
v_sub_f32 v102, v102, v111
v_sub_f32 v103, v103, v111
v_cvt_pk_bf16_f32 v64, v96, v97
v_cvt_pk_bf16_f32 v68, v98, v99
v_cvt_pk_bf16_f32 v72, v100, v101
v_cvt_pk_bf16_f32 v76, v102, v103
v_add_f32 v96, v96, v97
v_lshlrev_b32 v97, 16, v64
v_add_f32 v98, v98, v99
v_lshlrev_b32 v99, 16, v68
v_add_f32 v100, v100, v101
v_lshlrev_b32 v101, 16, v72
v_add_f32 v102, v102, v103
v_lshlrev_b32 v103, 16, v76
v_sub_f32 v96, v96, v97
v_and_b32 v97, 0xffff0000, v64
v_sub_f32 v98, v98, v99
v_and_b32 v99, 0xffff0000, v68
v_sub_f32 v100, v100, v101
v_and_b32 v101, 0xffff0000, v72
v_sub_f32 v102, v102, v103
v_and_b32 v103, 0xffff0000, v76
v_sub_f32 v96, v96, v97
v_sub_f32 v98, v98, v99
v_sub_f32 v100, v100, v101
v_sub_f32 v102, v102, v103
v_sub_f32 v104, v108, v96
v_sub_f32 v105, v109, v98
v_sub_f32 v106, v110, v100
v_sub_f32 v107, v111, v102
v_lshlrev_b32 v96, 16, v65
v_and_b32 v97, 0xffff0000, v65
v_lshlrev_b32 v98, 16, v69
v_and_b32 v99, 0xffff0000, v69
v_lshlrev_b32 v100, 16, v73
v_and_b32 v101, 0xffff0000, v73
v_lshlrev_b32 v102, 16, v77
v_and_b32 v103, 0xffff0000, v77
v_sub_f32 v96, v96, v104
v_sub_f32 v97, v97, v108
v_sub_f32 v98, v98, v105
v_sub_f32 v99, v99, v109
v_sub_f32 v100, v100, v106
v_sub_f32 v101, v101, v110
v_sub_f32 v102, v102, v107
v_sub_f32 v103, v103, v111
v_cvt_pk_bf16_f32 v65, v96, v97
v_cvt_pk_bf16_f32 v69, v98, v99
v_cvt_pk_bf16_f32 v73, v100, v101
v_cvt_pk_bf16_f32 v77, v102, v103
v_add_f32 v96, v96, v97
v_lshlrev_b32 v97, 16, v65
v_add_f32 v98, v98, v99
v_lshlrev_b32 v99, 16, v69
v_add_f32 v100, v100, v101
v_lshlrev_b32 v101, 16, v73
v_add_f32 v102, v102, v103
v_lshlrev_b32 v103, 16, v77
v_sub_f32 v96, v96, v97
v_and_b32 v97, 0xffff0000, v65
v_sub_f32 v98, v98, v99
v_and_b32 v99, 0xffff0000, v69
v_sub_f32 v100, v100, v101
v_and_b32 v101, 0xffff0000, v73
v_sub_f32 v102, v102, v103
v_and_b32 v103, 0xffff0000, v77
v_sub_f32 v96, v96, v97
v_sub_f32 v98, v98, v99
v_sub_f32 v100, v100, v101
v_sub_f32 v102, v102, v103
v_sub_f32 v104, v108, v96
v_sub_f32 v105, v109, v98
v_sub_f32 v106, v110, v100
v_sub_f32 v107, v111, v102
v_lshlrev_b32 v96, 16, v66
v_and_b32 v97, 0xffff0000, v66
v_lshlrev_b32 v98, 16, v70
v_and_b32 v99, 0xffff0000, v70
v_lshlrev_b32 v100, 16, v74
v_and_b32 v101, 0xffff0000, v74
v_lshlrev_b32 v102, 16, v78
v_and_b32 v103, 0xffff0000, v78
v_sub_f32 v96, v96, v104
v_sub_f32 v97, v97, v108
v_sub_f32 v98, v98, v105
v_sub_f32 v99, v99, v109
v_sub_f32 v100, v100, v106
v_sub_f32 v101, v101, v110
v_sub_f32 v102, v102, v107
v_sub_f32 v103, v103, v111
v_cvt_pk_bf16_f32 v66, v96, v97
v_cvt_pk_bf16_f32 v70, v98, v99
v_cvt_pk_bf16_f32 v74, v100, v101
v_cvt_pk_bf16_f32 v78, v102, v103
v_add_f32 v96, v96, v97
v_lshlrev_b32 v97, 16, v66
v_add_f32 v98, v98, v99
v_lshlrev_b32 v99, 16, v70
v_add_f32 v100, v100, v101
v_lshlrev_b32 v101, 16, v74
v_add_f32 v102, v102, v103
v_lshlrev_b32 v103, 16, v78
v_sub_f32 v96, v96, v97
v_and_b32 v97, 0xffff0000, v66
v_sub_f32 v98, v98, v99
v_and_b32 v99, 0xffff0000, v70
v_sub_f32 v100, v100, v101
v_and_b32 v101, 0xffff0000, v74
v_sub_f32 v102, v102, v103
v_and_b32 v103, 0xffff0000, v78
v_sub_f32 v96, v96, v97
v_sub_f32 v98, v98, v99
v_sub_f32 v100, v100, v101
v_sub_f32 v102, v102, v103
v_sub_f32 v104, v108, v96
v_sub_f32 v105, v109, v98
v_sub_f32 v106, v110, v100
v_sub_f32 v107, v111, v102
v_lshlrev_b32 v96, 16, v67
v_and_b32 v97, 0xffff0000, v67
v_lshlrev_b32 v98, 16, v71
v_and_b32 v99, 0xffff0000, v71
v_lshlrev_b32 v100, 16, v75
v_and_b32 v101, 0xffff0000, v75
v_lshlrev_b32 v102, 16, v79
v_and_b32 v103, 0xffff0000, v79
v_sub_f32 v96, v96, v104
v_sub_f32 v97, v97, v108
v_sub_f32 v98, v98, v105
v_sub_f32 v99, v99, v109
v_sub_f32 v100, v100, v106
v_sub_f32 v101, v101, v110
v_sub_f32 v102, v102, v107
v_sub_f32 v103, v103, v111
v_cvt_pk_bf16_f32 v67, v96, v97
v_cvt_pk_bf16_f32 v71, v98, v99
v_cvt_pk_bf16_f32 v75, v100, v101
v_cvt_pk_bf16_f32 v79, v102, v103
buffer_store_dwordx4 v[64:67], v1, s[4:7], s60 offen sc1
buffer_store_dwordx4 v[68:71], v1, s[4:7], s61 offen sc1
buffer_store_dwordx4 v[72:75], v1, s[4:7], s62 offen sc1
buffer_store_dwordx4 v[76:79], v1, s[4:7], s63 offen sc1
L_l_p2f_26:
v_mov_b32 v5, 0x26200
L_l_pa_28:
ds_read_b128 v[8:11], v5
s_add_u32 s66, s66, 1
s_waitcnt lgkmcnt(0)
v_min3_u32 v8, v8, v9, v10
v_min_u32 v8, v8, v11
v_cmp_gt_u32 vcc, 1, v8
s_cbranch_vccz L_l_pa_28_ok
s_sleep 2
s_cmp_lt_u32 s66, 0x800000
s_cbranch_scc1 L_l_pa_28
L_l_pa_28_ok:
s_cmp_eq_u32 s64, 0
s_cbranch_scc1 L_l_sk_29
v_mov_b32 v96, 1
s_waitcnt vmcnt(0)
s_mov_b64 exec, 1
buffer_store_dword v96, off, s[4:7], s59 sc1
s_mov_b64 exec, -1
L_l_sk_29:
s_cmp_lg_u32 s38, 1
s_cbranch_scc1 L_l_m_30_e
s_mov_b32 s51, 0
s_lshl_b32 s48, s36, 7
s_add_u32 s48, s48, 0x12f4800
s_add_u32 s49, s47, 1
v_and_b32 v4, 31, v0
v_lshlrev_b32 v4, 2, v4
L_l_m_30:
buffer_load_dword v8, v4, s[4:7], s48 offen sc1
s_add_u32 s66, s66, 1
s_waitcnt vmcnt(0)
v_cmp_eq_u32 vcc, 0, v8
s_cbranch_vccz L_l_m_30_ok
s_sleep 8
s_add_u32 s51, s51, 1
s_cmp_ge_u32 s51, 24
s_cselect_b32 s50, 1024, 0
s_xor_b32 s48, s48, s50
s_cmp_lg_u32 s51, 24
s_cbranch_scc1 L_l_m_30_n
s_lshl_b32 s50, s37, 2
s_add_u32 s50, s50, s48
v_mov_b32 v9, s49
s_mov_b64 exec, 1
buffer_store_dword v9, off, s[4:7], s50 sc1
s_mov_b64 exec, -1
L_l_m_30_n:
s_cmp_lt_u32 s66, 0x800000
s_cbranch_scc1 L_l_m_30
L_l_m_30_ok:
v_cmp_ne_u32 vcc, s49, v8
s_cbranch_vccz L_l_m_30_l
s_or_b32 s48, s48, 1024
s_lshl_b32 s50, s37, 2
s_add_u32 s50, s50, s48
v_mov_b32 v9, s49
s_mov_b64 exec, 1
buffer_store_dword v9, off, s[4:7], s50 sc1
s_mov_b64 exec, -1
L_l_m_30_l:
s_cmp_lg_u64 vcc, 0
s_cselect_b32 s48, 1, 0
v_mov_b32 v8, s48
v_mov_b32 v9, 34816
ds_write_b32 v9, v8
s_waitcnt lgkmcnt(0)
L_l_m_30_e:
s_waitcnt vmcnt(0)
v_mov_b32 v2, 2
ds_write_b32 v3, v2
s_cmp_lg_u32 s90, 1
s_cbranch_scc1 L_l_sk_31
s_cmp_eq_u32 s90, 0
s_cbranch_scc1 L_l_p2f_32
v_lshlrev_b32 v96, 2, v0
L_l_p2p_33:
buffer_load_dword v108, v96, s[4:7], s91 offen offset:0 sc1
buffer_load_dword v109, v96, s[4:7], s91 offen offset:256 sc1
buffer_load_dword v110, v96, s[4:7], s91 offen offset:512 sc1
buffer_load_dword v111, v96, s[4:7], s91 offen offset:768 sc1
s_add_u32 s66, s66, 1
s_waitcnt vmcnt(0)
v_max3_u32 v97, v108, v109, v110
v_max_u32 v97, v97, v111
v_cmp_eq_u32 vcc, -1, v97
s_cbranch_vccz L_l_p2p_33_ok
s_sleep 12
s_cmp_lt_u32 s66, 0x800000
s_cbranch_scc1 L_l_p2p_33
L_l_p2p_33_ok:
v_add_f32 v108, v108, v109
v_add_f32 v110, v110, v111
v_add_f32 v108, v108, v110
v_mul_f32 v108, 0x3b000000, v108
v_mov_b32 v110, v108
s_nop 1
v_permlane16_swap_b32 v108, v110
v_mov_b32 v109, v108
v_mov_b32 v111, v110
s_nop 0
v_permlane32_swap_b32 v108, v109
v_permlane32_swap_b32 v110, v111
v_lshlrev_b32 v96, 16, v48
v_and_b32 v97, 0xffff0000, v48
v_lshlrev_b32 v98, 16, v52
v_and_b32 v99, 0xffff0000, v52
v_lshlrev_b32 v100, 16, v56
v_and_b32 v101, 0xffff0000, v56
v_lshlrev_b32 v102, 16, v60
v_and_b32 v103, 0xffff0000, v60
v_sub_f32 v96, v96, v108
v_sub_f32 v97, v97, v108
v_sub_f32 v98, v98, v109
v_sub_f32 v99, v99, v109
v_sub_f32 v100, v100, v110
v_sub_f32 v101, v101, v110
v_sub_f32 v102, v102, v111
v_sub_f32 v103, v103, v111
v_cvt_pk_bf16_f32 v48, v96, v97
v_cvt_pk_bf16_f32 v52, v98, v99
v_cvt_pk_bf16_f32 v56, v100, v101
v_cvt_pk_bf16_f32 v60, v102, v103
v_add_f32 v96, v96, v97
v_lshlrev_b32 v97, 16, v48
v_add_f32 v98, v98, v99
v_lshlrev_b32 v99, 16, v52
v_add_f32 v100, v100, v101
v_lshlrev_b32 v101, 16, v56
v_add_f32 v102, v102, v103
v_lshlrev_b32 v103, 16, v60
v_sub_f32 v96, v96, v97
v_and_b32 v97, 0xffff0000, v48
v_sub_f32 v98, v98, v99
v_and_b32 v99, 0xffff0000, v52
v_sub_f32 v100, v100, v101
v_and_b32 v101, 0xffff0000, v56
v_sub_f32 v102, v102, v103
v_and_b32 v103, 0xffff0000, v60
v_sub_f32 v96, v96, v97
v_sub_f32 v98, v98, v99
v_sub_f32 v100, v100, v101
v_sub_f32 v102, v102, v103
v_sub_f32 v104, v108, v96
v_sub_f32 v105, v109, v98
v_sub_f32 v106, v110, v100
v_sub_f32 v107, v111, v102
v_lshlrev_b32 v96, 16, v49
v_and_b32 v97, 0xffff0000, v49
v_lshlrev_b32 v98, 16, v53
v_and_b32 v99, 0xffff0000, v53
v_lshlrev_b32 v100, 16, v57
v_and_b32 v101, 0xffff0000, v57
v_lshlrev_b32 v102, 16, v61
v_and_b32 v103, 0xffff0000, v61
v_sub_f32 v96, v96, v104
v_sub_f32 v97, v97, v108
v_sub_f32 v98, v98, v105
v_sub_f32 v99, v99, v109
v_sub_f32 v100, v100, v106
v_sub_f32 v101, v101, v110
v_sub_f32 v102, v102, v107
v_sub_f32 v103, v103, v111
v_cvt_pk_bf16_f32 v49, v96, v97
v_cvt_pk_bf16_f32 v53, v98, v99
v_cvt_pk_bf16_f32 v57, v100, v101
v_cvt_pk_bf16_f32 v61, v102, v103
v_add_f32 v96, v96, v97
v_lshlrev_b32 v97, 16, v49
v_add_f32 v98, v98, v99
v_lshlrev_b32 v99, 16, v53
v_add_f32 v100, v100, v101
v_lshlrev_b32 v101, 16, v57
v_add_f32 v102, v102, v103
v_lshlrev_b32 v103, 16, v61
v_sub_f32 v96, v96, v97
v_and_b32 v97, 0xffff0000, v49
v_sub_f32 v98, v98, v99
v_and_b32 v99, 0xffff0000, v53
v_sub_f32 v100, v100, v101
v_and_b32 v101, 0xffff0000, v57
v_sub_f32 v102, v102, v103
v_and_b32 v103, 0xffff0000, v61
v_sub_f32 v96, v96, v97
v_sub_f32 v98, v98, v99
v_sub_f32 v100, v100, v101
v_sub_f32 v102, v102, v103
v_sub_f32 v104, v108, v96
v_sub_f32 v105, v109, v98
v_sub_f32 v106, v110, v100
v_sub_f32 v107, v111, v102
v_lshlrev_b32 v96, 16, v50
v_and_b32 v97, 0xffff0000, v50
v_lshlrev_b32 v98, 16, v54
v_and_b32 v99, 0xffff0000, v54
v_lshlrev_b32 v100, 16, v58
v_and_b32 v101, 0xffff0000, v58
v_lshlrev_b32 v102, 16, v62
v_and_b32 v103, 0xffff0000, v62
v_sub_f32 v96, v96, v104
v_sub_f32 v97, v97, v108
v_sub_f32 v98, v98, v105
v_sub_f32 v99, v99, v109
v_sub_f32 v100, v100, v106
v_sub_f32 v101, v101, v110
v_sub_f32 v102, v102, v107
v_sub_f32 v103, v103, v111
v_cvt_pk_bf16_f32 v50, v96, v97
v_cvt_pk_bf16_f32 v54, v98, v99
v_cvt_pk_bf16_f32 v58, v100, v101
v_cvt_pk_bf16_f32 v62, v102, v103
v_add_f32 v96, v96, v97
v_lshlrev_b32 v97, 16, v50
v_add_f32 v98, v98, v99
v_lshlrev_b32 v99, 16, v54
v_add_f32 v100, v100, v101
v_lshlrev_b32 v101, 16, v58
v_add_f32 v102, v102, v103
v_lshlrev_b32 v103, 16, v62
v_sub_f32 v96, v96, v97
v_and_b32 v97, 0xffff0000, v50
v_sub_f32 v98, v98, v99
v_and_b32 v99, 0xffff0000, v54
v_sub_f32 v100, v100, v101
v_and_b32 v101, 0xffff0000, v58
v_sub_f32 v102, v102, v103
v_and_b32 v103, 0xffff0000, v62
v_sub_f32 v96, v96, v97
v_sub_f32 v98, v98, v99
v_sub_f32 v100, v100, v101
v_sub_f32 v102, v102, v103
v_sub_f32 v104, v108, v96
v_sub_f32 v105, v109, v98
v_sub_f32 v106, v110, v100
v_sub_f32 v107, v111, v102
v_lshlrev_b32 v96, 16, v51
v_and_b32 v97, 0xffff0000, v51
v_lshlrev_b32 v98, 16, v55
v_and_b32 v99, 0xffff0000, v55
v_lshlrev_b32 v100, 16, v59
v_and_b32 v101, 0xffff0000, v59
v_lshlrev_b32 v102, 16, v63
v_and_b32 v103, 0xffff0000, v63
v_sub_f32 v96, v96, v104
v_sub_f32 v97, v97, v108
v_sub_f32 v98, v98, v105
v_sub_f32 v99, v99, v109
v_sub_f32 v100, v100, v106
v_sub_f32 v101, v101, v110
v_sub_f32 v102, v102, v107
v_sub_f32 v103, v103, v111
v_cvt_pk_bf16_f32 v51, v96, v97
v_cvt_pk_bf16_f32 v55, v98, v99
v_cvt_pk_bf16_f32 v59, v100, v101
v_cvt_pk_bf16_f32 v63, v102, v103
buffer_store_dwordx4 v[48:51], v1, s[4:7], s92 offen sc1
buffer_store_dwordx4 v[52:55], v1, s[4:7], s93 offen sc1
buffer_store_dwordx4 v[56:59], v1, s[4:7], s94 offen sc1
buffer_store_dwordx4 v[60:63], v1, s[4:7], s95 offen sc1
L_l_p2f_32:
L_l_sk_31:
s_add_u32 s48, s82, 0x524000
buffer_load_dwordx4 a[0:3], v1, s[4:7], s48 offen offset:0
buffer_load_dwordx4 a[4:7], v1, s[4:7], s48 offen offset:1024
buffer_load_dwordx4 a[8:11], v1, s[4:7], s48 offen offset:2048
buffer_load_dwordx4 a[12:15], v1, s[4:7], s48 offen offset:3072
s_add_u32 s48, s82, 0x528000
buffer_load_dwordx4 a[16:19], v1, s[4:7], s48 offen offset:0
buffer_load_dwordx4 a[20:23], v1, s[4:7], s48 offen offset:1024
buffer_load_dwordx4 a[24:27], v1, s[4:7], s48 offen offset:2048
buffer_load_dwordx4 a[28:31], v1, s[4:7], s48 offen offset:3072
v_mov_b32 v5, 0x26200
L_l_pa_34:
ds_read_b128 v[8:11], v5
s_add_u32 s66, s66, 1
s_waitcnt lgkmcnt(0)
v_min3_u32 v8, v8, v9, v10
v_min_u32 v8, v8, v11
v_cmp_gt_u32 vcc, 2, v8
s_cbranch_vccz L_l_pa_34_ok
s_sleep 2
s_cmp_lt_u32 s66, 0x800000
s_cbranch_scc1 L_l_pa_34
L_l_pa_34_ok:
s_cmp_lg_u32 s90, 1
s_cbranch_scc1 L_l_sk_35
v_mov_b32 v96, 1
s_waitcnt vmcnt(8)
s_mov_b64 exec, 1
buffer_store_dword v96, off, s[4:7], s85 sc1
s_mov_b64 exec, -1
L_l_sk_35:
s_mul_i32 s50, s40, 7
s_lshr_b32 s48, s50, 2
s_add_u32 s50, s50, 6
s_lshr_b32 s50, s50, 2
v_bfe_u32 v4, v0, 2, 2
v_add_u32 v4, s48, v4
v_min_u32 v4, s50, v4
v_bfe_u32 v5, v0, 4, 1
v_mul_u32_u24 v5, 28, v5
v_add_u32 v4, v4, v5
v_and_b32 v5, 3, v0
v_lshlrev_b32 v5, 7, v5
v_lshl_add_u32 v4, v4, 9, v5
s_mov_b32 s49, 0x12e6000
buffer_load_dwordx4 v[8:11], v4, s[4:7], s49 offen
s_waitcnt vmcnt(0)
v_min3_u32 v8, v8, v9, v10
v_min_u32 v8, v8, v11
v_cmp_eq_u32 vcc, 0, v8
s_cbranch_vccz L_l_pf_37_ok
s_mov_b32 s49, 0x12e6000
L_l_pf_37:
buffer_load_dwordx4 v[8:11], v4, s[4:7], s49 offen sc1
s_add_u32 s66, s66, 1
s_waitcnt vmcnt(0)
v_min3_u32 v8, v8, v9, v10
v_min_u32 v8, v8, v11
v_cmp_eq_u32 vcc, 0, v8
s_cbranch_vccz L_l_pf_37_ok
s_sleep 12
s_cmp_lt_u32 s66, 0x800000
s_cbranch_scc1 L_l_pf_37
L_l_pf_37_ok:
s_add_u32 s48, s81, 0x180000
buffer_load_dwordx4 v[96:99], v1, s[4:7], s48 offen offset:0
buffer_load_dwordx4 v[100:103], v1, s[4:7], s48 offen offset:1024
buffer_load_dwordx4 v[104:107], v1, s[4:7], s48 offen offset:2048
buffer_load_dwordx4 v[108:111], v1, s[4:7], s48 offen offset:3072
s_add_u32 s48, s81, 0x184000
buffer_load_dwordx4 v[48:51], v1, s[4:7], s48 offen offset:0
buffer_load_dwordx4 v[52:55], v1, s[4:7], s48 offen offset:1024
buffer_load_dwordx4 v[56:59], v1, s[4:7], s48 offen offset:2048
buffer_load_dwordx4 v[60:63], v1, s[4:7], s48 offen offset:3072
s_barrier
s_add_u32 s48, s81, 0x188000
buffer_load_dwordx4 v[32:35], v1, s[4:7], s48 offen offset:0
buffer_load_dwordx4 v[36:39], v1, s[4:7], s48 offen offset:1024
buffer_load_dwordx4 v[40:43], v1, s[4:7], s48 offen offset:2048
buffer_load_dwordx4 v[44:47], v1, s[4:7], s48 offen offset:3072
s_add_u32 s48, s81, 0x18c000
buffer_load_dwordx4 v[80:83], v1, s[4:7], s48 offen offset:0
buffer_load_dwordx4 v[84:87], v1, s[4:7], s48 offen offset:1024
buffer_load_dwordx4 v[88:91], v1, s[4:7], s48 offen offset:2048
buffer_load_dwordx4 v[92:95], v1, s[4:7], s48 offen offset:3072
s_add_u32 s48, s81, 0x190000
buffer_load_dwordx4 v[64:67], v1, s[4:7], s48 offen offset:0
buffer_load_dwordx4 v[68:71], v1, s[4:7], s48 offen offset:1024
buffer_load_dwordx4 v[72:75], v1, s[4:7], s48 offen offset:2048
buffer_load_dwordx4 v[76:79], v1, s[4:7], s48 offen offset:3072
s_waitcnt vmcnt(16)
s_add_u32 s48, s73, 0x0
v_add_u32 v15, s48, v1
ds_write_b128 v15, v[96:99] offset:0
ds_write_b128 v15, v[100:103] offset:1024
ds_write_b128 v15, v[104:107] offset:2048
ds_write_b128 v15, v[108:111] offset:3072
s_waitcnt lgkmcnt(0)
s_barrier
s_waitcnt vmcnt(12)
s_add_u32 s48, s73, 0x4000
v_add_u32 v15, s48, v1
ds_write_b128 v15, v[48:51] offset:0
ds_write_b128 v15, v[52:55] offset:1024
ds_write_b128 v15, v[56:59] offset:2048
ds_write_b128 v15, v[60:63] offset:3072
s_waitcnt lgkmcnt(0)
s_barrier
s_waitcnt vmcnt(8)
s_add_u32 s48, s73, 0x8000
v_add_u32 v15, s48, v1
ds_write_b128 v15, v[32:35] offset:0
ds_write_b128 v15, v[36:39] offset:1024
ds_write_b128 v15, v[40:43] offset:2048
ds_write_b128 v15, v[44:47] offset:3072
s_waitcnt vmcnt(4)
s_add_u32 s48, s73, 0xc000
v_add_u32 v15, s48, v1
ds_write_b128 v15, v[80:83] offset:0
ds_write_b128 v15, v[84:87] offset:1024
ds_write_b128 v15, v[88:91] offset:2048
ds_write_b128 v15, v[92:95] offset:3072
s_waitcnt lgkmcnt(4)
s_barrier
s_waitcnt vmcnt(0)
s_add_u32 s48, s73, 0x10000
v_add_u32 v15, s48, v1
ds_write_b128 v15, v[64:67] offset:0
ds_write_b128 v15, v[68:71] offset:1024
ds_write_b128 v15, v[72:75] offset:2048
ds_write_b128 v15, v[76:79] offset:3072
s_waitcnt lgkmcnt(4)
s_barrier
s_add_u32 s48, s81, 0x194000
buffer_load_dwordx4 v[112:115], v1, s[4:7], s48 offen offset:0
buffer_load_dwordx4 v[116:119], v1, s[4:7], s48 offen offset:1024
buffer_load_dwordx4 v[120:123], v1, s[4:7], s48 offen offset:2048
buffer_load_dwordx4 v[124:127], v1, s[4:7], s48 offen offset:3072
s_add_u32 s48, s81, 0x198000
buffer_load_dwordx4 v[16:19], v1, s[4:7], s48 offen offset:0
buffer_load_dwordx4 v[20:23], v1, s[4:7], s48 offen offset:1024
buffer_load_dwordx4 v[24:27], v1, s[4:7], s48 offen offset:2048
buffer_load_dwordx4 v[28:31], v1, s[4:7], s48 offen offset:3072
s_waitcnt vmcnt(4)
s_add_u32 s48, s73, 0x14000
v_add_u32 v15, s48, v1
ds_write_b128 v15, v[112:115] offset:0
ds_write_b128 v15, v[116:119] offset:1024
ds_write_b128 v15, v[120:123] offset:2048
ds_write_b128 v15, v[124:127] offset:3072
s_waitcnt lgkmcnt(0)
s_barrier
s_add_u32 s48, s81, 0x19c000
buffer_load_dwordx4 a[112:115], v1, s[4:7], s48 offen offset:0
buffer_load_dwordx4 a[116:119], v1, s[4:7], s48 offen offset:1024
buffer_load_dwordx4 a[120:123], v1, s[4:7], s48 offen offset:2048
buffer_load_dwordx4 a[124:127], v1, s[4:7], s48 offen offset:3072
s_add_u32 s48, s81, 0x1a0000
buffer_load_dwordx4 a[96:99], v1, s[4:7], s48 offen offset:0
buffer_load_dwordx4 a[100:103], v1, s[4:7], s48 offen offset:1024
buffer_load_dwordx4 a[104:107], v1, s[4:7], s48 offen offset:2048
buffer_load_dwordx4 a[108:111], v1, s[4:7], s48 offen offset:3072
s_add_u32 m0, s73, 0x0
s_add_u32 s48, s81, 0x1a4000
buffer_load_dwordx4 v1, s[4:7], s48 offen offset:0 lds
buffer_load_dwordx4 v1, s[4:7], s48 offen offset:1024 lds
buffer_load_dwordx4 v1, s[4:7], s48 offen offset:2048 lds
buffer_load_dwordx4 v1, s[4:7], s48 offen offset:3072 lds
s_waitcnt vmcnt(12)
s_add_u32 s48, s73, 0x18000
v_add_u32 v15, s48, v1
ds_write_b128 v15, v[16:19] offset:0
ds_write_b128 v15, v[20:23] offset:1024
ds_write_b128 v15, v[24:27] offset:2048
ds_write_b128 v15, v[28:31] offset:3072
s_waitcnt vmcnt(8)
s_add_u32 s48, s73, 0x1c000
v_add_u32 v15, s48, v1
ds_write_b128 v15, a[112:115] offset:0
ds_write_b128 v15, a[116:119] offset:1024
ds_write_b128 v15, a[120:123] offset:2048
ds_write_b128 v15, a[124:127] offset:3072
s_waitcnt lgkmcnt(0)
s_barrier
s_add_u32 m0, s73, 0x4000
s_add_u32 s48, s81, 0x1a8000
buffer_load_dwordx4 v1, s[4:7], s48 offen offset:0 lds
buffer_load_dwordx4 v1, s[4:7], s48 offen offset:1024 lds
buffer_load_dwordx4 v1, s[4:7], s48 offen offset:2048 lds
buffer_load_dwordx4 v1, s[4:7], s48 offen offset:3072 lds
s_add_u32 m0, s73, 0x8000
s_add_u32 s48, s81, 0x1ac000
buffer_load_dwordx4 v1, s[4:7], s48 offen offset:0 lds
buffer_load_dwordx4 v1, s[4:7], s48 offen offset:1024 lds
buffer_load_dwordx4 v1, s[4:7], s48 offen offset:2048 lds
buffer_load_dwordx4 v1, s[4:7], s48 offen offset:3072 lds
s_add_u32 m0, s73, 0xc000
s_add_u32 s48, s81, 0x1b0000
buffer_load_dwordx4 v1, s[4:7], s48 offen offset:0 lds
buffer_load_dwordx4 v1, s[4:7], s48 offen offset:1024 lds
buffer_load_dwordx4 v1, s[4:7], s48 offen offset:2048 lds
buffer_load_dwordx4 v1, s[4:7], s48 offen offset:3072 lds
s_waitcnt vmcnt(16)
s_add_u32 s48, s73, 0x20000
v_add_u32 v15, s48, v1
ds_write_b128 v15, a[96:99] offset:0
ds_write_b128 v15, a[100:103] offset:1024
ds_write_b128 v15, a[104:107] offset:2048
ds_write_b128 v15, a[108:111] offset:3072
s_waitcnt vmcnt(12)
s_waitcnt lgkmcnt(0)
s_barrier
s_add_u32 m0, s73, 0x10000
s_add_u32 s48, s81, 0x1b4000
buffer_load_dwordx4 v1, s[4:7], s48 offen offset:0 lds
buffer_load_dwordx4 v1, s[4:7], s48 offen offset:1024 lds
buffer_load_dwordx4 v1, s[4:7], s48 offen offset:2048 lds
buffer_load_dwordx4 v1, s[4:7], s48 offen offset:3072 lds
s_add_u32 m0, s73, 0x14000
s_add_u32 s48, s82, 0x500000
buffer_load_dwordx4 v1, s[4:7], s48 offen offset:0 lds
buffer_load_dwordx4 v1, s[4:7], s48 offen offset:1024 lds
buffer_load_dwordx4 v1, s[4:7], s48 offen offset:2048 lds
buffer_load_dwordx4 v1, s[4:7], s48 offen offset:3072 lds
s_add_u32 m0, s73, 0x18000
s_add_u32 s48, s82, 0x504000
buffer_load_dwordx4 v1, s[4:7], s48 offen offset:0 lds
buffer_load_dwordx4 v1, s[4:7], s48 offen offset:1024 lds
buffer_load_dwordx4 v1, s[4:7], s48 offen offset:2048 lds
buffer_load_dwordx4 v1, s[4:7], s48 offen offset:3072 lds
s_waitcnt vmcnt(16)
s_barrier
s_add_u32 m0, s73, 0x1c000
s_add_u32 s48, s82, 0x508000
buffer_load_dwordx4 v1, s[4:7], s48 offen offset:0 lds
buffer_load_dwordx4 v1, s[4:7], s48 offen offset:1024 lds
buffer_load_dwordx4 v1, s[4:7], s48 offen offset:2048 lds
buffer_load_dwordx4 v1, s[4:7], s48 offen offset:3072 lds
s_add_u32 m0, s73, 0x20000
s_add_u32 s48, s82, 0x50c000
buffer_load_dwordx4 v1, s[4:7], s48 offen offset:0 lds
buffer_load_dwordx4 v1, s[4:7], s48 offen offset:1024 lds
buffer_load_dwordx4 v1, s[4:7], s48 offen offset:2048 lds
buffer_load_dwordx4 v1, s[4:7], s48 offen offset:3072 lds
s_add_u32 s48, s82, 0x52c000
buffer_load_dwordx4 a[32:35], v1, s[4:7], s48 offen offset:0
buffer_load_dwordx4 a[36:39], v1, s[4:7], s48 offen offset:1024
buffer_load_dwordx4 a[40:43], v1, s[4:7], s48 offen offset:2048
buffer_load_dwordx4 a[44:47], v1, s[4:7], s48 offen offset:3072
s_add_u32 s48, s82, 0x530000
buffer_load_dwordx4 a[48:51], v1, s[4:7], s48 offen offset:0
buffer_load_dwordx4 a[52:55], v1, s[4:7], s48 offen offset:1024
buffer_load_dwordx4 a[56:59], v1, s[4:7], s48 offen offset:2048
buffer_load_dwordx4 a[60:63], v1, s[4:7], s48 offen offset:3072
s_waitcnt vmcnt(24)
s_barrier
s_add_u32 m0, s73, 0x0
s_add_u32 s48, s82, 0x510000
buffer_load_dwordx4 v1, s[4:7], s48 offen offset:0 lds
buffer_load_dwordx4 v1, s[4:7], s48 offen offset:1024 lds
buffer_load_dwordx4 v1, s[4:7], s48 offen offset:2048 lds
buffer_load_dwordx4 v1, s[4:7], s48 offen offset:3072 lds
s_add_u32 m0, s73, 0x4000
s_add_u32 s48, s82, 0x514000
buffer_load_dwordx4 v1, s[4:7], s48 offen offset:0 lds
buffer_load_dwordx4 v1, s[4:7], s48 offen offset:1024 lds
buffer_load_dwordx4 v1, s[4:7], s48 offen offset:2048 lds
buffer_load_dwordx4 v1, s[4:7], s48 offen offset:3072 lds
s_add_u32 s48, s82, 0x534000
buffer_load_dwordx4 a[64:67], v1, s[4:7], s48 offen offset:0
buffer_load_dwordx4 a[68:71], v1, s[4:7], s48 offen offset:1024
buffer_load_dwordx4 a[72:75], v1, s[4:7], s48 offen offset:2048
buffer_load_dwordx4 a[76:79], v1, s[4:7], s48 offen offset:3072
s_waitcnt vmcnt(32)
s_barrier
s_lshr_b32 s48, s40, 1
s_add_u32 s48, s48, 56
v_bfe_u32 v4, v0, 2, 2
v_min_u32 v4, 2, v4
v_lshlrev_b32 v4, 3, v4
v_add_u32 v4, s48, v4
v_and_b32 v5, 3, v0
v_lshlrev_b32 v5, 7, v5
v_lshl_add_u32 v4, v4, 9, v5
s_mov_b32 s49, 0x12e6000
buffer_load_dwordx4 v[8:11], v4, s[4:7], s49 offen
s_add_u32 m0, s73, 0x8000
s_add_u32 s48, s82, 0x518000
buffer_load_dwordx4 v1, s[4:7], s48 offen offset:0 lds
buffer_load_dwordx4 v1, s[4:7], s48 offen offset:1024 lds
buffer_load_dwordx4 v1, s[4:7], s48 offen offset:2048 lds
buffer_load_dwordx4 v1, s[4:7], s48 offen offset:3072 lds
s_add_u32 m0, s73, 0xc000
s_add_u32 s48, s82, 0x51c000
buffer_load_dwordx4 v1, s[4:7], s48 offen offset:0 lds
buffer_load_dwordx4 v1, s[4:7], s48 offen offset:1024 lds
buffer_load_dwordx4 v1, s[4:7], s48 offen offset:2048 lds
buffer_load_dwordx4 v1, s[4:7], s48 offen offset:3072 lds
s_waitcnt vmcnt(33)
s_barrier
s_waitcnt vmcnt(8)
v_min3_u32 v8, v8, v9, v10
v_min_u32 v8, v8, v11
v_cmp_eq_u32 vcc, 0, v8
s_cbranch_vccz L_l_pf_39_ok
s_mov_b32 s49, 0x12e6000
L_l_pf_39:
buffer_load_dwordx4 v[8:11], v4, s[4:7], s49 offen sc1
s_add_u32 s66, s66, 1
s_waitcnt vmcnt(0)
v_min3_u32 v8, v8, v9, v10
v_min_u32 v8, v8, v11
v_cmp_eq_u32 vcc, 0, v8
s_cbranch_vccz L_l_pf_39_ok
s_sleep 12
s_cmp_lt_u32 s66, 0x800000
s_cbranch_scc1 L_l_pf_39
L_l_pf_39_ok:
s_add_u32 m0, s73, 0x10000
s_add_u32 s48, s82, 0x520000
buffer_load_dwordx4 v1, s[4:7], s48 offen offset:0 lds
buffer_load_dwordx4 v1, s[4:7], s48 offen offset:1024 lds
buffer_load_dwordx4 v1, s[4:7], s48 offen offset:2048 lds
buffer_load_dwordx4 v1, s[4:7], s48 offen offset:3072 lds
s_barrier
s_add_u32 s48, s73, 0x14000
v_add_u32 v15, s48, v1
ds_write_b128 v15, a[0:3] offset:0
ds_write_b128 v15, a[4:7] offset:1024
ds_write_b128 v15, a[8:11] offset:2048
ds_write_b128 v15, a[12:15] offset:3072
s_add_u32 s48, s73, 0x18000
v_add_u32 v15, s48, v1
ds_write_b128 v15, a[16:19] offset:0
ds_write_b128 v15, a[20:23] offset:1024
ds_write_b128 v15, a[24:27] offset:2048
ds_write_b128 v15, a[28:31] offset:3072
s_waitcnt vmcnt(8)
s_barrier
s_add_u32 s48, s73, 0x1c000
v_add_u32 v15, s48, v1
ds_write_b128 v15, a[32:35] offset:0
ds_write_b128 v15, a[36:39] offset:1024
ds_write_b128 v15, a[40:43] offset:2048
ds_write_b128 v15, a[44:47] offset:3072
s_waitcnt lgkmcnt(8)
s_add_u32 s48, s73, 0x20000
v_add_u32 v15, s48, v1
ds_write_b128 v15, a[48:51] offset:0
ds_write_b128 v15, a[52:55] offset:1024
ds_write_b128 v15, a[56:59] offset:2048
ds_write_b128 v15, a[60:63] offset:3072
s_waitcnt vmcnt(0)
s_barrier
s_waitcnt lgkmcnt(8)
s_add_u32 s48, s73, 0x0
v_add_u32 v15, s48, v1
ds_write_b128 v15, a[64:67] offset:0
ds_write_b128 v15, a[68:71] offset:1024
ds_write_b128 v15, a[72:75] offset:2048
ds_write_b128 v15, a[76:79] offset:3072
s_barrier
s_waitcnt lgkmcnt(4)
s_barrier
s_waitcnt lgkmcnt(0)
s_barrier
s_add_u32 m0, s73, 0x4000
s_add_u32 s48, s80, 0x0
buffer_load_dwordx4 v1, s[4:7], s48 offen offset:0 lds
buffer_load_dwordx4 v1, s[4:7], s48 offen offset:1024 lds
buffer_load_dwordx4 v1, s[4:7], s48 offen offset:2048 lds
buffer_load_dwordx4 v1, s[4:7], s48 offen offset:3072 lds
s_add_u32 m0, s73, 0x8000
s_add_u32 s48, s80, 0x4000
buffer_load_dwordx4 v1, s[4:7], s48 offen offset:0 lds
buffer_load_dwordx4 v1, s[4:7], s48 offen offset:1024 lds
buffer_load_dwordx4 v1, s[4:7], s48 offen offset:2048 lds
buffer_load_dwordx4 v1, s[4:7], s48 offen offset:3072 lds
s_add_u32 m0, s73, 0xc000
s_add_u32 s48, s80, 0x8000
buffer_load_dwordx4 v1, s[4:7], s48 offen offset:0 lds
buffer_load_dwordx4 v1, s[4:7], s48 offen offset:1024 lds
buffer_load_dwordx4 v1, s[4:7], s48 offen offset:2048 lds
buffer_load_dwordx4 v1, s[4:7], s48 offen offset:3072 lds
s_waitcnt vmcnt(8)
s_barrier
s_waitcnt vmcnt(4)
s_barrier
s_add_u32 m0, s73, 0x10000
s_add_u32 s48, s80, 0xc000
buffer_load_dwordx4 v1, s[4:7], s48 offen offset:0 lds
buffer_load_dwordx4 v1, s[4:7], s48 offen offset:1024 lds
buffer_load_dwordx4 v1, s[4:7], s48 offen offset:2048 lds
buffer_load_dwordx4 v1, s[4:7], s48 offen offset:3072 lds
s_waitcnt vmcnt(4)
s_barrier
s_waitcnt vmcnt(0)
s_barrier
s_lshl_b32 s48, s38, 2
s_add_u32 s48, s48, 0x26210
v_mov_b32 v3, s48
v_mov_b32 v2, 0
ds_write_b32 v3, v2
s_add_u32 s48, s73, 0x8000
v_add_u32 v15, s48, v1
ds_write_b128 v15, v[96:99] offset:0
ds_write_b128 v15, v[100:103] offset:1024
ds_write_b128 v15, v[104:107] offset:2048
ds_write_b128 v15, v[108:111] offset:3072
s_add_u32 m0, s73, 0x14000
s_add_u32 s48, s80, 0x10000
buffer_load_dwordx4 v1, s[4:7], s48 offen offset:0 lds
buffer_load_dwordx4 v1, s[4:7], s48 offen offset:1024 lds
buffer_load_dwordx4 v1, s[4:7], s48 offen offset:2048 lds
buffer_load_dwordx4 v1, s[4:7], s48 offen offset:3072 lds
s_add_u32 m0, s73, 0x18000
s_add_u32 s48, s80, 0x14000
buffer_load_dwordx4 v1, s[4:7], s48 offen offset:0 lds
buffer_load_dwordx4 v1, s[4:7], s48 offen offset:1024 lds
buffer_load_dwordx4 v1, s[4:7], s48 offen offset:2048 lds
buffer_load_dwordx4 v1, s[4:7], s48 offen offset:3072 lds
s_waitcnt lgkmcnt(4)
s_barrier
s_add_u32 s48, s73, 0xc000
v_add_u32 v15, s48, v1
ds_write_b128 v15, v[48:51] offset:0
ds_write_b128 v15, v[52:55] offset:1024
ds_write_b128 v15, v[56:59] offset:2048
ds_write_b128 v15, v[60:63] offset:3072
s_waitcnt vmcnt(0)
v_mov_b32 v2, 1
ds_write_b32 v3, v2
s_add_u32 m0, s73, 0x1c000
s_add_u32 s48, s83, 0x6c0000
buffer_load_dwordx4 v1, s[4:7], s48 offen offset:0 lds
buffer_load_dwordx4 v1, s[4:7], s48 offen offset:1024 lds
buffer_load_dwordx4 v1, s[4:7], s48 offen offset:2048 lds
buffer_load_dwordx4 v1, s[4:7], s48 offen offset:3072 lds
s_add_u32 m0, s73, 0x20000
s_add_u32 s48, s83, 0x6c4000
buffer_load_dwordx4 v1, s[4:7], s48 offen offset:0 lds
buffer_load_dwordx4 v1, s[4:7], s48 offen offset:1024 lds
buffer_load_dwordx4 v1, s[4:7], s48 offen offset:2048 lds
buffer_load_dwordx4 v1, s[4:7], s48 offen offset:3072 lds
s_add_u32 m0, s73, 0x0
s_add_u32 s48, s83, 0x6c8000
buffer_load_dwordx4 v1, s[4:7], s48 offen offset:0 lds
buffer_load_dwordx4 v1, s[4:7], s48 offen offset:1024 lds
buffer_load_dwordx4 v1, s[4:7], s48 offen offset:2048 lds
buffer_load_dwordx4 v1, s[4:7], s48 offen offset:3072 lds
v_mov_b32 v5, 0x26200
L_l_pa_40:
ds_read_b128 v[8:11], v5
s_add_u32 s66, s66, 1
s_waitcnt lgkmcnt(0)
v_min3_u32 v8, v8, v9, v10
v_min_u32 v8, v8, v11
v_cmp_gt_u32 vcc, 1, v8
s_cbranch_vccz L_l_pa_40_ok
s_sleep 2
s_cmp_lt_u32 s66, 0x800000
s_cbranch_scc1 L_l_pa_40
L_l_pa_40_ok:
s_add_u32 s48, s73, 0x10000
v_add_u32 v15, s48, v1
ds_write_b128 v15, v[32:35] offset:0
ds_write_b128 v15, v[36:39] offset:1024
ds_write_b128 v15, v[40:43] offset:2048
ds_write_b128 v15, v[44:47] offset:3072
s_add_u32 m0, s73, 0x4000
s_add_u32 s48, s83, 0x6cc000
buffer_load_dwordx4 v1, s[4:7], s48 offen offset:0 lds
buffer_load_dwordx4 v1, s[4:7], s48 offen offset:1024 lds
buffer_load_dwordx4 v1, s[4:7], s48 offen offset:2048 lds
buffer_load_dwordx4 v1, s[4:7], s48 offen offset:3072 lds
s_add_u32 s48, s81, 0x1a4000
buffer_load_dwordx4 a[0:3], v1, s[4:7], s48 offen offset:0
buffer_load_dwordx4 a[4:7], v1, s[4:7], s48 offen offset:1024
buffer_load_dwordx4 a[8:11], v1, s[4:7], s48 offen offset:2048
buffer_load_dwordx4 a[12:15], v1, s[4:7], s48 offen offset:3072
s_waitcnt vmcnt(4)
v_mov_b32 v2, 2
ds_write_b32 v3, v2
v_mov_b32 v5, 0x26200
L_l_pa_41:
ds_read_b128 v[8:11], v5
s_add_u32 s66, s66, 1
s_waitcnt lgkmcnt(0)
v_min3_u32 v8, v8, v9, v10
v_min_u32 v8, v8, v11
v_cmp_gt_u32 vcc, 2, v8
s_cbranch_vccz L_l_pa_41_ok
s_sleep 2
s_cmp_lt_u32 s66, 0x800000
s_cbranch_scc1 L_l_pa_41
L_l_pa_41_ok:
s_add_u32 s48, s73, 0x14000
v_add_u32 v15, s48, v1
ds_write_b128 v15, v[80:83] offset:0
ds_write_b128 v15, v[84:87] offset:1024
ds_write_b128 v15, v[88:91] offset:2048
ds_write_b128 v15, v[92:95] offset:3072
s_add_u32 s48, s73, 0x18000
v_add_u32 v15, s48, v1
ds_write_b128 v15, v[64:67] offset:0
ds_write_b128 v15, v[68:71] offset:1024
ds_write_b128 v15, v[72:75] offset:2048
ds_write_b128 v15, v[76:79] offset:3072
s_barrier
s_add_u32 s48, s73, 0x1c000
v_add_u32 v15, s48, v1
ds_write_b128 v15, v[112:115] offset:0
ds_write_b128 v15, v[116:119] offset:1024
ds_write_b128 v15, v[120:123] offset:2048
ds_write_b128 v15, v[124:127] offset:3072
s_add_u32 s48, s81, 0x1a8000
buffer_load_dwordx4 a[16:19], v1, s[4:7], s48 offen offset:0
buffer_load_dwordx4 a[20:23], v1, s[4:7], s48 offen offset:1024
buffer_load_dwordx4 a[24:27], v1, s[4:7], s48 offen offset:2048
buffer_load_dwordx4 a[28:31], v1, s[4:7], s48 offen offset:3072
s_add_u32 s48, s81, 0x1ac000
buffer_load_dwordx4 a[32:35], v1, s[4:7], s48 offen offset:0
buffer_load_dwordx4 a[36:39], v1, s[4:7], s48 offen offset:1024
buffer_load_dwordx4 a[40:43], v1, s[4:7], s48 offen offset:2048
buffer_load_dwordx4 a[44:47], v1, s[4:7], s48 offen offset:3072
s_barrier
s_waitcnt lgkmcnt(8)
s_add_u32 s48, s73, 0x20000
v_add_u32 v15, s48, v1
ds_write_b128 v15, v[16:19] offset:0
ds_write_b128 v15, v[20:23] offset:1024
ds_write_b128 v15, v[24:27] offset:2048
ds_write_b128 v15, v[28:31] offset:3072
s_waitcnt lgkmcnt(8)
s_add_u32 s48, s73, 0x0
v_add_u32 v15, s48, v1
ds_write_b128 v15, a[112:115] offset:0
ds_write_b128 v15, a[116:119] offset:1024
ds_write_b128 v15, a[120:123] offset:2048
ds_write_b128 v15, a[124:127] offset:3072
s_barrier
s_waitcnt lgkmcnt(8)
s_add_u32 s48, s73, 0x4000
v_add_u32 v15, s48, v1
ds_write_b128 v15, a[96:99] offset:0
ds_write_b128 v15, a[100:103] offset:1024
ds_write_b128 v15, a[104:107] offset:2048
ds_write_b128 v15, a[108:111] offset:3072
s_barrier
s_waitcnt lgkmcnt(8)
s_waitcnt vmcnt(8)
s_add_u32 s48, s73, 0x8000
v_add_u32 v15, s48, v1
ds_write_b128 v15, a[0:3] offset:0
ds_write_b128 v15, a[4:7] offset:1024
ds_write_b128 v15, a[8:11] offset:2048
ds_write_b128 v15, a[12:15] offset:3072
s_barrier
s_waitcnt lgkmcnt(8)
s_waitcnt vmcnt(4)
s_add_u32 s48, s73, 0xc000
v_add_u32 v15, s48, v1
ds_write_b128 v15, a[16:19] offset:0
ds_write_b128 v15, a[20:23] offset:1024
ds_write_b128 v15, a[24:27] offset:2048
ds_write_b128 v15, a[28:31] offset:3072
s_waitcnt lgkmcnt(4)
s_add_u32 s48, s81, 0x1b0000
buffer_load_dwordx4 a[0:3], v1, s[4:7], s48 offen offset:0
buffer_load_dwordx4 a[4:7], v1, s[4:7], s48 offen offset:1024
buffer_load_dwordx4 a[8:11], v1, s[4:7], s48 offen offset:2048
buffer_load_dwordx4 a[12:15], v1, s[4:7], s48 offen offset:3072
s_waitcnt lgkmcnt(0)
s_add_u32 s48, s81, 0x1b4000
buffer_load_dwordx4 a[16:19], v1, s[4:7], s48 offen offset:0
buffer_load_dwordx4 a[20:23], v1, s[4:7], s48 offen offset:1024
buffer_load_dwordx4 a[24:27], v1, s[4:7], s48 offen offset:2048
buffer_load_dwordx4 a[28:31], v1, s[4:7], s48 offen offset:3072
s_barrier
s_waitcnt vmcnt(8)
s_add_u32 s48, s73, 0x10000
v_add_u32 v15, s48, v1
ds_write_b128 v15, a[32:35] offset:0
ds_write_b128 v15, a[36:39] offset:1024
ds_write_b128 v15, a[40:43] offset:2048
ds_write_b128 v15, a[44:47] offset:3072
s_waitcnt lgkmcnt(0)
s_add_u32 s48, s82, 0x524000
buffer_load_dwordx4 a[32:35], v1, s[4:7], s48 offen offset:0
buffer_load_dwordx4 a[36:39], v1, s[4:7], s48 offen offset:1024
buffer_load_dwordx4 a[40:43], v1, s[4:7], s48 offen offset:2048
buffer_load_dwordx4 a[44:47], v1, s[4:7], s48 offen offset:3072
s_add_u32 s48, s82, 0x528000
buffer_load_dwordx4 a[48:51], v1, s[4:7], s48 offen offset:0
buffer_load_dwordx4 a[52:55], v1, s[4:7], s48 offen offset:1024
buffer_load_dwordx4 a[56:59], v1, s[4:7], s48 offen offset:2048
buffer_load_dwordx4 a[60:63], v1, s[4:7], s48 offen offset:3072
s_add_u32 s48, s82, 0x52c000
buffer_load_dwordx4 a[64:67], v1, s[4:7], s48 offen offset:0
buffer_load_dwordx4 a[68:71], v1, s[4:7], s48 offen offset:1024
buffer_load_dwordx4 a[72:75], v1, s[4:7], s48 offen offset:2048
buffer_load_dwordx4 a[76:79], v1, s[4:7], s48 offen offset:3072
s_barrier
s_waitcnt vmcnt(16)
s_add_u32 s48, s73, 0x14000
v_add_u32 v15, s48, v1
ds_write_b128 v15, a[0:3] offset:0
ds_write_b128 v15, a[4:7] offset:1024
ds_write_b128 v15, a[8:11] offset:2048
ds_write_b128 v15, a[12:15] offset:3072
s_waitcnt vmcnt(12)
s_add_u32 s48, s73, 0x18000
v_add_u32 v15, s48, v1
ds_write_b128 v15, a[16:19] offset:0
ds_write_b128 v15, a[20:23] offset:1024
ds_write_b128 v15, a[24:27] offset:2048
ds_write_b128 v15, a[28:31] offset:3072
s_waitcnt lgkmcnt(4)
s_add_u32 s48, s82, 0x530000
buffer_load_dwordx4 a[0:3], v1, s[4:7], s48 offen offset:0
buffer_load_dwordx4 a[4:7], v1, s[4:7], s48 offen offset:1024
buffer_load_dwordx4 a[8:11], v1, s[4:7], s48 offen offset:2048
buffer_load_dwordx4 a[12:15], v1, s[4:7], s48 offen offset:3072
s_waitcnt lgkmcnt(0)
s_add_u32 s48, s82, 0x534000
buffer_load_dwordx4 a[16:19], v1, s[4:7], s48 offen offset:0
buffer_load_dwordx4 a[20:23], v1, s[4:7], s48 offen offset:1024
buffer_load_dwordx4 a[24:27], v1, s[4:7], s48 offen offset:2048
buffer_load_dwordx4 a[28:31], v1, s[4:7], s48 offen offset:3072
s_add_u32 s48, s82, 0x520000
buffer_load_dwordx4 a[80:83], v1, s[4:7], s48 offen offset:0
buffer_load_dwordx4 a[84:87], v1, s[4:7], s48 offen offset:1024
buffer_load_dwordx4 a[88:91], v1, s[4:7], s48 offen offset:2048
buffer_load_dwordx4 a[92:95], v1, s[4:7], s48 offen offset:3072
s_barrier
s_add_u32 m0, s73, 0x1c000
s_add_u32 s48, s82, 0x500000
buffer_load_dwordx4 v1, s[4:7], s48 offen offset:0 lds
buffer_load_dwordx4 v1, s[4:7], s48 offen offset:1024 lds
buffer_load_dwordx4 v1, s[4:7], s48 offen offset:2048 lds
buffer_load_dwordx4 v1, s[4:7], s48 offen offset:3072 lds
s_add_u32 m0, s73, 0x20000
s_add_u32 s48, s82, 0x504000
buffer_load_dwordx4 v1, s[4:7], s48 offen offset:0 lds
buffer_load_dwordx4 v1, s[4:7], s48 offen offset:1024 lds
buffer_load_dwordx4 v1, s[4:7], s48 offen offset:2048 lds
buffer_load_dwordx4 v1, s[4:7], s48 offen offset:3072 lds
s_add_u32 s48, s82, 0x51c000
buffer_load_dwordx4 a[96:99], v1, s[4:7], s48 offen offset:0
buffer_load_dwordx4 a[100:103], v1, s[4:7], s48 offen offset:1024
buffer_load_dwordx4 a[104:107], v1, s[4:7], s48 offen offset:2048
buffer_load_dwordx4 a[108:111], v1, s[4:7], s48 offen offset:3072
s_barrier
s_add_u32 m0, s73, 0x0
s_add_u32 s48, s82, 0x508000
buffer_load_dwordx4 v1, s[4:7], s48 offen offset:0 lds
buffer_load_dwordx4 v1, s[4:7], s48 offen offset:1024 lds
buffer_load_dwordx4 v1, s[4:7], s48 offen offset:2048 lds
buffer_load_dwordx4 v1, s[4:7], s48 offen offset:3072 lds
s_add_u32 m0, s73, 0x4000
s_add_u32 s48, s82, 0x50c000
buffer_load_dwordx4 v1, s[4:7], s48 offen offset:0 lds
buffer_load_dwordx4 v1, s[4:7], s48 offen offset:1024 lds
buffer_load_dwordx4 v1, s[4:7], s48 offen offset:2048 lds
buffer_load_dwordx4 v1, s[4:7], s48 offen offset:3072 lds
s_add_u32 s48, s82, 0x518000
buffer_load_dwordx4 a[112:115], v1, s[4:7], s48 offen offset:0
buffer_load_dwordx4 a[116:119], v1, s[4:7], s48 offen offset:1024
buffer_load_dwordx4 a[120:123], v1, s[4:7], s48 offen offset:2048
buffer_load_dwordx4 a[124:127], v1, s[4:7], s48 offen offset:3072
s_barrier
s_add_u32 m0, s73, 0x8000
s_add_u32 s48, s82, 0x510000
buffer_load_dwordx4 v1, s[4:7], s48 offen offset:0 lds
buffer_load_dwordx4 v1, s[4:7], s48 offen offset:1024 lds
buffer_load_dwordx4 v1, s[4:7], s48 offen offset:2048 lds
buffer_load_dwordx4 v1, s[4:7], s48 offen offset:3072 lds
s_add_u32 m0, s73, 0xc000
s_add_u32 s48, s82, 0x514000
buffer_load_dwordx4 v1, s[4:7], s48 offen offset:0 lds
buffer_load_dwordx4 v1, s[4:7], s48 offen offset:1024 lds
buffer_load_dwordx4 v1, s[4:7], s48 offen offset:2048 lds
buffer_load_dwordx4 v1, s[4:7], s48 offen offset:3072 lds
s_waitcnt vmcnt(28)
s_barrier
s_waitcnt vmcnt(8)
s_add_u32 s48, s73, 0x10000
v_add_u32 v15, s48, v1
ds_write_b128 v15, a[112:115] offset:0
ds_write_b128 v15, a[116:119] offset:1024
ds_write_b128 v15, a[120:123] offset:2048
ds_write_b128 v15, a[124:127] offset:3072
s_add_u32 s48, s73, 0x14000
v_add_u32 v15, s48, v1
ds_write_b128 v15, a[96:99] offset:0
ds_write_b128 v15, a[100:103] offset:1024
ds_write_b128 v15, a[104:107] offset:2048
ds_write_b128 v15, a[108:111] offset:3072
s_barrier
s_add_u32 s48, s73, 0x18000
v_add_u32 v15, s48, v1
ds_write_b128 v15, a[80:83] offset:0
ds_write_b128 v15, a[84:87] offset:1024
ds_write_b128 v15, a[88:91] offset:2048
ds_write_b128 v15, a[92:95] offset:3072
s_waitcnt vmcnt(4)
s_barrier
s_waitcnt lgkmcnt(8)
s_add_u32 s48, s73, 0x1c000
v_add_u32 v15, s48, v1
ds_write_b128 v15, a[32:35] offset:0
ds_write_b128 v15, a[36:39] offset:1024
ds_write_b128 v15, a[40:43] offset:2048
ds_write_b128 v15, a[44:47] offset:3072
s_waitcnt lgkmcnt(8)
s_add_u32 s48, s73, 0x20000
v_add_u32 v15, s48, v1
ds_write_b128 v15, a[48:51] offset:0
ds_write_b128 v15, a[52:55] offset:1024
ds_write_b128 v15, a[56:59] offset:2048
ds_write_b128 v15, a[60:63] offset:3072
s_waitcnt vmcnt(0)
s_barrier
s_waitcnt lgkmcnt(8)
s_add_u32 s48, s73, 0x0
v_add_u32 v15, s48, v1
ds_write_b128 v15, a[64:67] offset:0
ds_write_b128 v15, a[68:71] offset:1024
ds_write_b128 v15, a[72:75] offset:2048
ds_write_b128 v15, a[76:79] offset:3072
s_waitcnt lgkmcnt(8)
s_add_u32 s48, s73, 0x4000
v_add_u32 v15, s48, v1
ds_write_b128 v15, a[0:3] offset:0
ds_write_b128 v15, a[4:7] offset:1024
ds_write_b128 v15, a[8:11] offset:2048
ds_write_b128 v15, a[12:15] offset:3072
s_barrier
s_waitcnt lgkmcnt(8)
s_add_u32 s48, s73, 0x8000
v_add_u32 v15, s48, v1
ds_write_b128 v15, a[16:19] offset:0
ds_write_b128 v15, a[20:23] offset:1024
ds_write_b128 v15, a[24:27] offset:2048
ds_write_b128 v15, a[28:31] offset:3072
s_barrier
s_waitcnt lgkmcnt(4)
s_barrier
s_waitcnt lgkmcnt(0)
s_barrier
s_barrier
s_endpgm
L_cons2:
s_barrier
s_cmp_lg_u32 s67, 0
s_cbranch_scc1 L_c_rs_5
v_add_u32 v118, 0x0, v118
v_add_u32 v119, 0x0, v119
ds_read_b64 v[8:9], v118 offset:0
ds_read_b64 v[10:11], v119 offset:0
ds_read_b64 v[12:13], v118 offset:2048
ds_read_b64 v[14:15], v119 offset:2048
s_waitcnt lgkmcnt(0)
L_c_rs_5:
ds_read_b128 a[0:3], v100 offset:0
ds_read_b128 a[4:7], v100 offset:2048
ds_read_b128 a[8:11], v101 offset:0
ds_read_b128 a[12:15], v101 offset:2048
ds_read_b64_tr_b16 v[16:17], v104 offset:16384
ds_read_b64_tr_b16 v[18:19], v104 offset:16896
ds_read_b64_tr_b16 v[20:21], v105 offset:16384
ds_read_b64_tr_b16 v[22:23], v105 offset:16896
ds_read_b64_tr_b16 v[24:25], v106 offset:16384
ds_read_b64_tr_b16 v[26:27], v106 offset:16896
s_waitcnt lgkmcnt(8)
s_waitcnt lgkmcnt(4)
v_mfma_f32_16x16x32_bf16 v[32:35], a[0:3], v[16:19], 0
ds_read_b64_tr_b16 v[28:29], v107 offset:16384
v_mfma_f32_16x16x32_bf16 v[36:39], a[4:7], v[16:19], 0
ds_read_b64_tr_b16 v[30:31], v107 offset:16896
v_mfma_f32_16x16x32_bf16 v[80:83], a[0:3], v[96:99], 0
ds_read_b64_tr_b16 v[68:69], v72 offset:16384
ds_read_b64_tr_b16 v[70:71], v72 offset:16896
s_waitcnt lgkmcnt(6)
v_mfma_f32_16x16x32_bf16 v[44:47], a[4:7], v[20:23], 0
ds_read_b64_tr_b16 v[16:17], v104 offset:20480
v_mfma_f32_16x16x32_bf16 v[40:43], a[0:3], v[20:23], 0
ds_read_b64_tr_b16 v[18:19], v104 offset:20992
v_mfma_f32_16x16x32_bf16 v[84:87], a[4:7], v[96:99], 0
s_waitcnt lgkmcnt(6)
v_mfma_f32_16x16x32_bf16 v[48:51], a[0:3], v[24:27], 0
ds_read_b64_tr_b16 v[20:21], v105 offset:20480
v_mfma_f32_16x16x32_bf16 v[52:55], a[4:7], v[24:27], 0
ds_read_b64_tr_b16 v[22:23], v105 offset:20992
v_mfma_f32_16x16x32_bf16 v[88:91], a[0:3], a[0:3], 0
s_waitcnt lgkmcnt(6)
v_mfma_f32_16x16x32_bf16 v[60:63], a[4:7], v[28:31], 0
ds_read_b64_tr_b16 v[24:25], v106 offset:20480
v_mfma_f32_16x16x32_bf16 v[56:59], a[0:3], v[28:31], 0
ds_read_b64_tr_b16 v[26:27], v106 offset:20992
v_mfma_f32_16x16x32_bf16 v[92:95], a[4:7], a[4:7], 0
s_waitcnt lgkmcnt(6)
v_mfma_f32_16x16x32_bf16 v[64:67], v[96:99], v[68:71], 0
s_barrier
s_lshl_b32 s48, s37, 2
s_add_u32 s48, s48, s38
s_mul_i32 s48, s48, 12288
v_lshrrev_b32 v122, 3, v0
v_mul_u32_u24 v122, 3072, v122
v_and_b32 v123, 7, v0
v_lshl_add_u32 v122, v123, 7, v122
s_bfm_b64 exec, 32, 0
buffer_load_dword v6, v122, s[24:27], s48 offen
s_mov_b64 exec, -1
s_cmp_lg_u32 s67, 1
s_cbranch_scc1 L_c_rs_6
v_add_u32 v118, 0x8000, v118
v_add_u32 v119, 0x8000, v119
ds_read_b64 v[8:9], v118 offset:0
ds_read_b64 v[10:11], v119 offset:0
ds_read_b64 v[12:13], v118 offset:2048
ds_read_b64 v[14:15], v119 offset:2048
s_waitcnt lgkmcnt(0)
L_c_rs_6:
ds_read_b128 a[16:19], v100 offset:32768
ds_read_b128 a[20:23], v100 offset:34816
ds_read_b128 a[24:27], v101 offset:32768
ds_read_b128 a[28:31], v101 offset:34816
s_waitcnt lgkmcnt(8)
v_mfma_f32_16x16x32_bf16 v[32:35], a[8:11], v[16:19], v[32:35]
ds_read_b64_tr_b16 v[28:29], v107 offset:20480
v_mfma_f32_16x16x32_bf16 v[36:39], a[12:15], v[16:19], v[36:39]
ds_read_b64_tr_b16 v[30:31], v107 offset:20992
v_mfma_f32_16x16x32_bf16 v[80:83], a[8:11], v[96:99], v[80:83]
ds_read_b64_tr_b16 v[68:69], v72 offset:20480
ds_read_b64_tr_b16 v[70:71], v72 offset:20992
s_waitcnt lgkmcnt(10)
v_mfma_f32_16x16x32_bf16 v[44:47], a[12:15], v[20:23], v[44:47]
ds_read_b64_tr_b16 v[16:17], v104 offset:24576
v_mfma_f32_16x16x32_bf16 v[40:43], a[8:11], v[20:23], v[40:43]
ds_read_b64_tr_b16 v[18:19], v104 offset:25088
v_mfma_f32_16x16x32_bf16 v[84:87], a[12:15], v[96:99], v[84:87]
s_waitcnt lgkmcnt(10)
v_mfma_f32_16x16x32_bf16 v[48:51], a[8:11], v[24:27], v[48:51]
ds_read_b64_tr_b16 v[20:21], v105 offset:24576
v_mfma_f32_16x16x32_bf16 v[52:55], a[12:15], v[24:27], v[52:55]
ds_read_b64_tr_b16 v[22:23], v105 offset:25088
v_mfma_f32_16x16x32_bf16 v[88:91], a[8:11], a[8:11], v[88:91]
s_waitcnt lgkmcnt(6)
v_mfma_f32_16x16x32_bf16 v[60:63], a[12:15], v[28:31], v[60:63]
ds_read_b64_tr_b16 v[24:25], v106 offset:24576
v_mfma_f32_16x16x32_bf16 v[56:59], a[8:11], v[28:31], v[56:59]
ds_read_b64_tr_b16 v[26:27], v106 offset:25088
v_mfma_f32_16x16x32_bf16 v[92:95], a[12:15], a[12:15], v[92:95]
s_waitcnt lgkmcnt(6)
v_mfma_f32_16x16x32_bf16 v[64:67], v[96:99], v[68:71], v[64:67]
s_waitcnt lgkmcnt(4)
v_mfma_f32_16x16x32_bf16 v[32:35], a[16:19], v[16:19], v[32:35]
ds_read_b64_tr_b16 v[28:29], v107 offset:24576
v_mfma_f32_16x16x32_bf16 v[36:39], a[20:23], v[16:19], v[36:39]
ds_read_b64_tr_b16 v[30:31], v107 offset:25088
v_mfma_f32_16x16x32_bf16 v[80:83], a[16:19], v[96:99], v[80:83]
ds_read_b64_tr_b16 v[68:69], v72 offset:24576
ds_read_b64_tr_b16 v[70:71], v72 offset:25088
s_waitcnt lgkmcnt(6)
v_mfma_f32_16x16x32_bf16 v[44:47], a[20:23], v[20:23], v[44:47]
ds_read_b64_tr_b16 v[16:17], v104 offset:28672
v_mfma_f32_16x16x32_bf16 v[40:43], a[16:19], v[20:23], v[40:43]
ds_read_b64_tr_b16 v[18:19], v104 offset:29184
v_mfma_f32_16x16x32_bf16 v[84:87], a[20:23], v[96:99], v[84:87]
s_waitcnt lgkmcnt(6)
v_mfma_f32_16x16x32_bf16 v[48:51], a[16:19], v[24:27], v[48:51]
ds_read_b64_tr_b16 v[20:21], v105 offset:28672
v_mfma_f32_16x16x32_bf16 v[52:55], a[20:23], v[24:27], v[52:55]
ds_read_b64_tr_b16 v[22:23], v105 offset:29184
v_mfma_f32_16x16x32_bf16 v[88:91], a[16:19], a[16:19], v[88:91]
s_waitcnt lgkmcnt(6)
v_mfma_f32_16x16x32_bf16 v[60:63], a[20:23], v[28:31], v[60:63]
ds_read_b64_tr_b16 v[24:25], v106 offset:28672
v_mfma_f32_16x16x32_bf16 v[56:59], a[16:19], v[28:31], v[56:59]
ds_read_b64_tr_b16 v[26:27], v106 offset:29184
v_mfma_f32_16x16x32_bf16 v[92:95], a[20:23], a[20:23], v[92:95]
s_waitcnt lgkmcnt(6)
v_mfma_f32_16x16x32_bf16 v[64:67], v[96:99], v[68:71], v[64:67]
s_barrier
s_cmp_lg_u32 s67, 2
s_cbranch_scc1 L_c_rs_7
v_add_u32 v118, 0xc000, v118
v_add_u32 v119, 0xc000, v119
ds_read_b64 v[8:9], v118 offset:0
ds_read_b64 v[10:11], v119 offset:0
ds_read_b64 v[12:13], v118 offset:2048
ds_read_b64 v[14:15], v119 offset:2048
s_waitcnt lgkmcnt(0)
L_c_rs_7:
ds_read_b128 a[32:35], v100 offset:49152
ds_read_b128 a[36:39], v100 offset:51200
ds_read_b128 a[40:43], v101 offset:49152
ds_read_b128 a[44:47], v101 offset:51200
s_waitcnt lgkmcnt(8)
v_mfma_f32_16x16x32_bf16 v[32:35], a[24:27], v[16:19], v[32:35]
ds_read_b64_tr_b16 v[28:29], v107 offset:28672
v_mfma_f32_16x16x32_bf16 v[36:39], a[28:31], v[16:19], v[36:39]
ds_read_b64_tr_b16 v[30:31], v107 offset:29184
v_mfma_f32_16x16x32_bf16 v[80:83], a[24:27], v[96:99], v[80:83]
ds_read_b64_tr_b16 v[68:69], v72 offset:28672
ds_read_b64_tr_b16 v[70:71], v72 offset:29184
s_waitcnt lgkmcnt(10)
v_mfma_f32_16x16x32_bf16 v[44:47], a[28:31], v[20:23], v[44:47]
ds_read_b64_tr_b16 v[16:17], v108 offset:0
v_mfma_f32_16x16x32_bf16 v[40:43], a[24:27], v[20:23], v[40:43]
ds_read_b64_tr_b16 v[18:19], v108 offset:512
v_mfma_f32_16x16x32_bf16 v[84:87], a[28:31], v[96:99], v[84:87]
s_waitcnt lgkmcnt(10)
v_mfma_f32_16x16x32_bf16 v[48:51], a[24:27], v[24:27], v[48:51]
ds_read_b64_tr_b16 v[20:21], v109 offset:0
v_mfma_f32_16x16x32_bf16 v[52:55], a[28:31], v[24:27], v[52:55]
ds_read_b64_tr_b16 v[22:23], v109 offset:512
v_mfma_f32_16x16x32_bf16 v[88:91], a[24:27], a[24:27], v[88:91]
s_waitcnt lgkmcnt(6)
v_mfma_f32_16x16x32_bf16 v[60:63], a[28:31], v[28:31], v[60:63]
ds_read_b64_tr_b16 v[24:25], v110 offset:0
v_mfma_f32_16x16x32_bf16 v[56:59], a[24:27], v[28:31], v[56:59]
ds_read_b64_tr_b16 v[26:27], v110 offset:512
v_mfma_f32_16x16x32_bf16 v[92:95], a[28:31], a[28:31], v[92:95]
s_waitcnt lgkmcnt(6)
v_mfma_f32_16x16x32_bf16 v[64:67], v[96:99], v[68:71], v[64:67]
s_waitcnt lgkmcnt(4)
v_mfma_f32_16x16x32_bf16 v[32:35], a[32:35], v[16:19], v[32:35]
ds_read_b64_tr_b16 v[28:29], v111 offset:0
v_mfma_f32_16x16x32_bf16 v[36:39], a[36:39], v[16:19], v[36:39]
ds_read_b64_tr_b16 v[30:31], v111 offset:512
v_mfma_f32_16x16x32_bf16 v[80:83], a[32:35], v[96:99], v[80:83]
ds_read_b64_tr_b16 v[68:69], v73 offset:0
ds_read_b64_tr_b16 v[70:71], v73 offset:512
s_waitcnt lgkmcnt(6)
v_mfma_f32_16x16x32_bf16 v[44:47], a[36:39], v[20:23], v[44:47]
ds_read_b64_tr_b16 v[16:17], v108 offset:4096
v_mfma_f32_16x16x32_bf16 v[40:43], a[32:35], v[20:23], v[40:43]
ds_read_b64_tr_b16 v[18:19], v108 offset:4608
v_mfma_f32_16x16x32_bf16 v[84:87], a[36:39], v[96:99], v[84:87]
s_waitcnt lgkmcnt(6)
v_mfma_f32_16x16x32_bf16 v[48:51], a[32:35], v[24:27], v[48:51]
ds_read_b64_tr_b16 v[20:21], v109 offset:4096
v_mfma_f32_16x16x32_bf16 v[52:55], a[36:39], v[24:27], v[52:55]
ds_read_b64_tr_b16 v[22:23], v109 offset:4608
v_mfma_f32_16x16x32_bf16 v[88:91], a[32:35], a[32:35], v[88:91]
s_waitcnt lgkmcnt(6)
v_mfma_f32_16x16x32_bf16 v[60:63], a[36:39], v[28:31], v[60:63]
ds_read_b64_tr_b16 v[24:25], v110 offset:4096
v_mfma_f32_16x16x32_bf16 v[56:59], a[32:35], v[28:31], v[56:59]
ds_read_b64_tr_b16 v[26:27], v110 offset:4608
v_mfma_f32_16x16x32_bf16 v[92:95], a[36:39], a[36:39], v[92:95]
s_waitcnt lgkmcnt(6)
v_mfma_f32_16x16x32_bf16 v[64:67], v[96:99], v[68:71], v[64:67]
s_barrier
s_cmp_lg_u32 s67, 3
s_cbranch_scc1 L_c_rs_8
v_add_u32 v118, 0x14000, v118
v_add_u32 v119, 0x14000, v119
ds_read_b64 v[8:9], v118 offset:0
ds_read_b64 v[10:11], v119 offset:0
ds_read_b64 v[12:13], v118 offset:2048
ds_read_b64 v[14:15], v119 offset:2048
s_waitcnt lgkmcnt(0)
L_c_rs_8:
v_add_u32 v102, 0x10000, v100
v_add_u32 v103, 0x10000, v101
ds_read_b128 a[48:51], v102 offset:16384
ds_read_b128 a[52:55], v102 offset:18432
ds_read_b128 a[56:59], v103 offset:16384
ds_read_b128 a[60:63], v103 offset:18432
s_waitcnt lgkmcnt(8)
v_mfma_f32_16x16x32_bf16 v[32:35], a[40:43], v[16:19], v[32:35]
ds_read_b64_tr_b16 v[28:29], v111 offset:4096
v_mfma_f32_16x16x32_bf16 v[36:39], a[44:47], v[16:19], v[36:39]
ds_read_b64_tr_b16 v[30:31], v111 offset:4608
v_mfma_f32_16x16x32_bf16 v[80:83], a[40:43], v[96:99], v[80:83]
ds_read_b64_tr_b16 v[68:69], v73 offset:4096
ds_read_b64_tr_b16 v[70:71], v73 offset:4608
s_waitcnt lgkmcnt(10)
v_mfma_f32_16x16x32_bf16 v[44:47], a[44:47], v[20:23], v[44:47]
ds_read_b64_tr_b16 v[16:17], v108 offset:8192
v_mfma_f32_16x16x32_bf16 v[40:43], a[40:43], v[20:23], v[40:43]
ds_read_b64_tr_b16 v[18:19], v108 offset:8704
v_mfma_f32_16x16x32_bf16 v[84:87], a[44:47], v[96:99], v[84:87]
s_waitcnt lgkmcnt(10)
v_mfma_f32_16x16x32_bf16 v[48:51], a[40:43], v[24:27], v[48:51]
ds_read_b64_tr_b16 v[20:21], v109 offset:8192
v_mfma_f32_16x16x32_bf16 v[52:55], a[44:47], v[24:27], v[52:55]
ds_read_b64_tr_b16 v[22:23], v109 offset:8704
v_mfma_f32_16x16x32_bf16 v[88:91], a[40:43], a[40:43], v[88:91]
s_waitcnt lgkmcnt(6)
v_mfma_f32_16x16x32_bf16 v[60:63], a[44:47], v[28:31], v[60:63]
ds_read_b64_tr_b16 v[24:25], v110 offset:8192
v_mfma_f32_16x16x32_bf16 v[56:59], a[40:43], v[28:31], v[56:59]
ds_read_b64_tr_b16 v[26:27], v110 offset:8704
v_mfma_f32_16x16x32_bf16 v[92:95], a[44:47], a[44:47], v[92:95]
s_waitcnt lgkmcnt(6)
v_mfma_f32_16x16x32_bf16 v[64:67], v[96:99], v[68:71], v[64:67]
s_waitcnt lgkmcnt(4)
v_mfma_f32_16x16x32_bf16 v[32:35], a[48:51], v[16:19], v[32:35]
ds_read_b64_tr_b16 v[28:29], v111 offset:8192
v_mfma_f32_16x16x32_bf16 v[36:39], a[52:55], v[16:19], v[36:39]
ds_read_b64_tr_b16 v[30:31], v111 offset:8704
v_mfma_f32_16x16x32_bf16 v[80:83], a[48:51], v[96:99], v[80:83]
ds_read_b64_tr_b16 v[68:69], v73 offset:8192
ds_read_b64_tr_b16 v[70:71], v73 offset:8704
s_waitcnt lgkmcnt(6)
v_mfma_f32_16x16x32_bf16 v[44:47], a[52:55], v[20:23], v[44:47]
ds_read_b64_tr_b16 v[16:17], v108 offset:12288
v_mfma_f32_16x16x32_bf16 v[40:43], a[48:51], v[20:23], v[40:43]
ds_read_b64_tr_b16 v[18:19], v108 offset:12800
v_mfma_f32_16x16x32_bf16 v[84:87], a[52:55], v[96:99], v[84:87]
s_waitcnt lgkmcnt(6)
v_mfma_f32_16x16x32_bf16 v[48:51], a[48:51], v[24:27], v[48:51]
ds_read_b64_tr_b16 v[20:21], v109 offset:12288
v_mfma_f32_16x16x32_bf16 v[52:55], a[52:55], v[24:27], v[52:55]
ds_read_b64_tr_b16 v[22:23], v109 offset:12800
v_mfma_f32_16x16x32_bf16 v[88:91], a[48:51], a[48:51], v[88:91]
s_waitcnt lgkmcnt(6)
v_mfma_f32_16x16x32_bf16 v[60:63], a[52:55], v[28:31], v[60:63]
ds_read_b64_tr_b16 v[24:25], v110 offset:12288
v_mfma_f32_16x16x32_bf16 v[56:59], a[48:51], v[28:31], v[56:59]
ds_read_b64_tr_b16 v[26:27], v110 offset:12800
v_mfma_f32_16x16x32_bf16 v[92:95], a[52:55], a[52:55], v[92:95]
s_waitcnt lgkmcnt(6)
v_mfma_f32_16x16x32_bf16 v[64:67], v[96:99], v[68:71], v[64:67]
s_barrier
s_cmp_lg_u32 s67, 4
s_cbranch_scc1 L_c_rs_9
v_add_u32 v118, 0x18000, v118
v_add_u32 v119, 0x18000, v119
ds_read_b64 v[8:9], v118 offset:0
ds_read_b64 v[10:11], v119 offset:0
ds_read_b64 v[12:13], v118 offset:2048
ds_read_b64 v[14:15], v119 offset:2048
s_waitcnt lgkmcnt(0)
L_c_rs_9:
v_add_u32 v102, 0x10000, v100
v_add_u32 v103, 0x10000, v101
ds_read_b128 a[64:67], v102 offset:32768
ds_read_b128 a[68:71], v102 offset:34816
ds_read_b128 a[72:75], v103 offset:32768
ds_read_b128 a[76:79], v103 offset:34816
s_waitcnt lgkmcnt(8)
v_mfma_f32_16x16x32_bf16 v[32:35], a[56:59], v[16:19], v[32:35]
ds_read_b64_tr_b16 v[28:29], v111 offset:12288
v_mfma_f32_16x16x32_bf16 v[36:39], a[60:63], v[16:19], v[36:39]
ds_read_b64_tr_b16 v[30:31], v111 offset:12800
v_mfma_f32_16x16x32_bf16 v[80:83], a[56:59], v[96:99], v[80:83]
ds_read_b64_tr_b16 v[68:69], v73 offset:12288
ds_read_b64_tr_b16 v[70:71], v73 offset:12800
s_waitcnt lgkmcnt(10)
v_mfma_f32_16x16x32_bf16 v[44:47], a[60:63], v[20:23], v[44:47]
ds_read_b64_tr_b16 v[16:17], v108 offset:49152
v_mfma_f32_16x16x32_bf16 v[40:43], a[56:59], v[20:23], v[40:43]
ds_read_b64_tr_b16 v[18:19], v108 offset:49664
v_mfma_f32_16x16x32_bf16 v[84:87], a[60:63], v[96:99], v[84:87]
s_waitcnt lgkmcnt(10)
v_mfma_f32_16x16x32_bf16 v[48:51], a[56:59], v[24:27], v[48:51]
ds_read_b64_tr_b16 v[20:21], v109 offset:49152
v_mfma_f32_16x16x32_bf16 v[52:55], a[60:63], v[24:27], v[52:55]
ds_read_b64_tr_b16 v[22:23], v109 offset:49664
v_mfma_f32_16x16x32_bf16 v[88:91], a[56:59], a[56:59], v[88:91]
s_waitcnt lgkmcnt(6)
v_mfma_f32_16x16x32_bf16 v[60:63], a[60:63], v[28:31], v[60:63]
ds_read_b64_tr_b16 v[24:25], v110 offset:49152
v_mfma_f32_16x16x32_bf16 v[56:59], a[56:59], v[28:31], v[56:59]
ds_read_b64_tr_b16 v[26:27], v110 offset:49664
v_mfma_f32_16x16x32_bf16 v[92:95], a[60:63], a[60:63], v[92:95]
s_waitcnt lgkmcnt(6)
v_mfma_f32_16x16x32_bf16 v[64:67], v[96:99], v[68:71], v[64:67]
s_waitcnt lgkmcnt(4)
v_mfma_f32_16x16x32_bf16 v[32:35], a[64:67], v[16:19], v[32:35]
ds_read_b64_tr_b16 v[28:29], v111 offset:49152
v_mfma_f32_16x16x32_bf16 v[36:39], a[68:71], v[16:19], v[36:39]
ds_read_b64_tr_b16 v[30:31], v111 offset:49664
v_mfma_f32_16x16x32_bf16 v[80:83], a[64:67], v[96:99], v[80:83]
ds_read_b64_tr_b16 v[68:69], v73 offset:49152
ds_read_b64_tr_b16 v[70:71], v73 offset:49664
s_waitcnt lgkmcnt(6)
v_mfma_f32_16x16x32_bf16 v[44:47], a[68:71], v[20:23], v[44:47]
ds_read_b64_tr_b16 v[16:17], v108 offset:53248
v_mfma_f32_16x16x32_bf16 v[40:43], a[64:67], v[20:23], v[40:43]
ds_read_b64_tr_b16 v[18:19], v108 offset:53760
v_mfma_f32_16x16x32_bf16 v[84:87], a[68:71], v[96:99], v[84:87]
s_waitcnt lgkmcnt(6)
v_mfma_f32_16x16x32_bf16 v[48:51], a[64:67], v[24:27], v[48:51]
ds_read_b64_tr_b16 v[20:21], v109 offset:53248
v_mfma_f32_16x16x32_bf16 v[52:55], a[68:71], v[24:27], v[52:55]
ds_read_b64_tr_b16 v[22:23], v109 offset:53760
v_mfma_f32_16x16x32_bf16 v[88:91], a[64:67], a[64:67], v[88:91]
s_waitcnt lgkmcnt(6)
v_mfma_f32_16x16x32_bf16 v[60:63], a[68:71], v[28:31], v[60:63]
ds_read_b64_tr_b16 v[24:25], v110 offset:53248
v_mfma_f32_16x16x32_bf16 v[56:59], a[64:67], v[28:31], v[56:59]
ds_read_b64_tr_b16 v[26:27], v110 offset:53760
v_mfma_f32_16x16x32_bf16 v[92:95], a[68:71], a[68:71], v[92:95]
s_waitcnt lgkmcnt(6)
v_mfma_f32_16x16x32_bf16 v[64:67], v[96:99], v[68:71], v[64:67]
s_barrier
s_cmp_lg_u32 s67, 5
s_cbranch_scc1 L_c_rs_10
v_add_u32 v118, 0x20000, v118
v_add_u32 v119, 0x20000, v119
ds_read_b64 v[8:9], v118 offset:0
ds_read_b64 v[10:11], v119 offset:0
ds_read_b64 v[12:13], v118 offset:2048
ds_read_b64 v[14:15], v119 offset:2048
s_waitcnt lgkmcnt(0)
L_c_rs_10:
v_add_u32 v102, 0x20000, v100
v_add_u32 v103, 0x20000, v101
ds_read_b128 a[80:83], v102 offset:0
ds_read_b128 a[84:87], v102 offset:2048
ds_read_b128 a[88:91], v103 offset:0
ds_read_b128 a[92:95], v103 offset:2048
s_waitcnt lgkmcnt(8)
v_mfma_f32_16x16x32_bf16 v[32:35], a[72:75], v[16:19], v[32:35]
ds_read_b64_tr_b16 v[28:29], v111 offset:53248
v_mfma_f32_16x16x32_bf16 v[36:39], a[76:79], v[16:19], v[36:39]
ds_read_b64_tr_b16 v[30:31], v111 offset:53760
v_mfma_f32_16x16x32_bf16 v[80:83], a[72:75], v[96:99], v[80:83]
ds_read_b64_tr_b16 v[68:69], v73 offset:53248
ds_read_b64_tr_b16 v[70:71], v73 offset:53760
s_waitcnt lgkmcnt(10)
v_mfma_f32_16x16x32_bf16 v[44:47], a[76:79], v[20:23], v[44:47]
ds_read_b64_tr_b16 v[16:17], v108 offset:57344
v_mfma_f32_16x16x32_bf16 v[40:43], a[72:75], v[20:23], v[40:43]
ds_read_b64_tr_b16 v[18:19], v108 offset:57856
v_mfma_f32_16x16x32_bf16 v[84:87], a[76:79], v[96:99], v[84:87]
s_waitcnt lgkmcnt(10)
v_mfma_f32_16x16x32_bf16 v[48:51], a[72:75], v[24:27], v[48:51]
ds_read_b64_tr_b16 v[20:21], v109 offset:57344
v_mfma_f32_16x16x32_bf16 v[52:55], a[76:79], v[24:27], v[52:55]
ds_read_b64_tr_b16 v[22:23], v109 offset:57856
v_mfma_f32_16x16x32_bf16 v[88:91], a[72:75], a[72:75], v[88:91]
s_waitcnt lgkmcnt(6)
v_mfma_f32_16x16x32_bf16 v[60:63], a[76:79], v[28:31], v[60:63]
ds_read_b64_tr_b16 v[24:25], v110 offset:57344
v_mfma_f32_16x16x32_bf16 v[56:59], a[72:75], v[28:31], v[56:59]
ds_read_b64_tr_b16 v[26:27], v110 offset:57856
v_mfma_f32_16x16x32_bf16 v[92:95], a[76:79], a[76:79], v[92:95]
s_waitcnt lgkmcnt(6)
v_mfma_f32_16x16x32_bf16 v[64:67], v[96:99], v[68:71], v[64:67]
s_waitcnt lgkmcnt(4)
v_mfma_f32_16x16x32_bf16 v[32:35], a[80:83], v[16:19], v[32:35]
ds_read_b64_tr_b16 v[28:29], v111 offset:57344
v_mfma_f32_16x16x32_bf16 v[36:39], a[84:87], v[16:19], v[36:39]
ds_read_b64_tr_b16 v[30:31], v111 offset:57856
v_mfma_f32_16x16x32_bf16 v[80:83], a[80:83], v[96:99], v[80:83]
ds_read_b64_tr_b16 v[68:69], v73 offset:57344
ds_read_b64_tr_b16 v[70:71], v73 offset:57856
s_waitcnt lgkmcnt(6)
v_mfma_f32_16x16x32_bf16 v[44:47], a[84:87], v[20:23], v[44:47]
ds_read_b64_tr_b16 v[16:17], v108 offset:61440
v_mfma_f32_16x16x32_bf16 v[40:43], a[80:83], v[20:23], v[40:43]
ds_read_b64_tr_b16 v[18:19], v108 offset:61952
v_mfma_f32_16x16x32_bf16 v[84:87], a[84:87], v[96:99], v[84:87]
s_waitcnt lgkmcnt(6)
v_mfma_f32_16x16x32_bf16 v[48:51], a[80:83], v[24:27], v[48:51]
ds_read_b64_tr_b16 v[20:21], v109 offset:61440
v_mfma_f32_16x16x32_bf16 v[52:55], a[84:87], v[24:27], v[52:55]
ds_read_b64_tr_b16 v[22:23], v109 offset:61952
v_mfma_f32_16x16x32_bf16 v[88:91], a[80:83], a[80:83], v[88:91]
s_waitcnt lgkmcnt(6)
v_mfma_f32_16x16x32_bf16 v[60:63], a[84:87], v[28:31], v[60:63]
ds_read_b64_tr_b16 v[24:25], v110 offset:61440
v_mfma_f32_16x16x32_bf16 v[56:59], a[80:83], v[28:31], v[56:59]
ds_read_b64_tr_b16 v[26:27], v110 offset:61952
v_mfma_f32_16x16x32_bf16 v[92:95], a[84:87], a[84:87], v[92:95]
s_waitcnt lgkmcnt(6)
v_mfma_f32_16x16x32_bf16 v[64:67], v[96:99], v[68:71], v[64:67]
s_barrier
s_cmp_lg_u32 s67, 6
s_cbranch_scc1 L_c_rs_11
v_add_u32 v118, 0x0, v118
v_add_u32 v119, 0x0, v119
ds_read_b64 v[8:9], v118 offset:0
ds_read_b64 v[10:11], v119 offset:0
ds_read_b64 v[12:13], v118 offset:2048
ds_read_b64 v[14:15], v119 offset:2048
s_waitcnt lgkmcnt(0)
L_c_rs_11:
ds_read_b128 a[96:99], v100 offset:0
ds_read_b128 a[100:103], v100 offset:2048
ds_read_b128 a[104:107], v101 offset:0
ds_read_b128 a[108:111], v101 offset:2048
s_waitcnt lgkmcnt(8)
v_mfma_f32_16x16x32_bf16 v[32:35], a[88:91], v[16:19], v[32:35]
ds_read_b64_tr_b16 v[28:29], v111 offset:61440
v_mfma_f32_16x16x32_bf16 v[36:39], a[92:95], v[16:19], v[36:39]
ds_read_b64_tr_b16 v[30:31], v111 offset:61952
v_mfma_f32_16x16x32_bf16 v[80:83], a[88:91], v[96:99], v[80:83]
ds_read_b64_tr_b16 v[68:69], v73 offset:61440
ds_read_b64_tr_b16 v[70:71], v73 offset:61952
s_waitcnt lgkmcnt(10)
v_mfma_f32_16x16x32_bf16 v[44:47], a[92:95], v[20:23], v[44:47]
ds_read_b64_tr_b16 v[16:17], v104 offset:16384
v_mfma_f32_16x16x32_bf16 v[40:43], a[88:91], v[20:23], v[40:43]
ds_read_b64_tr_b16 v[18:19], v104 offset:16896
v_mfma_f32_16x16x32_bf16 v[84:87], a[92:95], v[96:99], v[84:87]
s_waitcnt lgkmcnt(10)
v_mfma_f32_16x16x32_bf16 v[48:51], a[88:91], v[24:27], v[48:51]
ds_read_b64_tr_b16 v[20:21], v105 offset:16384
v_mfma_f32_16x16x32_bf16 v[52:55], a[92:95], v[24:27], v[52:55]
ds_read_b64_tr_b16 v[22:23], v105 offset:16896
v_mfma_f32_16x16x32_bf16 v[88:91], a[88:91], a[88:91], v[88:91]
s_waitcnt lgkmcnt(6)
v_mfma_f32_16x16x32_bf16 v[60:63], a[92:95], v[28:31], v[60:63]
ds_read_b64_tr_b16 v[24:25], v106 offset:16384
v_mfma_f32_16x16x32_bf16 v[56:59], a[88:91], v[28:31], v[56:59]
ds_read_b64_tr_b16 v[26:27], v106 offset:16896
v_mfma_f32_16x16x32_bf16 v[92:95], a[92:95], a[92:95], v[92:95]
s_waitcnt lgkmcnt(6)
v_mfma_f32_16x16x32_bf16 v[64:67], v[96:99], v[68:71], v[64:67]
s_waitcnt lgkmcnt(4)
v_mfma_f32_16x16x32_bf16 v[32:35], a[96:99], v[16:19], v[32:35]
ds_read_b64_tr_b16 v[28:29], v107 offset:16384
v_mfma_f32_16x16x32_bf16 v[36:39], a[100:103], v[16:19], v[36:39]
ds_read_b64_tr_b16 v[30:31], v107 offset:16896
v_mfma_f32_16x16x32_bf16 v[80:83], a[96:99], v[96:99], v[80:83]
ds_read_b64_tr_b16 v[68:69], v72 offset:16384
ds_read_b64_tr_b16 v[70:71], v72 offset:16896
s_waitcnt lgkmcnt(6)
v_mfma_f32_16x16x32_bf16 v[44:47], a[100:103], v[20:23], v[44:47]
ds_read_b64_tr_b16 v[16:17], v104 offset:20480
v_mfma_f32_16x16x32_bf16 v[40:43], a[96:99], v[20:23], v[40:43]
ds_read_b64_tr_b16 v[18:19], v104 offset:20992
v_mfma_f32_16x16x32_bf16 v[84:87], a[100:103], v[96:99], v[84:87]
s_waitcnt lgkmcnt(6)
v_mfma_f32_16x16x32_bf16 v[48:51], a[96:99], v[24:27], v[48:51]
ds_read_b64_tr_b16 v[20:21], v105 offset:20480
v_mfma_f32_16x16x32_bf16 v[52:55], a[100:103], v[24:27], v[52:55]
ds_read_b64_tr_b16 v[22:23], v105 offset:20992
v_mfma_f32_16x16x32_bf16 v[88:91], a[96:99], a[96:99], v[88:91]
s_waitcnt lgkmcnt(6)
v_mfma_f32_16x16x32_bf16 v[60:63], a[100:103], v[28:31], v[60:63]
ds_read_b64_tr_b16 v[24:25], v106 offset:20480
v_mfma_f32_16x16x32_bf16 v[56:59], a[96:99], v[28:31], v[56:59]
ds_read_b64_tr_b16 v[26:27], v106 offset:20992
v_mfma_f32_16x16x32_bf16 v[92:95], a[100:103], a[100:103], v[92:95]
s_waitcnt lgkmcnt(6)
v_mfma_f32_16x16x32_bf16 v[64:67], v[96:99], v[68:71], v[64:67]
s_barrier
s_lshl_b32 s51, s38, 2
s_add_u32 s51, s51, 0x26200
v_mov_b32 v122, s51
v_mov_b32 v123, 0
ds_write_b32 v122, v123
s_cmp_lg_u32 s67, 7
s_cbranch_scc1 L_c_rs_12
v_add_u32 v118, 0x8000, v118
v_add_u32 v119, 0x8000, v119
ds_read_b64 v[8:9], v118 offset:0
ds_read_b64 v[10:11], v119 offset:0
ds_read_b64 v[12:13], v118 offset:2048
ds_read_b64 v[14:15], v119 offset:2048
s_waitcnt lgkmcnt(0)
L_c_rs_12:
ds_read_b128 a[112:115], v100 offset:32768
ds_read_b128 a[116:119], v100 offset:34816
ds_read_b128 a[120:123], v101 offset:32768
ds_read_b128 a[124:127], v101 offset:34816
s_waitcnt lgkmcnt(9)
v_mfma_f32_16x16x32_bf16 v[32:35], a[104:107], v[16:19], v[32:35]
ds_read_b64_tr_b16 v[28:29], v107 offset:20480
v_mfma_f32_16x16x32_bf16 v[36:39], a[108:111], v[16:19], v[36:39]
ds_read_b64_tr_b16 v[30:31], v107 offset:20992
v_mfma_f32_16x16x32_bf16 v[80:83], a[104:107], v[96:99], v[80:83]
ds_read_b64_tr_b16 v[68:69], v72 offset:20480
ds_read_b64_tr_b16 v[70:71], v72 offset:20992
s_waitcnt lgkmcnt(11)
v_mfma_f32_16x16x32_bf16 v[44:47], a[108:111], v[20:23], v[44:47]
ds_read_b64_tr_b16 v[16:17], v104 offset:24576
v_mfma_f32_16x16x32_bf16 v[40:43], a[104:107], v[20:23], v[40:43]
ds_read_b64_tr_b16 v[18:19], v104 offset:25088
v_mfma_f32_16x16x32_bf16 v[84:87], a[108:111], v[96:99], v[84:87]
s_waitcnt lgkmcnt(11)
v_mfma_f32_16x16x32_bf16 v[48:51], a[104:107], v[24:27], v[48:51]
ds_read_b64_tr_b16 v[20:21], v105 offset:24576
v_mfma_f32_16x16x32_bf16 v[52:55], a[108:111], v[24:27], v[52:55]
ds_read_b64_tr_b16 v[22:23], v105 offset:25088
v_mfma_f32_16x16x32_bf16 v[88:91], a[104:107], a[104:107], v[88:91]
s_waitcnt lgkmcnt(6)
v_mfma_f32_16x16x32_bf16 v[60:63], a[108:111], v[28:31], v[60:63]
ds_read_b64_tr_b16 v[24:25], v106 offset:24576
v_mfma_f32_16x16x32_bf16 v[56:59], a[104:107], v[28:31], v[56:59]
ds_read_b64_tr_b16 v[26:27], v106 offset:25088
v_mfma_f32_16x16x32_bf16 v[92:95], a[108:111], a[108:111], v[92:95]
s_waitcnt lgkmcnt(6)
v_mfma_f32_16x16x32_bf16 v[64:67], v[96:99], v[68:71], v[64:67]
s_waitcnt lgkmcnt(4)
v_mfma_f32_16x16x32_bf16 v[32:35], a[112:115], v[16:19], v[32:35]
ds_read_b64_tr_b16 v[28:29], v107 offset:24576
v_mfma_f32_16x16x32_bf16 v[36:39], a[116:119], v[16:19], v[36:39]
ds_read_b64_tr_b16 v[30:31], v107 offset:25088
v_mfma_f32_16x16x32_bf16 v[80:83], a[112:115], v[96:99], v[80:83]
ds_read_b64_tr_b16 v[68:69], v72 offset:24576
ds_read_b64_tr_b16 v[70:71], v72 offset:25088
s_waitcnt lgkmcnt(6)
v_mfma_f32_16x16x32_bf16 v[44:47], a[116:119], v[20:23], v[44:47]
ds_read_b64_tr_b16 v[16:17], v104 offset:28672
v_mfma_f32_16x16x32_bf16 v[40:43], a[112:115], v[20:23], v[40:43]
ds_read_b64_tr_b16 v[18:19], v104 offset:29184
v_mfma_f32_16x16x32_bf16 v[84:87], a[116:119], v[96:99], v[84:87]
s_waitcnt lgkmcnt(6)
v_mfma_f32_16x16x32_bf16 v[48:51], a[112:115], v[24:27], v[48:51]
ds_read_b64_tr_b16 v[20:21], v105 offset:28672
v_mfma_f32_16x16x32_bf16 v[52:55], a[116:119], v[24:27], v[52:55]
ds_read_b64_tr_b16 v[22:23], v105 offset:29184
v_mfma_f32_16x16x32_bf16 v[88:91], a[112:115], a[112:115], v[88:91]
s_waitcnt lgkmcnt(6)
v_mfma_f32_16x16x32_bf16 v[60:63], a[116:119], v[28:31], v[60:63]
ds_read_b64_tr_b16 v[24:25], v106 offset:28672
v_mfma_f32_16x16x32_bf16 v[56:59], a[112:115], v[28:31], v[56:59]
ds_read_b64_tr_b16 v[26:27], v106 offset:29184
v_mfma_f32_16x16x32_bf16 v[92:95], a[116:119], a[116:119], v[92:95]
s_waitcnt lgkmcnt(6)
v_mfma_f32_16x16x32_bf16 v[64:67], v[96:99], v[68:71], v[64:67]
s_waitcnt lgkmcnt(4)
v_mfma_f32_16x16x32_bf16 v[32:35], a[120:123], v[16:19], v[32:35]
ds_read_b64_tr_b16 v[28:29], v107 offset:28672
v_mfma_f32_16x16x32_bf16 v[36:39], a[124:127], v[16:19], v[36:39]
ds_read_b64_tr_b16 v[30:31], v107 offset:29184
v_mfma_f32_16x16x32_bf16 v[80:83], a[120:123], v[96:99], v[80:83]
ds_read_b64_tr_b16 v[68:69], v72 offset:28672
ds_read_b64_tr_b16 v[70:71], v72 offset:29184
s_waitcnt lgkmcnt(6)
v_mfma_f32_16x16x32_bf16 v[44:47], a[124:127], v[20:23], v[44:47]
v_mfma_f32_16x16x32_bf16 v[40:43], a[120:123], v[20:23], v[40:43]
v_mfma_f32_16x16x32_bf16 v[84:87], a[124:127], v[96:99], v[84:87]
s_waitcnt lgkmcnt(4)
v_mfma_f32_16x16x32_bf16 v[48:51], a[120:123], v[24:27], v[48:51]
v_mfma_f32_16x16x32_bf16 v[52:55], a[124:127], v[24:27], v[52:55]
v_mfma_f32_16x16x32_bf16 v[88:91], a[120:123], a[120:123], v[88:91]
s_waitcnt lgkmcnt(2)
v_mfma_f32_16x16x32_bf16 v[60:63], a[124:127], v[28:31], v[60:63]
v_mfma_f32_16x16x32_bf16 v[56:59], a[120:123], v[28:31], v[56:59]
v_mfma_f32_16x16x32_bf16 v[92:95], a[124:127], a[124:127], v[92:95]
s_waitcnt lgkmcnt(0)
v_mfma_f32_16x16x32_bf16 v[64:67], v[96:99], v[68:71], v[64:67]
s_lshl_b32 s48, s38, 12
v_add_u32 v72, 0x0, v4
v_add_u32 v73, s48, v72
s_nop 4
ds_write_b32 v73, v64
s_waitcnt lgkmcnt(0)
s_barrier
ds_read_b32 v64, v72 offset:0
ds_read_b32 v68, v72 offset:4096
ds_read_b32 v74, v72 offset:8192
ds_read_b32 v76, v72 offset:12288
s_mov_b32 s76, 0xaaaaaaaa
s_mov_b32 s77, s76
s_mov_b32 s78, 0xcccccccc
s_mov_b32 s79, s78
v_cndmask_b32 v104, v80, v81, s[76:77]
v_cndmask_b32 v108, v82, v83, s[76:77]
v_cndmask_b32 v105, v84, v85, s[76:77]
v_cndmask_b32 v109, v86, v87, s[76:77]
v_cndmask_b32 v106, v88, v89, s[76:77]
v_cndmask_b32 v110, v90, v91, s[76:77]
v_cndmask_b32 v107, v92, v93, s[76:77]
v_cndmask_b32 v111, v94, v95, s[76:77]
v_cndmask_b32 v104, v104, v108, s[78:79]
v_cndmask_b32 v105, v105, v109, s[78:79]
v_cndmask_b32 v106, v106, v110, s[78:79]
v_cndmask_b32 v107, v107, v111, s[78:79]
v_mul_f32 v104, 0xbb000000, v104
v_mul_f32 v105, 0xbb000000, v105
v_mul_f32 v106, 0x3b000000, v106
v_mul_f32 v107, 0x3b000000, v107
v_fma_f32 v106, -v104, v104, v106
v_fma_f32 v107, -v105, v105, v107
v_max_f32 v106, 0, v106
v_max_f32 v107, 0, v107
v_add_f32 v106, 0x3727c5ac, v106
v_add_f32 v107, 0x3727c5ac, v107
v_rsq_f32 v106, v106
v_rsq_f32 v107, v107
s_sub_u32 s48, s73, 0x1c000
v_add_u32 v108, s48, v4
v_lshrrev_b32 v109, 4, v0
v_lshlrev_b32 v109, 4, v109
v_add_u32 v109, s48, v109
s_waitcnt lgkmcnt(0)
s_mov_b32 exec_lo, 0x00f0000f
s_mov_b32 exec_hi, 0xf0000f00
ds_write_b32 v108, v104 offset:0
ds_write_b32 v108, v105 offset:64
ds_write_b32 v108, v106 offset:128
ds_write_b32 v108, v107 offset:192
s_mov_b64 exec, -1
ds_read_b128 v[116:119], v109 offset:0
ds_read_b128 v[120:123], v109 offset:64
ds_read_b128 v[96:99], v109 offset:128
ds_read_b128 v[100:103], v109 offset:192
v_mov_b32 v88, v112
v_mov_b32 v89, v113
v_mov_b32 v90, v114
v_mov_b32 v91, v115
ds_read_b32 v94, v108 offset:0
ds_read_b32 v95, v108 offset:64
ds_read_b32 v112, v108 offset:128
ds_read_b32 v113, v108 offset:192
s_waitcnt lgkmcnt(6)
v_pk_fma_f32 v[32:33], v[116:117], v[64:65], v[32:33] op_sel_hi:[1,0,1]
v_pk_fma_f32 v[34:35], v[118:119], v[64:65], v[34:35] op_sel_hi:[1,0,1]
v_pk_fma_f32 v[36:37], v[120:121], v[64:65], v[36:37] op_sel_hi:[1,0,1]
v_pk_fma_f32 v[38:39], v[122:123], v[64:65], v[38:39] op_sel_hi:[1,0,1]
v_pk_fma_f32 v[40:41], v[116:117], v[68:69], v[40:41] op_sel_hi:[1,0,1]
v_pk_fma_f32 v[42:43], v[118:119], v[68:69], v[42:43] op_sel_hi:[1,0,1]
v_pk_fma_f32 v[44:45], v[120:121], v[68:69], v[44:45] op_sel_hi:[1,0,1]
v_pk_fma_f32 v[46:47], v[122:123], v[68:69], v[46:47] op_sel_hi:[1,0,1]
v_pk_fma_f32 v[48:49], v[116:117], v[74:75], v[48:49] op_sel_hi:[1,0,1]
v_pk_fma_f32 v[50:51], v[118:119], v[74:75], v[50:51] op_sel_hi:[1,0,1]
v_pk_fma_f32 v[52:53], v[120:121], v[74:75], v[52:53] op_sel_hi:[1,0,1]
v_pk_fma_f32 v[54:55], v[122:123], v[74:75], v[54:55] op_sel_hi:[1,0,1]
v_pk_fma_f32 v[56:57], v[116:117], v[76:77], v[56:57] op_sel_hi:[1,0,1]
v_pk_fma_f32 v[58:59], v[118:119], v[76:77], v[58:59] op_sel_hi:[1,0,1]
v_pk_fma_f32 v[60:61], v[120:121], v[76:77], v[60:61] op_sel_hi:[1,0,1]
v_pk_fma_f32 v[62:63], v[122:123], v[76:77], v[62:63] op_sel_hi:[1,0,1]
s_waitcnt lgkmcnt(4)
v_mul_f32 v104, 0x3fb8aa3b, v96
v_mul_f32 v105, 0x3fb8aa3b, v97
v_mul_f32 v106, 0x3fb8aa3b, v98
v_mul_f32 v107, 0x3fb8aa3b, v99
v_mul_f32 v108, 0x3fb8aa3b, v100
v_mul_f32 v109, 0x3fb8aa3b, v101
v_mul_f32 v110, 0x3fb8aa3b, v102
v_mul_f32 v111, 0x3fb8aa3b, v103
s_waitcnt lgkmcnt(0)
v_mul_f32 v114, 0x3fb8aa3b, v112
v_mul_f32 v115, 0x3fb8aa3b, v113
v_pk_mul_f32 v[64:65], v[32:33], v[104:105]
v_pk_mul_f32 v[66:67], v[34:35], v[106:107]
v_exp_f32_e64 v64, v64 clamp
v_exp_f32_e64 v65, v65 clamp
v_exp_f32_e64 v66, v66 clamp
v_exp_f32_e64 v67, v67 clamp
v_pk_fma_f32 v[32:33], v[32:33], v[96:97], s[74:75] op_sel_hi:[1,1,0]
v_pk_fma_f32 v[34:35], v[34:35], v[98:99], s[74:75] op_sel_hi:[1,1,0]
v_max_f32 v32, s74, v32
v_max_f32 v33, s74, v33
v_max_f32 v34, s74, v34
v_max_f32 v35, s74, v35
v_pk_add_f32 v[32:33], v[32:33], v[64:65]
v_pk_add_f32 v[34:35], v[34:35], v[66:67]
v_cvt_pk_bf16_f32 v116, v32, v33
v_cvt_pk_bf16_f32 v117, v34, v35
v_pk_mul_f32 v[68:69], v[36:37], v[108:109]
v_pk_mul_f32 v[70:71], v[38:39], v[110:111]
v_exp_f32_e64 v68, v68 clamp
v_exp_f32_e64 v69, v69 clamp
v_exp_f32_e64 v70, v70 clamp
v_exp_f32_e64 v71, v71 clamp
v_pk_fma_f32 v[36:37], v[36:37], v[100:101], s[74:75] op_sel_hi:[1,1,0]
v_pk_fma_f32 v[38:39], v[38:39], v[102:103], s[74:75] op_sel_hi:[1,1,0]
v_max_f32 v36, s74, v36
v_max_f32 v37, s74, v37
v_max_f32 v38, s74, v38
v_max_f32 v39, s74, v39
v_pk_add_f32 v[36:37], v[36:37], v[68:69]
v_pk_add_f32 v[38:39], v[38:39], v[70:71]
v_cvt_pk_bf16_f32 v118, v36, v37
v_cvt_pk_bf16_f32 v119, v38, v39
v_pk_mul_f32 v[48:49], v[48:49], v[96:97]
v_pk_mul_f32 v[50:51], v[50:51], v[98:99]
v_cvt_pk_bf16_f32 v80, v48, v49
v_cvt_pk_bf16_f32 v81, v50, v51
v_pk_mul_f32 v[52:53], v[52:53], v[100:101]
v_pk_mul_f32 v[54:55], v[54:55], v[102:103]
v_cvt_pk_bf16_f32 v82, v52, v53
v_cvt_pk_bf16_f32 v83, v54, v55
s_nop 1
v_mfma_f32_16x16x32_bf16 v[32:35], v[116:119], v[80:83], 0
v_pk_mul_f32 v[72:73], v[40:41], v[104:105]
v_pk_mul_f32 v[74:75], v[42:43], v[106:107]
v_exp_f32_e64 v72, v72 clamp
v_exp_f32_e64 v73, v73 clamp
v_exp_f32_e64 v74, v74 clamp
v_exp_f32_e64 v75, v75 clamp
v_pk_fma_f32 v[40:41], v[40:41], v[96:97], s[74:75] op_sel_hi:[1,1,0]
v_pk_fma_f32 v[42:43], v[42:43], v[98:99], s[74:75] op_sel_hi:[1,1,0]
v_max_f32 v40, s74, v40
v_max_f32 v41, s74, v41
v_max_f32 v42, s74, v42
v_max_f32 v43, s74, v43
v_pk_add_f32 v[40:41], v[40:41], v[72:73]
v_pk_add_f32 v[42:43], v[42:43], v[74:75]
v_cvt_pk_bf16_f32 v120, v40, v41
v_cvt_pk_bf16_f32 v121, v42, v43
v_pk_mul_f32 v[76:77], v[44:45], v[108:109]
v_pk_mul_f32 v[78:79], v[46:47], v[110:111]
v_exp_f32_e64 v76, v76 clamp
v_exp_f32_e64 v77, v77 clamp
v_exp_f32_e64 v78, v78 clamp
v_exp_f32_e64 v79, v79 clamp
v_pk_fma_f32 v[44:45], v[44:45], v[100:101], s[74:75] op_sel_hi:[1,1,0]
v_pk_fma_f32 v[46:47], v[46:47], v[102:103], s[74:75] op_sel_hi:[1,1,0]
v_max_f32 v44, s74, v44
v_max_f32 v45, s74, v45
v_max_f32 v46, s74, v46
v_max_f32 v47, s74, v47
v_pk_add_f32 v[44:45], v[44:45], v[76:77]
v_pk_add_f32 v[46:47], v[46:47], v[78:79]
v_cvt_pk_bf16_f32 v122, v44, v45
v_cvt_pk_bf16_f32 v123, v46, v47
v_mov_b32 v104, 0x3f803f80
v_mov_b32 v105, 0x3f803f80
v_mov_b32 v106, 0x3f803f80
v_mov_b32 v107, 0x3f803f80
v_pk_mul_f32 v[56:57], v[56:57], v[96:97]
v_pk_mul_f32 v[58:59], v[58:59], v[98:99]
v_cvt_pk_bf16_f32 v84, v56, v57
v_cvt_pk_bf16_f32 v85, v58, v59
v_pk_mul_f32 v[60:61], v[60:61], v[100:101]
v_pk_mul_f32 v[62:63], v[62:63], v[102:103]
v_cvt_pk_bf16_f32 v86, v60, v61
v_cvt_pk_bf16_f32 v87, v62, v63
s_nop 1
v_mfma_f32_16x16x32_bf16 v[40:43], v[120:123], v[84:87], 0
v_mfma_f32_16x16x32_bf16 v[36:39], v[116:119], v[104:107], 0
v_mfma_f32_16x16x32_bf16 v[44:47], v[120:123], v[104:107], 0
v_add_u32 v96, s72, v3
v_add_u32 v97, s73, v1
v_and_b32 v98, 0x30, v0
v_add_u32 v99, 0x20000, v98
v_add_u32 v99, s72, v99
v_add_u32 v98, s73, v98
s_cmp_lt_u32 s38, 2
s_cselect_b64 vcc, -1, 0
v_cndmask_b32 v97, v98, v97, vcc
ds_write_b128 v96, v[32:35] offset:16384
ds_write_b128 v96, v[40:43] offset:20480
ds_write_b128 v99, v[36:39] offset:24576
ds_write_b128 v99, v[44:47] offset:28672
s_lshl_b32 s51, s38, 2
v_mov_b32 v59, 1
v_mov_b32 v56, 0x26200
v_add_u32 v58, s51, v56
ds_write_b32 v58, v59
L_c_sa_13:
ds_read_b128 v[48:51], v56
ds_read_b128 v[52:55], v56 offset:16
s_add_u32 s66, s66, 1
s_cmp_lt_u32 s66, 0x800000
s_waitcnt lgkmcnt(0)
v_min3_u32 v48, v48, v49, v50
v_min3_u32 v52, v52, v53, v54
v_min3_u32 v48, v48, v51, v55
v_min_u32 v48, v48, v52
v_cmp_gt_u32 vcc, 1, v48
s_cbranch_scc0 L_c_sa_13_x
s_cbranch_vccnz L_c_sa_13
L_c_sa_13_x:
ds_read_b128 v[32:35], v97 offset:0
ds_read_b128 v[36:39], v97 offset:1024
ds_read_b128 v[40:43], v97 offset:2048
ds_read_b128 v[44:47], v97 offset:3072
ds_read_b64_tr_b16 v[16:17], v88 offset:49152
ds_read_b64_tr_b16 v[18:19], v88 offset:49408
ds_read_b64_tr_b16 v[20:21], v89 offset:49152
ds_read_b64_tr_b16 v[22:23], v89 offset:49408
ds_read_b64_tr_b16 v[24:25], v88 offset:51200
ds_read_b64_tr_b16 v[26:27], v88 offset:51456
s_waitcnt lgkmcnt(8)
v_pk_add_f32 v[32:33], v[32:33], v[36:37]
v_pk_add_f32 v[34:35], v[34:35], v[38:39]
s_waitcnt lgkmcnt(6)
v_pk_add_f32 v[40:41], v[40:41], v[44:45]
v_pk_add_f32 v[42:43], v[42:43], v[46:47]
v_pk_add_f32 v[32:33], v[32:33], v[40:41]
v_pk_add_f32 v[34:35], v[34:35], v[42:43]
v_cvt_pk_bf16_f32 v32, v32, v33
v_cvt_pk_bf16_f32 v33, v34, v35
v_min_u32 v32, -2, v32
v_min_u32 v33, -2, v33
s_waitcnt vmcnt(0)
s_add_u32 s49, s63, 0x1280000
buffer_store_dwordx2 v[32:33], v126, s[4:7], s49 offen offset:0 sc1
v_mov_b32 v118, -1
v_mov_b32 v119, -1
v_mov_b32 v120, -1
v_mov_b32 v121, -1
s_add_u32 s49, s68, 0x740000
buffer_store_dwordx4 v[118:121], v1, s[4:7], s49 offen offset:0 sc1
buffer_store_dwordx4 v[118:121], v1, s[4:7], s49 offen offset:1024 sc1
s_add_u32 s49, s69, 0x940000
buffer_store_dwordx4 v[118:121], v1, s[4:7], s49 offen offset:0 sc1
buffer_store_dwordx4 v[118:121], v1, s[4:7], s49 offen offset:1024 sc1
s_and_b32 s48, s65, 3
s_cbranch_scc1 L_c_ns_18
s_add_u32 s49, s61, 0x1240000
buffer_store_dwordx4 v[118:121], v1, s[4:7], s49 offen sc1
s_add_u32 s49, s61, 0x13c0000
buffer_store_dwordx4 v[118:121], v1, s[4:7], s49 offen sc1
s_add_u32 s49, s61, 0x1380000
buffer_store_dwordx4 v[118:121], v1, s[4:7], s49 offen sc1
L_c_ns_18:
s_waitcnt lgkmcnt(4)
v_mfma_f32_16x16x32_bf16 v[64:67], v[16:19], a[0:3], 0
ds_read_b64_tr_b16 v[28:29], v89 offset:51200
v_mfma_f32_16x16x32_bf16 v[68:71], v[16:19], a[4:7], 0
ds_read_b64_tr_b16 v[30:31], v89 offset:51456
v_mfma_f32_16x16x32_bf16 v[80:83], v[16:19], v[104:107], 0
s_waitcnt lgkmcnt(4)
v_mfma_f32_16x16x32_bf16 v[76:79], v[20:23], a[4:7], 0
ds_read_b64_tr_b16 v[16:17], v88 offset:53248
v_mfma_f32_16x16x32_bf16 v[72:75], v[20:23], a[0:3], 0
ds_read_b64_tr_b16 v[18:19], v88 offset:53504
v_mfma_f32_16x16x32_bf16 v[84:87], v[20:23], v[104:107], 0
s_waitcnt lgkmcnt(4)
v_mfma_f32_16x16x32_bf16 v[64:67], v[24:27], a[8:11], v[64:67]
ds_read_b64_tr_b16 v[20:21], v89 offset:53248
v_mfma_f32_16x16x32_bf16 v[68:71], v[24:27], a[12:15], v[68:71]
ds_read_b64_tr_b16 v[22:23], v89 offset:53504
v_mfma_f32_16x16x32_bf16 v[80:83], v[24:27], v[104:107], v[80:83]
s_waitcnt lgkmcnt(4)
v_mfma_f32_16x16x32_bf16 v[76:79], v[28:31], a[12:15], v[76:79]
ds_read_b64_tr_b16 v[24:25], v88 offset:55296
v_mfma_f32_16x16x32_bf16 v[72:75], v[28:31], a[8:11], v[72:75]
ds_read_b64_tr_b16 v[26:27], v88 offset:55552
v_mfma_f32_16x16x32_bf16 v[84:87], v[28:31], v[104:107], v[84:87]
s_waitcnt lgkmcnt(4)
v_mfma_f32_16x16x32_bf16 v[64:67], v[16:19], a[16:19], v[64:67]
ds_read_b64_tr_b16 v[28:29], v89 offset:55296
v_mfma_f32_16x16x32_bf16 v[68:71], v[16:19], a[20:23], v[68:71]
ds_read_b64_tr_b16 v[30:31], v89 offset:55552
v_mfma_f32_16x16x32_bf16 v[80:83], v[16:19], v[104:107], v[80:83]
s_waitcnt lgkmcnt(4)
v_mfma_f32_16x16x32_bf16 v[76:79], v[20:23], a[20:23], v[76:79]
ds_read_b64_tr_b16 v[16:17], v88 offset:57344
v_mfma_f32_16x16x32_bf16 v[72:75], v[20:23], a[16:19], v[72:75]
ds_read_b64_tr_b16 v[18:19], v88 offset:57600
v_mfma_f32_16x16x32_bf16 v[84:87], v[20:23], v[104:107], v[84:87]
s_waitcnt lgkmcnt(4)
v_mfma_f32_16x16x32_bf16 v[64:67], v[24:27], a[24:27], v[64:67]
ds_read_b64_tr_b16 v[20:21], v89 offset:57344
v_mfma_f32_16x16x32_bf16 v[68:71], v[24:27], a[28:31], v[68:71]
ds_read_b64_tr_b16 v[22:23], v89 offset:57600
v_mfma_f32_16x16x32_bf16 v[80:83], v[24:27], v[104:107], v[80:83]
s_waitcnt lgkmcnt(4)
v_mfma_f32_16x16x32_bf16 v[76:79], v[28:31], a[28:31], v[76:79]
ds_read_b64_tr_b16 v[24:25], v88 offset:59392
v_mfma_f32_16x16x32_bf16 v[72:75], v[28:31], a[24:27], v[72:75]
ds_read_b64_tr_b16 v[26:27], v88 offset:59648
v_mfma_f32_16x16x32_bf16 v[84:87], v[28:31], v[104:107], v[84:87]
s_waitcnt lgkmcnt(4)
v_mfma_f32_16x16x32_bf16 v[64:67], v[16:19], a[32:35], v[64:67]
ds_read_b64_tr_b16 v[28:29], v89 offset:59392
v_mfma_f32_16x16x32_bf16 v[68:71], v[16:19], a[36:39], v[68:71]
ds_read_b64_tr_b16 v[30:31], v89 offset:59648
v_mfma_f32_16x16x32_bf16 v[80:83], v[16:19], v[104:107], v[80:83]
s_waitcnt lgkmcnt(4)
v_mfma_f32_16x16x32_bf16 v[76:79], v[20:23], a[36:39], v[76:79]
ds_read_b64_tr_b16 v[16:17], v88 offset:61440
v_mfma_f32_16x16x32_bf16 v[72:75], v[20:23], a[32:35], v[72:75]
ds_read_b64_tr_b16 v[18:19], v88 offset:61696
v_mfma_f32_16x16x32_bf16 v[84:87], v[20:23], v[104:107], v[84:87]
s_waitcnt lgkmcnt(4)
v_mfma_f32_16x16x32_bf16 v[64:67], v[24:27], a[40:43], v[64:67]
ds_read_b64_tr_b16 v[20:21], v89 offset:61440
v_mfma_f32_16x16x32_bf16 v[68:71], v[24:27], a[44:47], v[68:71]
ds_read_b64_tr_b16 v[22:23], v89 offset:61696
v_mfma_f32_16x16x32_bf16 v[80:83], v[24:27], v[104:107], v[80:83]
s_waitcnt lgkmcnt(4)
v_mfma_f32_16x16x32_bf16 v[76:79], v[28:31], a[44:47], v[76:79]
ds_read_b64_tr_b16 v[24:25], v88 offset:63488
v_mfma_f32_16x16x32_bf16 v[72:75], v[28:31], a[40:43], v[72:75]
ds_read_b64_tr_b16 v[26:27], v88 offset:63744
v_mfma_f32_16x16x32_bf16 v[84:87], v[28:31], v[104:107], v[84:87]
s_waitcnt lgkmcnt(4)
v_mfma_f32_16x16x32_bf16 v[64:67], v[16:19], a[48:51], v[64:67]
ds_read_b64_tr_b16 v[28:29], v89 offset:63488
v_mfma_f32_16x16x32_bf16 v[68:71], v[16:19], a[52:55], v[68:71]
ds_read_b64_tr_b16 v[30:31], v89 offset:63744
v_mfma_f32_16x16x32_bf16 v[80:83], v[16:19], v[104:107], v[80:83]
s_waitcnt lgkmcnt(4)
v_mfma_f32_16x16x32_bf16 v[76:79], v[20:23], a[52:55], v[76:79]
ds_read_b64_tr_b16 v[16:17], v90 offset:0
v_mfma_f32_16x16x32_bf16 v[72:75], v[20:23], a[48:51], v[72:75]
ds_read_b64_tr_b16 v[18:19], v90 offset:256
v_mfma_f32_16x16x32_bf16 v[84:87], v[20:23], v[104:107], v[84:87]
s_waitcnt lgkmcnt(4)
v_mfma_f32_16x16x32_bf16 v[64:67], v[24:27], a[56:59], v[64:67]
ds_read_b64_tr_b16 v[20:21], v91 offset:0
v_mfma_f32_16x16x32_bf16 v[68:71], v[24:27], a[60:63], v[68:71]
ds_read_b64_tr_b16 v[22:23], v91 offset:256
v_mfma_f32_16x16x32_bf16 v[80:83], v[24:27], v[104:107], v[80:83]
s_waitcnt lgkmcnt(4)
v_mfma_f32_16x16x32_bf16 v[76:79], v[28:31], a[60:63], v[76:79]
ds_read_b64_tr_b16 v[24:25], v90 offset:2048
v_mfma_f32_16x16x32_bf16 v[72:75], v[28:31], a[56:59], v[72:75]
ds_read_b64_tr_b16 v[26:27], v90 offset:2304
v_mfma_f32_16x16x32_bf16 v[84:87], v[28:31], v[104:107], v[84:87]
s_waitcnt lgkmcnt(4)
v_mfma_f32_16x16x32_bf16 v[64:67], v[16:19], a[64:67], v[64:67]
ds_read_b64_tr_b16 v[28:29], v91 offset:2048
v_mfma_f32_16x16x32_bf16 v[68:71], v[16:19], a[68:71], v[68:71]
ds_read_b64_tr_b16 v[30:31], v91 offset:2304
v_mfma_f32_16x16x32_bf16 v[80:83], v[16:19], v[104:107], v[80:83]
s_waitcnt lgkmcnt(4)
v_mfma_f32_16x16x32_bf16 v[76:79], v[20:23], a[68:71], v[76:79]
ds_read_b64_tr_b16 v[16:17], v90 offset:4096
v_mfma_f32_16x16x32_bf16 v[72:75], v[20:23], a[64:67], v[72:75]
ds_read_b64_tr_b16 v[18:19], v90 offset:4352
v_mfma_f32_16x16x32_bf16 v[84:87], v[20:23], v[104:107], v[84:87]
s_waitcnt lgkmcnt(4)
v_mfma_f32_16x16x32_bf16 v[64:67], v[24:27], a[72:75], v[64:67]
ds_read_b64_tr_b16 v[20:21], v91 offset:4096
v_mfma_f32_16x16x32_bf16 v[68:71], v[24:27], a[76:79], v[68:71]
ds_read_b64_tr_b16 v[22:23], v91 offset:4352
v_mfma_f32_16x16x32_bf16 v[80:83], v[24:27], v[104:107], v[80:83]
s_waitcnt lgkmcnt(4)
v_mfma_f32_16x16x32_bf16 v[76:79], v[28:31], a[76:79], v[76:79]
ds_read_b64_tr_b16 v[24:25], v90 offset:6144
v_mfma_f32_16x16x32_bf16 v[72:75], v[28:31], a[72:75], v[72:75]
ds_read_b64_tr_b16 v[26:27], v90 offset:6400
v_mfma_f32_16x16x32_bf16 v[84:87], v[28:31], v[104:107], v[84:87]
s_waitcnt lgkmcnt(4)
v_mfma_f32_16x16x32_bf16 v[64:67], v[16:19], a[80:83], v[64:67]
ds_read_b64_tr_b16 v[28:29], v91 offset:6144
v_mfma_f32_16x16x32_bf16 v[68:71], v[16:19], a[84:87], v[68:71]
ds_read_b64_tr_b16 v[30:31], v91 offset:6400
v_mfma_f32_16x16x32_bf16 v[80:83], v[16:19], v[104:107], v[80:83]
s_waitcnt lgkmcnt(4)
v_mfma_f32_16x16x32_bf16 v[76:79], v[20:23], a[84:87], v[76:79]
ds_read_b64_tr_b16 v[16:17], v90 offset:8192
v_mfma_f32_16x16x32_bf16 v[72:75], v[20:23], a[80:83], v[72:75]
ds_read_b64_tr_b16 v[18:19], v90 offset:8448
v_mfma_f32_16x16x32_bf16 v[84:87], v[20:23], v[104:107], v[84:87]
s_waitcnt lgkmcnt(4)
v_mfma_f32_16x16x32_bf16 v[64:67], v[24:27], a[88:91], v[64:67]
ds_read_b64_tr_b16 v[20:21], v91 offset:8192
v_mfma_f32_16x16x32_bf16 v[68:71], v[24:27], a[92:95], v[68:71]
ds_read_b64_tr_b16 v[22:23], v91 offset:8448
v_mfma_f32_16x16x32_bf16 v[80:83], v[24:27], v[104:107], v[80:83]
s_waitcnt lgkmcnt(4)
v_mfma_f32_16x16x32_bf16 v[76:79], v[28:31], a[92:95], v[76:79]
ds_read_b64_tr_b16 v[24:25], v90 offset:10240
v_mfma_f32_16x16x32_bf16 v[72:75], v[28:31], a[88:91], v[72:75]
ds_read_b64_tr_b16 v[26:27], v90 offset:10496
v_mfma_f32_16x16x32_bf16 v[84:87], v[28:31], v[104:107], v[84:87]
s_waitcnt lgkmcnt(4)
v_mfma_f32_16x16x32_bf16 v[64:67], v[16:19], a[96:99], v[64:67]
ds_read_b64_tr_b16 v[28:29], v91 offset:10240
v_mfma_f32_16x16x32_bf16 v[68:71], v[16:19], a[100:103], v[68:71]
ds_read_b64_tr_b16 v[30:31], v91 offset:10496
v_mfma_f32_16x16x32_bf16 v[80:83], v[16:19], v[104:107], v[80:83]
s_waitcnt lgkmcnt(4)
v_mfma_f32_16x16x32_bf16 v[76:79], v[20:23], a[100:103], v[76:79]
ds_read_b64_tr_b16 v[16:17], v90 offset:12288
v_mfma_f32_16x16x32_bf16 v[72:75], v[20:23], a[96:99], v[72:75]
ds_read_b64_tr_b16 v[18:19], v90 offset:12544
v_mfma_f32_16x16x32_bf16 v[84:87], v[20:23], v[104:107], v[84:87]
s_waitcnt lgkmcnt(4)
v_mfma_f32_16x16x32_bf16 v[64:67], v[24:27], a[104:107], v[64:67]
ds_read_b64_tr_b16 v[20:21], v91 offset:12288
v_mfma_f32_16x16x32_bf16 v[68:71], v[24:27], a[108:111], v[68:71]
ds_read_b64_tr_b16 v[22:23], v91 offset:12544
v_mfma_f32_16x16x32_bf16 v[80:83], v[24:27], v[104:107], v[80:83]
s_waitcnt lgkmcnt(4)
v_mfma_f32_16x16x32_bf16 v[76:79], v[28:31], a[108:111], v[76:79]
ds_read_b64_tr_b16 v[24:25], v90 offset:14336
v_mfma_f32_16x16x32_bf16 v[72:75], v[28:31], a[104:107], v[72:75]
ds_read_b64_tr_b16 v[26:27], v90 offset:14592
v_mfma_f32_16x16x32_bf16 v[84:87], v[28:31], v[104:107], v[84:87]
s_waitcnt lgkmcnt(4)
v_mfma_f32_16x16x32_bf16 v[64:67], v[16:19], a[112:115], v[64:67]
ds_read_b64_tr_b16 v[28:29], v91 offset:14336
v_mfma_f32_16x16x32_bf16 v[68:71], v[16:19], a[116:119], v[68:71]
ds_read_b64_tr_b16 v[30:31], v91 offset:14592
v_mfma_f32_16x16x32_bf16 v[80:83], v[16:19], v[104:107], v[80:83]
s_waitcnt lgkmcnt(4)
v_mfma_f32_16x16x32_bf16 v[76:79], v[20:23], a[116:119], v[76:79]
v_mfma_f32_16x16x32_bf16 v[72:75], v[20:23], a[112:115], v[72:75]
v_mfma_f32_16x16x32_bf16 v[84:87], v[20:23], v[104:107], v[84:87]
s_waitcnt lgkmcnt(2)
v_mfma_f32_16x16x32_bf16 v[64:67], v[24:27], a[120:123], v[64:67]
v_mfma_f32_16x16x32_bf16 v[68:71], v[24:27], a[124:127], v[68:71]
v_mfma_f32_16x16x32_bf16 v[80:83], v[24:27], v[104:107], v[80:83]
s_waitcnt lgkmcnt(0)
v_mfma_f32_16x16x32_bf16 v[76:79], v[28:31], a[124:127], v[76:79]
v_mfma_f32_16x16x32_bf16 v[72:75], v[28:31], a[120:123], v[72:75]
v_mfma_f32_16x16x32_bf16 v[84:87], v[28:31], v[104:107], v[84:87]
s_add_u32 s49, s62, 0x1280000
buffer_load_dwordx2 v[32:33], v126, s[4:7], s49 offen offset:0
buffer_load_dwordx2 v[34:35], v126, s[4:7], s49 offen offset:1280
buffer_load_dwordx2 v[36:37], v126, s[4:7], s49 offen offset:2560
s_add_u32 s49, s62, 0x1280f00
buffer_load_dwordx2 v[38:39], v126, s[4:7], s49 offen offset:0
buffer_load_dwordx2 v[40:41], v126, s[4:7], s49 offen offset:1280
buffer_load_dwordx2 v[42:43], v126, s[4:7], s49 offen offset:2560
s_add_u32 s49, s62, 0x1281e00
buffer_load_dwordx2 v[44:45], v126, s[4:7], s49 offen offset:0
buffer_load_dwordx2 v[46:47], v126, s[4:7], s49 offen offset:1280
buffer_load_dwordx2 v[48:49], v126, s[4:7], s49 offen offset:2560
s_add_u32 s49, s62, 0x1282d00
buffer_load_dwordx2 v[50:51], v126, s[4:7], s49 offen offset:0
buffer_load_dwordx2 v[52:53], v126, s[4:7], s49 offen offset:1280
buffer_load_dwordx2 v[54:55], v126, s[4:7], s49 offen offset:2560
s_add_u32 s49, s62, 0x1283c00
buffer_load_dwordx2 v[56:57], v126, s[4:7], s49 offen offset:0
buffer_load_dwordx2 v[58:59], v126, s[4:7], s49 offen offset:1280
buffer_load_dwordx2 v[60:61], v126, s[4:7], s49 offen offset:2560
s_add_u32 s49, s62, 0x1284b00
buffer_load_dwordx2 v[62:63], v126, s[4:7], s49 offen offset:0
v_fmac_f32 v64, v80, v94
v_fmac_f32 v65, v81, v94
v_fmac_f32 v66, v82, v94
v_fmac_f32 v67, v83, v94
v_mul_f32 v96, v64, v114
v_mul_f32 v97, v65, v114
v_mul_f32 v98, v66, v114
v_mul_f32 v99, v67, v114
v_exp_f32_e64 v96, v96 clamp
v_exp_f32_e64 v97, v97 clamp
v_exp_f32_e64 v98, v98 clamp
v_exp_f32_e64 v99, v99 clamp
v_fma_f32 v64, v64, v112, s74
v_fma_f32 v65, v65, v112, s74
v_fma_f32 v66, v66, v112, s74
v_fma_f32 v67, v67, v112, s74
v_max_f32 v64, s74, v64
v_max_f32 v65, s74, v65
v_max_f32 v66, s74, v66
v_max_f32 v67, s74, v67
v_pk_add_f32 v[64:65], v[64:65], v[96:97]
v_pk_add_f32 v[66:67], v[66:67], v[98:99]
v_cvt_pk_bf16_f32 v116, v64, v65
v_cvt_pk_bf16_f32 v117, v66, v67
v_fmac_f32 v68, v80, v95
v_fmac_f32 v69, v81, v95
v_fmac_f32 v70, v82, v95
v_fmac_f32 v71, v83, v95
v_mul_f32 v100, v68, v115
v_mul_f32 v101, v69, v115
v_mul_f32 v102, v70, v115
v_mul_f32 v103, v71, v115
v_exp_f32_e64 v100, v100 clamp
v_exp_f32_e64 v101, v101 clamp
v_exp_f32_e64 v102, v102 clamp
v_exp_f32_e64 v103, v103 clamp
v_fma_f32 v68, v68, v113, s74
v_fma_f32 v69, v69, v113, s74
v_fma_f32 v70, v70, v113, s74
v_fma_f32 v71, v71, v113, s74
v_max_f32 v68, s74, v68
v_max_f32 v69, s74, v69
v_max_f32 v70, s74, v70
v_max_f32 v71, s74, v71
v_pk_add_f32 v[68:69], v[68:69], v[100:101]
v_pk_add_f32 v[70:71], v[70:71], v[102:103]
v_cvt_pk_bf16_f32 v120, v68, v69
v_cvt_pk_bf16_f32 v121, v70, v71
v_fmac_f32 v72, v84, v94
v_fmac_f32 v73, v85, v94
v_fmac_f32 v74, v86, v94
v_fmac_f32 v75, v87, v94
v_mul_f32 v96, v72, v114
v_mul_f32 v97, v73, v114
v_mul_f32 v98, v74, v114
v_mul_f32 v99, v75, v114
v_exp_f32_e64 v96, v96 clamp
v_exp_f32_e64 v97, v97 clamp
v_exp_f32_e64 v98, v98 clamp
v_exp_f32_e64 v99, v99 clamp
v_fma_f32 v72, v72, v112, s74
v_fma_f32 v73, v73, v112, s74
v_fma_f32 v74, v74, v112, s74
v_fma_f32 v75, v75, v112, s74
v_max_f32 v72, s74, v72
v_max_f32 v73, s74, v73
v_max_f32 v74, s74, v74
v_max_f32 v75, s74, v75
v_pk_add_f32 v[72:73], v[72:73], v[96:97]
v_pk_add_f32 v[74:75], v[74:75], v[98:99]
v_cvt_pk_bf16_f32 v118, v72, v73
v_cvt_pk_bf16_f32 v119, v74, v75
v_fmac_f32 v76, v84, v95
v_fmac_f32 v77, v85, v95
v_fmac_f32 v78, v86, v95
v_fmac_f32 v79, v87, v95
v_mul_f32 v100, v76, v115
v_mul_f32 v101, v77, v115
v_mul_f32 v102, v78, v115
v_mul_f32 v103, v79, v115
v_exp_f32_e64 v100, v100 clamp
v_exp_f32_e64 v101, v101 clamp
v_exp_f32_e64 v102, v102 clamp
v_exp_f32_e64 v103, v103 clamp
v_fma_f32 v76, v76, v113, s74
v_fma_f32 v77, v77, v113, s74
v_fma_f32 v78, v78, v113, s74
v_fma_f32 v79, v79, v113, s74
v_max_f32 v76, s74, v76
v_max_f32 v77, s74, v77
v_max_f32 v78, s74, v78
v_max_f32 v79, s74, v79
v_pk_add_f32 v[76:77], v[76:77], v[100:101]
v_pk_add_f32 v[78:79], v[78:79], v[102:103]
v_cvt_pk_bf16_f32 v122, v76, v77
v_cvt_pk_bf16_f32 v123, v78, v79
v_mov_b32 v66, 0
v_mov_b32 v67, 0
v_mov_b32 v68, 0
v_mov_b32 v69, 0
v_mov_b32 v74, 0
v_mov_b32 v75, 0
v_mov_b32 v76, 0
v_mov_b32 v77, 0
s_mov_b32 s51, 0x3f80
s_mov_b32 s52, 0x3f800000
v_lshrrev_b32 v97, 1, v1
s_lshr_b32 s53, s72, 1
s_add_u32 s53, s53, 0x24000
v_add_u32 v96, s53, v97
v_add_u32 v97, 0x24000, v97
s_waitcnt vmcnt(12)
v_max3_u32 v98, v32, v33, 0
v_dot2_f32_bf16 v100, v32, s51, 0
v_dot2_f32_bf16 v101, v32, s52, 0
v_dot2_f32_bf16 v102, v33, s51, 0
v_dot2_f32_bf16 v103, v33, s52, 0
v_max3_u32 v98, v34, v35, v98
v_dot2_f32_bf16 v100, v34, s51, v100
v_dot2_f32_bf16 v101, v34, s52, v101
v_dot2_f32_bf16 v102, v35, s51, v102
v_dot2_f32_bf16 v103, v35, s52, v103
v_max3_u32 v98, v36, v37, v98
v_dot2_f32_bf16 v100, v36, s51, v100
v_dot2_f32_bf16 v101, v36, s52, v101
v_dot2_f32_bf16 v102, v37, s51, v102
v_dot2_f32_bf16 v103, v37, s52, v103
v_max3_u32 v98, v38, v39, v98
v_dot2_f32_bf16 v100, v38, s51, v100
v_dot2_f32_bf16 v101, v38, s52, v101
v_dot2_f32_bf16 v102, v39, s51, v102
v_dot2_f32_bf16 v103, v39, s52, v103
s_waitcnt vmcnt(8)
v_max3_u32 v98, v40, v41, v98
v_dot2_f32_bf16 v100, v40, s51, v100
v_dot2_f32_bf16 v101, v40, s52, v101
v_dot2_f32_bf16 v102, v41, s51, v102
v_dot2_f32_bf16 v103, v41, s52, v103
v_max3_u32 v98, v42, v43, v98
v_dot2_f32_bf16 v100, v42, s51, v100
v_dot2_f32_bf16 v101, v42, s52, v101
v_dot2_f32_bf16 v102, v43, s51, v102
v_dot2_f32_bf16 v103, v43, s52, v103
v_max3_u32 v98, v44, v45, v98
v_dot2_f32_bf16 v100, v44, s51, v100
v_dot2_f32_bf16 v101, v44, s52, v101
v_dot2_f32_bf16 v102, v45, s51, v102
v_dot2_f32_bf16 v103, v45, s52, v103
v_max3_u32 v98, v46, v47, v98
v_dot2_f32_bf16 v100, v46, s51, v100
v_dot2_f32_bf16 v101, v46, s52, v101
v_dot2_f32_bf16 v102, v47, s51, v102
v_dot2_f32_bf16 v103, v47, s52, v103
s_waitcnt vmcnt(4)
v_max3_u32 v98, v48, v49, v98
v_dot2_f32_bf16 v100, v48, s51, v100
v_dot2_f32_bf16 v101, v48, s52, v101
v_dot2_f32_bf16 v102, v49, s51, v102
v_dot2_f32_bf16 v103, v49, s52, v103
v_max3_u32 v98, v50, v51, v98
v_dot2_f32_bf16 v100, v50, s51, v100
v_dot2_f32_bf16 v101, v50, s52, v101
v_dot2_f32_bf16 v102, v51, s51, v102
v_dot2_f32_bf16 v103, v51, s52, v103
v_max3_u32 v98, v52, v53, v98
v_dot2_f32_bf16 v100, v52, s51, v100
v_dot2_f32_bf16 v101, v52, s52, v101
v_dot2_f32_bf16 v102, v53, s51, v102
v_dot2_f32_bf16 v103, v53, s52, v103
v_max3_u32 v98, v54, v55, v98
v_dot2_f32_bf16 v100, v54, s51, v100
v_dot2_f32_bf16 v101, v54, s52, v101
v_dot2_f32_bf16 v102, v55, s51, v102
v_dot2_f32_bf16 v103, v55, s52, v103
s_waitcnt vmcnt(0)
v_max3_u32 v98, v56, v57, v98
v_dot2_f32_bf16 v100, v56, s51, v100
v_dot2_f32_bf16 v101, v56, s52, v101
v_dot2_f32_bf16 v102, v57, s51, v102
v_dot2_f32_bf16 v103, v57, s52, v103
v_max3_u32 v98, v58, v59, v98
v_dot2_f32_bf16 v100, v58, s51, v100
v_dot2_f32_bf16 v101, v58, s52, v101
v_dot2_f32_bf16 v102, v59, s51, v102
v_dot2_f32_bf16 v103, v59, s52, v103
v_max3_u32 v98, v60, v61, v98
v_dot2_f32_bf16 v100, v60, s51, v100
v_dot2_f32_bf16 v101, v60, s52, v101
v_dot2_f32_bf16 v102, v61, s51, v102
v_dot2_f32_bf16 v103, v61, s52, v103
v_max3_u32 v98, v62, v63, v98
v_dot2_f32_bf16 v100, v62, s51, v100
v_dot2_f32_bf16 v101, v62, s52, v101
v_dot2_f32_bf16 v102, v63, s51, v102
v_dot2_f32_bf16 v103, v63, s52, v103
v_cmp_eq_u32 vcc, -1, v98
s_cbranch_vccnz L_c_gsl_19
L_c_gok_20:
s_nop 1
v_cvt_pk_bf16_f32 v100, v100, v101
v_cvt_pk_bf16_f32 v101, v102, v103
ds_write_b64 v96, v[100:101]
s_lshl_b32 s51, s38, 2
v_mov_b32 v59, 2
v_mov_b32 v56, 0x26200
v_add_u32 v58, s51, v56
ds_write_b32 v58, v59
L_c_sa_21:
ds_read_b128 v[48:51], v56
ds_read_b128 v[52:55], v56 offset:16
s_add_u32 s66, s66, 1
s_cmp_lt_u32 s66, 0x800000
s_waitcnt lgkmcnt(0)
v_min3_u32 v48, v48, v49, v50
v_min3_u32 v52, v52, v53, v54
v_min3_u32 v48, v48, v51, v55
v_min_u32 v48, v48, v52
v_cmp_gt_u32 vcc, 2, v48
s_cbranch_scc0 L_c_sa_21_x
s_cbranch_vccnz L_c_sa_21
L_c_sa_21_x:
ds_read_b64 v[64:65], v97 offset:0
ds_read_b64 v[70:71], v97 offset:512
ds_read_b64 v[72:73], v97 offset:1024
ds_read_b64 v[78:79], v97 offset:1536
v_mov_b32 v98, 34816
ds_read_b32 v98, v98
s_waitcnt lgkmcnt(1)
v_mfma_f32_16x16x32_bf16 v[40:43], v[72:75], v[116:119], 0
v_mfma_f32_16x16x32_bf16 v[44:47], v[76:79], v[116:119], 0
v_mfma_f32_16x16x32_bf16 v[32:35], v[64:67], v[116:119], 0
v_mfma_f32_16x16x32_bf16 v[36:39], v[68:71], v[116:119], 0
v_mfma_f32_16x16x32_bf16 v[56:59], v[72:75], v[120:123], 0
v_mfma_f32_16x16x32_bf16 v[60:63], v[76:79], v[120:123], 0
v_mfma_f32_16x16x32_bf16 v[48:51], v[64:67], v[120:123], 0
v_mfma_f32_16x16x32_bf16 v[52:55], v[68:71], v[120:123], 0
s_waitcnt lgkmcnt(0)
v_readfirstlane_b32 s39, v98
v_add_f32 v40, s74, v40
v_add_f32 v44, s74, v44
v_rcp_f32 v40, v40
v_rcp_f32 v44, v44
v_pk_mul_f32 v[32:33], v[32:33], v[40:41] op_sel_hi:[1,0]
v_pk_mul_f32 v[34:35], v[34:35], v[40:41] op_sel_hi:[1,0]
v_pk_mul_f32 v[36:37], v[36:37], v[44:45] op_sel_hi:[1,0]
v_pk_mul_f32 v[38:39], v[38:39], v[44:45] op_sel_hi:[1,0]
v_cvt_pk_bf16_f32 v116, v32, v33
v_cvt_pk_bf16_f32 v117, v34, v35
v_cvt_pk_bf16_f32 v118, v36, v37
v_cvt_pk_bf16_f32 v119, v38, v39
v_add_f32 v56, s74, v56
v_add_f32 v60, s74, v60
v_rcp_f32 v56, v56
v_rcp_f32 v60, v60
v_pk_mul_f32 v[48:49], v[48:49], v[56:57] op_sel_hi:[1,0]
v_pk_mul_f32 v[50:51], v[50:51], v[56:57] op_sel_hi:[1,0]
v_pk_mul_f32 v[52:53], v[52:53], v[60:61] op_sel_hi:[1,0]
v_pk_mul_f32 v[54:55], v[54:55], v[60:61] op_sel_hi:[1,0]
v_cvt_pk_bf16_f32 v120, v48, v49
v_cvt_pk_bf16_f32 v121, v50, v51
v_cvt_pk_bf16_f32 v122, v52, v53
v_cvt_pk_bf16_f32 v123, v54, v55
s_cmp_lg_u32 s39, 0
s_cbranch_scc1 L_c_stg_22
s_add_u32 s49, s68, 0x740000
buffer_store_dwordx4 v[116:119], v1, s[4:7], s49 offen offset:0
buffer_store_dwordx4 v[120:123], v1, s[4:7], s49 offen offset:1024
L_c_stb_23:
s_lshl_b32 s51, s46, 13
v_add_u32 v64, s51, v1
v_add_u32 v65, s51, v2
v_add_u32 v66, s51, v3
ds_read_b128 v[16:19], v65 offset:16384
ds_read_b128 v[20:23], v65 offset:17408
ds_read_b128 v[24:27], v65 offset:18432
s_waitcnt vmcnt(0)
v_mov_b32 v6, 1
s_mov_b64 exec, 1
s_cmp_lg_u32 s39, 0
s_cbranch_scc1 L_c_stg_24
buffer_store_dword v6, off, s[4:7], s81  offset:0
L_c_stb_25:
s_mov_b64 exec, -1
buffer_load_dword v98, v5, s[4:7], s57 offen nt
v_lshlrev_b32 v32, 16, v8
v_and_b32 v33, 0xffff0000, v8
v_lshlrev_b32 v34, 16, v9
v_and_b32 v35, 0xffff0000, v9
v_lshlrev_b32 v40, 16, v10
v_and_b32 v41, 0xffff0000, v10
v_lshlrev_b32 v42, 16, v11
v_and_b32 v43, 0xffff0000, v11
v_lshlrev_b32 v36, 16, v12
v_and_b32 v37, 0xffff0000, v12
v_lshlrev_b32 v38, 16, v13
v_and_b32 v39, 0xffff0000, v13
v_lshlrev_b32 v44, 16, v14
v_and_b32 v45, 0xffff0000, v14
v_lshlrev_b32 v46, 16, v15
v_and_b32 v47, 0xffff0000, v15
s_waitcnt vmcnt(0)
v_cmp_gt_u32 vcc, 1, v98
s_cbranch_vccnz L_c_psl_27
L_c_pok_26:
s_add_u32 s100, s55, 0x741000
s_add_u32 s100, s100, s4
s_addc_u32 s101, s5, 0
global_load_dwordx4 a[0:3], v1, s[100:101] offset:-4096 sc1
global_load_dwordx4 a[4:7], v1, s[100:101] offset:-3072 sc1
global_load_dwordx4 a[8:11], v1, s[100:101] offset:-2048 sc1
global_load_dwordx4 a[12:15], v1, s[100:101] offset:-1024 sc1
global_load_dwordx4 a[16:19], v1, s[100:101] offset:0 sc1
global_load_dwordx4 a[20:23], v1, s[100:101] offset:1024 sc1
global_load_dwordx4 a[24:27], v1, s[100:101] offset:2048 sc1
global_load_dwordx4 a[28:31], v1, s[100:101] offset:3072 sc1
s_add_u32 s100, s100, 0x2000
s_addc_u32 s101, s101, 0
global_load_dwordx4 a[32:35], v1, s[100:101] offset:-4096 sc1
global_load_dwordx4 a[36:39], v1, s[100:101] offset:-3072 sc1
global_load_dwordx4 a[40:43], v1, s[100:101] offset:-2048 sc1
global_load_dwordx4 a[44:47], v1, s[100:101] offset:-1024 sc1
s_waitcnt vmcnt(10)
s_waitcnt lgkmcnt(1)
v_mfma_f32_16x16x32_bf16 v[32:35], v[16:19], a[0:3], v[32:35]
ds_read_b128 v[28:31], v65 offset:19456
v_mfma_f32_16x16x32_bf16 v[36:39], v[16:19], a[4:7], v[36:39]
global_load_dwordx4 a[48:51], v1, s[100:101] offset:0 sc1
v_mfma_f32_16x16x32_bf16 v[44:47], v[20:23], a[4:7], v[44:47]
ds_read_b128 v[16:19], v65 offset:20480
v_mfma_f32_16x16x32_bf16 v[40:43], v[20:23], a[0:3], v[40:43]
global_load_dwordx4 a[52:55], v1, s[100:101] offset:1024 sc1
s_waitcnt lgkmcnt(1)
v_mfma_f32_16x16x32_bf16 v[48:51], v[24:27], a[0:3], 0
ds_read_b128 v[20:23], v65 offset:21504
v_mfma_f32_16x16x32_bf16 v[52:55], v[24:27], a[4:7], 0
v_mfma_f32_16x16x32_bf16 v[60:63], v[28:31], a[4:7], 0
ds_read_b128 v[24:27], v65 offset:22528
v_mfma_f32_16x16x32_bf16 v[56:59], v[28:31], a[0:3], 0
s_waitcnt vmcnt(10)
s_waitcnt lgkmcnt(1)
v_mfma_f32_16x16x32_bf16 v[32:35], v[16:19], a[8:11], v[32:35]
ds_read_b128 v[28:31], v65 offset:23552
v_mfma_f32_16x16x32_bf16 v[36:39], v[16:19], a[12:15], v[36:39]
global_load_dwordx4 a[56:59], v1, s[100:101] offset:2048 sc1
v_mfma_f32_16x16x32_bf16 v[44:47], v[20:23], a[12:15], v[44:47]
ds_read_b128 v[16:19], v65 offset:32768
v_mfma_f32_16x16x32_bf16 v[40:43], v[20:23], a[8:11], v[40:43]
global_load_dwordx4 a[60:63], v1, s[100:101] offset:3072 sc1
s_waitcnt lgkmcnt(1)
v_mfma_f32_16x16x32_bf16 v[48:51], v[24:27], a[8:11], v[48:51]
ds_read_b128 v[20:23], v65 offset:33792
v_mfma_f32_16x16x32_bf16 v[52:55], v[24:27], a[12:15], v[52:55]
v_mfma_f32_16x16x32_bf16 v[60:63], v[28:31], a[12:15], v[60:63]
ds_read_b128 v[24:27], v65 offset:34816
v_mfma_f32_16x16x32_bf16 v[56:59], v[28:31], a[8:11], v[56:59]
s_waitcnt vmcnt(10)
s_waitcnt lgkmcnt(1)
v_mfma_f32_16x16x32_bf16 v[32:35], v[16:19], a[16:19], v[32:35]
ds_read_b128 v[28:31], v65 offset:35840
v_mfma_f32_16x16x32_bf16 v[36:39], v[16:19], a[20:23], v[36:39]
v_mfma_f32_16x16x32_bf16 v[44:47], v[20:23], a[20:23], v[44:47]
ds_read_b128 v[16:19], v65 offset:36864
v_mfma_f32_16x16x32_bf16 v[40:43], v[20:23], a[16:19], v[40:43]
s_add_u32 s49, s69, 0x940000
s_bfm_b64 exec, 16, 0
buffer_load_dword v6, v125, s[4:7], s49 offen sc1
s_mov_b64 exec, -1
s_add_u32 s49, s61, 0x1240000
s_bfm_b64 exec, 8, 0
buffer_load_dword v6, v125, s[4:7], s49 offen sc1
s_mov_b64 exec, -1
s_waitcnt lgkmcnt(1)
v_mfma_f32_16x16x32_bf16 v[48:51], v[24:27], a[16:19], v[48:51]
ds_read_b128 v[20:23], v65 offset:37888
v_mfma_f32_16x16x32_bf16 v[52:55], v[24:27], a[20:23], v[52:55]
v_mfma_f32_16x16x32_bf16 v[60:63], v[28:31], a[20:23], v[60:63]
ds_read_b128 v[24:27], v65 offset:38912
v_mfma_f32_16x16x32_bf16 v[56:59], v[28:31], a[16:19], v[56:59]
s_barrier
s_waitcnt vmcnt(10)
s_waitcnt lgkmcnt(1)
v_mfma_f32_16x16x32_bf16 v[32:35], v[16:19], a[24:27], v[32:35]
ds_read_b128 v[28:31], v65 offset:39936
v_mfma_f32_16x16x32_bf16 v[36:39], v[16:19], a[28:31], v[36:39]
v_mfma_f32_16x16x32_bf16 v[44:47], v[20:23], a[28:31], v[44:47]
ds_read_b128 v[16:19], v65 offset:49152
v_mfma_f32_16x16x32_bf16 v[40:43], v[20:23], a[24:27], v[40:43]
s_waitcnt lgkmcnt(1)
v_mfma_f32_16x16x32_bf16 v[48:51], v[24:27], a[24:27], v[48:51]
ds_read_b128 v[20:23], v65 offset:50176
v_mfma_f32_16x16x32_bf16 v[52:55], v[24:27], a[28:31], v[52:55]
v_mfma_f32_16x16x32_bf16 v[60:63], v[28:31], a[28:31], v[60:63]
ds_read_b128 v[24:27], v65 offset:51200
v_mfma_f32_16x16x32_bf16 v[56:59], v[28:31], a[24:27], v[56:59]
s_waitcnt vmcnt(8)
s_waitcnt lgkmcnt(1)
v_mfma_f32_16x16x32_bf16 v[32:35], v[16:19], a[32:35], v[32:35]
ds_read_b128 v[28:31], v65 offset:52224
v_mfma_f32_16x16x32_bf16 v[36:39], v[16:19], a[36:39], v[36:39]
v_mfma_f32_16x16x32_bf16 v[44:47], v[20:23], a[36:39], v[44:47]
ds_read_b128 v[16:19], v65 offset:53248
v_mfma_f32_16x16x32_bf16 v[40:43], v[20:23], a[32:35], v[40:43]
s_waitcnt lgkmcnt(1)
v_mfma_f32_16x16x32_bf16 v[48:51], v[24:27], a[32:35], v[48:51]
ds_read_b128 v[20:23], v65 offset:54272
v_mfma_f32_16x16x32_bf16 v[52:55], v[24:27], a[36:39], v[52:55]
v_mfma_f32_16x16x32_bf16 v[60:63], v[28:31], a[36:39], v[60:63]
ds_read_b128 v[24:27], v65 offset:55296
v_mfma_f32_16x16x32_bf16 v[56:59], v[28:31], a[32:35], v[56:59]
s_waitcnt vmcnt(6)
s_waitcnt lgkmcnt(1)
v_mfma_f32_16x16x32_bf16 v[32:35], v[16:19], a[40:43], v[32:35]
ds_read_b128 v[28:31], v65 offset:56320
v_mfma_f32_16x16x32_bf16 v[36:39], v[16:19], a[44:47], v[36:39]
v_mfma_f32_16x16x32_bf16 v[44:47], v[20:23], a[44:47], v[44:47]
ds_read_b128 v[16:19], v66 offset:2048
v_mfma_f32_16x16x32_bf16 v[40:43], v[20:23], a[40:43], v[40:43]
s_waitcnt lgkmcnt(1)
v_mfma_f32_16x16x32_bf16 v[48:51], v[24:27], a[40:43], v[48:51]
ds_read_b128 v[20:23], v66 offset:3072
v_mfma_f32_16x16x32_bf16 v[52:55], v[24:27], a[44:47], v[52:55]
v_mfma_f32_16x16x32_bf16 v[60:63], v[28:31], a[44:47], v[60:63]
ds_read_b128 v[24:27], v66 offset:6144
v_mfma_f32_16x16x32_bf16 v[56:59], v[28:31], a[40:43], v[56:59]
s_waitcnt vmcnt(4)
s_waitcnt lgkmcnt(1)
v_mfma_f32_16x16x32_bf16 v[48:51], v[16:19], a[48:51], v[48:51]
ds_read_b128 v[28:31], v66 offset:7168
v_mfma_f32_16x16x32_bf16 v[52:55], v[16:19], a[52:55], v[52:55]
v_mfma_f32_16x16x32_bf16 v[60:63], v[20:23], a[52:55], v[60:63]
ds_read_b128 v[16:19], v66 offset:0
v_mfma_f32_16x16x32_bf16 v[56:59], v[20:23], a[48:51], v[56:59]
v_add_u32 v120, s73, v1
s_xor_b32 s51, s73, 0x2000
v_add_u32 v121, s51, v1
s_waitcnt vmcnt(2)
s_waitcnt lgkmcnt(1)
v_mfma_f32_16x16x32_bf16 v[48:51], v[24:27], a[56:59], v[48:51]
ds_read_b128 v[20:23], v66 offset:1024
v_mfma_f32_16x16x32_bf16 v[52:55], v[24:27], a[60:63], v[52:55]
v_mfma_f32_16x16x32_bf16 v[60:63], v[28:31], a[60:63], v[60:63]
ds_read_b128 v[24:27], v66 offset:4096
v_mfma_f32_16x16x32_bf16 v[56:59], v[28:31], a[56:59], v[56:59]
s_waitcnt lgkmcnt(1)
v_mfma_f32_16x16x32_bf16 v[32:35], v[16:19], a[48:51], v[32:35]
ds_read_b128 v[28:31], v66 offset:5120
v_mfma_f32_16x16x32_bf16 v[36:39], v[16:19], a[52:55], v[36:39]
ds_write_b128 v120, v[48:51] offset:0
ds_write_b128 v120, v[52:55] offset:1024
v_mfma_f32_16x16x32_bf16 v[44:47], v[20:23], a[52:55], v[44:47]
v_mfma_f32_16x16x32_bf16 v[40:43], v[20:23], a[48:51], v[40:43]
ds_write_b128 v120, v[56:59] offset:2048
ds_write_b128 v120, v[60:63] offset:3072
s_waitcnt lgkmcnt(4)
v_mfma_f32_16x16x32_bf16 v[32:35], v[24:27], a[56:59], v[32:35]
v_mfma_f32_16x16x32_bf16 v[36:39], v[24:27], a[60:63], v[36:39]
s_waitcnt lgkmcnt(0)
s_barrier
ds_read_b128 v[48:51], v121 offset:0
ds_read_b128 v[52:55], v121 offset:1024
ds_read_b128 v[56:59], v121 offset:2048
ds_read_b128 v[60:63], v121 offset:3072
v_mfma_f32_16x16x32_bf16 v[44:47], v[28:31], a[60:63], v[44:47]
v_mfma_f32_16x16x32_bf16 v[40:43], v[28:31], a[56:59], v[40:43]
s_waitcnt lgkmcnt(1)
v_pk_add_f32 v[32:33], v[32:33], v[48:49]
v_pk_add_f32 v[34:35], v[34:35], v[50:51]
s_nop 4
v_pk_add_f32 v[40:41], v[40:41], v[56:57]
v_pk_add_f32 v[42:43], v[42:43], v[58:59]
v_cvt_pk_bf16_f32 v8, v32, v33
v_cvt_pk_bf16_f32 v9, v34, v35
v_cvt_pk_bf16_f32 v10, v40, v41
v_cvt_pk_bf16_f32 v11, v42, v43
s_waitcnt lgkmcnt(0)
v_pk_add_f32 v[36:37], v[36:37], v[52:53]
v_pk_add_f32 v[38:39], v[38:39], v[54:55]
v_pk_add_f32 v[44:45], v[44:45], v[60:61]
v_pk_add_f32 v[46:47], v[46:47], v[62:63]
v_cvt_pk_bf16_f32 v12, v36, v37
v_cvt_pk_bf16_f32 v13, v38, v39
v_cvt_pk_bf16_f32 v14, v44, v45
v_cvt_pk_bf16_f32 v15, v46, v47
s_cmp_lg_u32 s39, 0
s_cbranch_scc1 L_c_stg_30
s_add_u32 s49, s69, 0x940000
buffer_store_dwordx4 v[8:11], v1, s[4:7], s49 offen offset:0
buffer_store_dwordx4 v[12:15], v1, s[4:7], s49 offen offset:1024
L_c_stb_31:
v_pk_add_f32 v[48:49], v[32:33], v[34:35]
v_pk_mul_f32 v[50:51], v[32:33], v[32:33]
v_pk_add_f32 v[48:49], v[48:49], v[40:41]
v_pk_fma_f32 v[50:51], v[34:35], v[34:35], v[50:51]
v_pk_add_f32 v[48:49], v[48:49], v[42:43]
v_pk_fma_f32 v[50:51], v[40:41], v[40:41], v[50:51]
v_pk_fma_f32 v[50:51], v[42:43], v[42:43], v[50:51]
v_pk_add_f32 v[52:53], v[36:37], v[38:39]
v_pk_mul_f32 v[54:55], v[36:37], v[36:37]
v_pk_add_f32 v[52:53], v[52:53], v[44:45]
v_pk_fma_f32 v[54:55], v[38:39], v[38:39], v[54:55]
v_pk_add_f32 v[52:53], v[52:53], v[46:47]
v_pk_fma_f32 v[54:55], v[44:45], v[44:45], v[54:55]
v_pk_fma_f32 v[54:55], v[46:47], v[46:47], v[54:55]
v_add_f32 v48, v48, v49
v_add_f32 v50, v50, v51
v_add_f32 v52, v52, v53
v_add_f32 v54, v54, v55
s_nop 0
v_permlane32_swap_b32 v48, v52
v_permlane32_swap_b32 v50, v54
v_add_f32 v48, v48, v52
v_add_f32 v50, v50, v54
s_nop 1
v_permlane16_swap_b32 v48, v50
v_add_f32 v48, v48, v50
v_min_u32 v48, -2, v48
s_cmp_lg_u32 s39, 0
s_cbranch_scc1 L_c_stg_32
s_add_u32 s49, s61, 0x1240000
buffer_store_dword v48, v1, s[4:7], s49 offen offset:0
L_c_stb_33:
L_ph3_0:
ds_read_b128 v[16:19], v1 offset:0
ds_read_b128 v[20:23], v1 offset:1024
ds_read_b128 v[24:27], v1 offset:2048
s_waitcnt vmcnt(1)
v_mov_b32 v6, 1
s_mov_b64 exec, 1
s_cmp_lg_u32 s39, 0
s_cbranch_scc1 L_c_stg_34
buffer_store_dword v6, off, s[4:7], s82  offset:0
L_c_stb_35:
s_mov_b64 exec, -1
buffer_load_dword v96, v4, s[4:7], s56 offen nt
s_waitcnt vmcnt(0)
v_cmp_gt_u32 vcc, 1, v96
s_cbranch_vccnz L_c_psl_37
L_c_pok_36:
s_add_u32 s100, s54, 0x941000
s_add_u32 s100, s100, s4
s_addc_u32 s101, s5, 0
global_load_dwordx4 a[0:3], v1, s[100:101] offset:-4096 sc1
global_load_dwordx4 a[4:7], v1, s[100:101] offset:-3072 sc1
global_load_dwordx4 a[8:11], v1, s[100:101] offset:-2048 sc1
global_load_dwordx4 a[12:15], v1, s[100:101] offset:-1024 sc1
global_load_dwordx4 a[16:19], v1, s[100:101] offset:0 sc1
global_load_dwordx4 a[20:23], v1, s[100:101] offset:1024 sc1
global_load_dwordx4 a[24:27], v1, s[100:101] offset:2048 sc1
global_load_dwordx4 a[28:31], v1, s[100:101] offset:3072 sc1
s_add_u32 s100, s100, 0x2000
s_addc_u32 s101, s101, 0
global_load_dwordx4 a[32:35], v1, s[100:101] offset:-4096 sc1
global_load_dwordx4 a[36:39], v1, s[100:101] offset:-3072 sc1
global_load_dwordx4 a[40:43], v1, s[100:101] offset:-2048 sc1
global_load_dwordx4 a[44:47], v1, s[100:101] offset:-1024 sc1
s_waitcnt vmcnt(10)
s_waitcnt lgkmcnt(1)
v_mfma_f32_16x16x32_bf16 v[32:35], v[16:19], a[0:3], 0
ds_read_b128 v[28:31], v1 offset:3072
v_mfma_f32_16x16x32_bf16 v[36:39], v[16:19], a[4:7], 0
global_load_dwordx4 a[48:51], v1, s[100:101] offset:0 sc1
v_mfma_f32_16x16x32_bf16 v[44:47], v[20:23], a[4:7], 0
ds_read_b128 v[16:19], v1 offset:4096
v_mfma_f32_16x16x32_bf16 v[40:43], v[20:23], a[0:3], 0
global_load_dwordx4 a[52:55], v1, s[100:101] offset:1024 sc1
s_waitcnt lgkmcnt(1)
v_mfma_f32_16x16x32_bf16 v[48:51], v[24:27], a[0:3], 0
ds_read_b128 v[20:23], v1 offset:5120
v_mfma_f32_16x16x32_bf16 v[52:55], v[24:27], a[4:7], 0
v_mfma_f32_16x16x32_bf16 v[60:63], v[28:31], a[4:7], 0
ds_read_b128 v[24:27], v1 offset:6144
v_mfma_f32_16x16x32_bf16 v[56:59], v[28:31], a[0:3], 0
s_waitcnt vmcnt(10)
s_waitcnt lgkmcnt(1)
v_mfma_f32_16x16x32_bf16 v[32:35], v[16:19], a[8:11], v[32:35]
ds_read_b128 v[28:31], v1 offset:7168
v_mfma_f32_16x16x32_bf16 v[36:39], v[16:19], a[12:15], v[36:39]
global_load_dwordx4 a[56:59], v1, s[100:101] offset:2048 sc1
v_mfma_f32_16x16x32_bf16 v[44:47], v[20:23], a[12:15], v[44:47]
ds_read_b128 v[16:19], v1 offset:8192
v_mfma_f32_16x16x32_bf16 v[40:43], v[20:23], a[8:11], v[40:43]
global_load_dwordx4 a[60:63], v1, s[100:101] offset:3072 sc1
s_waitcnt lgkmcnt(1)
v_mfma_f32_16x16x32_bf16 v[48:51], v[24:27], a[8:11], v[48:51]
ds_read_b128 v[20:23], v1 offset:9216
v_mfma_f32_16x16x32_bf16 v[52:55], v[24:27], a[12:15], v[52:55]
v_mfma_f32_16x16x32_bf16 v[60:63], v[28:31], a[12:15], v[60:63]
ds_read_b128 v[24:27], v1 offset:10240
v_mfma_f32_16x16x32_bf16 v[56:59], v[28:31], a[8:11], v[56:59]
s_waitcnt vmcnt(10)
s_waitcnt lgkmcnt(1)
v_mfma_f32_16x16x32_bf16 v[32:35], v[16:19], a[16:19], v[32:35]
ds_read_b128 v[28:31], v1 offset:11264
v_mfma_f32_16x16x32_bf16 v[36:39], v[16:19], a[20:23], v[36:39]
s_add_u32 s100, s100, 0x2000
s_addc_u32 s101, s101, 0
global_load_dwordx4 a[64:67], v1, s[100:101] offset:-4096 sc1
v_mfma_f32_16x16x32_bf16 v[44:47], v[20:23], a[20:23], v[44:47]
ds_read_b128 v[16:19], v1 offset:12288
v_mfma_f32_16x16x32_bf16 v[40:43], v[20:23], a[16:19], v[40:43]
global_load_dwordx4 a[68:71], v1, s[100:101] offset:-3072 sc1
s_waitcnt lgkmcnt(1)
v_mfma_f32_16x16x32_bf16 v[48:51], v[24:27], a[16:19], v[48:51]
ds_read_b128 v[20:23], v1 offset:13312
v_mfma_f32_16x16x32_bf16 v[52:55], v[24:27], a[20:23], v[52:55]
v_mfma_f32_16x16x32_bf16 v[60:63], v[28:31], a[20:23], v[60:63]
ds_read_b128 v[24:27], v1 offset:14336
v_mfma_f32_16x16x32_bf16 v[56:59], v[28:31], a[16:19], v[56:59]
s_barrier
s_waitcnt vmcnt(10)
s_waitcnt lgkmcnt(1)
v_mfma_f32_16x16x32_bf16 v[32:35], v[16:19], a[24:27], v[32:35]
ds_read_b128 v[28:31], v1 offset:15360
v_mfma_f32_16x16x32_bf16 v[36:39], v[16:19], a[28:31], v[36:39]
global_load_dwordx4 a[72:75], v1, s[100:101] offset:-2048 sc1
v_mfma_f32_16x16x32_bf16 v[44:47], v[20:23], a[28:31], v[44:47]
ds_read_b128 v[16:19], v1 offset:16384
v_mfma_f32_16x16x32_bf16 v[40:43], v[20:23], a[24:27], v[40:43]
global_load_dwordx4 a[76:79], v1, s[100:101] offset:-1024 sc1
s_waitcnt lgkmcnt(1)
v_mfma_f32_16x16x32_bf16 v[48:51], v[24:27], a[24:27], v[48:51]
ds_read_b128 v[20:23], v1 offset:17408
v_mfma_f32_16x16x32_bf16 v[52:55], v[24:27], a[28:31], v[52:55]
v_mfma_f32_16x16x32_bf16 v[60:63], v[28:31], a[28:31], v[60:63]
ds_read_b128 v[24:27], v1 offset:18432
v_mfma_f32_16x16x32_bf16 v[56:59], v[28:31], a[24:27], v[56:59]
s_waitcnt vmcnt(10)
s_waitcnt lgkmcnt(1)
v_mfma_f32_16x16x32_bf16 v[32:35], v[16:19], a[32:35], v[32:35]
ds_read_b128 v[28:31], v1 offset:19456
v_mfma_f32_16x16x32_bf16 v[36:39], v[16:19], a[36:39], v[36:39]
global_load_dwordx4 a[80:83], v1, s[100:101] offset:0 sc1
v_mfma_f32_16x16x32_bf16 v[44:47], v[20:23], a[36:39], v[44:47]
ds_read_b128 v[16:19], v1 offset:20480
v_mfma_f32_16x16x32_bf16 v[40:43], v[20:23], a[32:35], v[40:43]
global_load_dwordx4 a[84:87], v1, s[100:101] offset:1024 sc1
s_waitcnt lgkmcnt(1)
v_mfma_f32_16x16x32_bf16 v[48:51], v[24:27], a[32:35], v[48:51]
ds_read_b128 v[20:23], v1 offset:21504
v_mfma_f32_16x16x32_bf16 v[52:55], v[24:27], a[36:39], v[52:55]
v_mfma_f32_16x16x32_bf16 v[60:63], v[28:31], a[36:39], v[60:63]
ds_read_b128 v[24:27], v1 offset:22528
v_mfma_f32_16x16x32_bf16 v[56:59], v[28:31], a[32:35], v[56:59]
s_waitcnt vmcnt(10)
s_waitcnt lgkmcnt(1)
v_mfma_f32_16x16x32_bf16 v[32:35], v[16:19], a[40:43], v[32:35]
ds_read_b128 v[28:31], v1 offset:23552
v_mfma_f32_16x16x32_bf16 v[36:39], v[16:19], a[44:47], v[36:39]
global_load_dwordx4 a[88:91], v1, s[100:101] offset:2048 sc1
v_mfma_f32_16x16x32_bf16 v[44:47], v[20:23], a[44:47], v[44:47]
ds_read_b128 v[16:19], v1 offset:24576
v_mfma_f32_16x16x32_bf16 v[40:43], v[20:23], a[40:43], v[40:43]
global_load_dwordx4 a[92:95], v1, s[100:101] offset:3072 sc1
s_waitcnt lgkmcnt(1)
v_mfma_f32_16x16x32_bf16 v[48:51], v[24:27], a[40:43], v[48:51]
ds_read_b128 v[20:23], v1 offset:25600
v_mfma_f32_16x16x32_bf16 v[52:55], v[24:27], a[44:47], v[52:55]
s_add_u32 s100, s60, 0x1241000
s_add_u32 s100, s100, s4
s_addc_u32 s101, s5, 0
global_load_dwordx4 v[80:83], v1, s[100:101] offset:-4096 sc1
v_mfma_f32_16x16x32_bf16 v[60:63], v[28:31], a[44:47], v[60:63]
ds_read_b128 v[24:27], v1 offset:26624
v_mfma_f32_16x16x32_bf16 v[56:59], v[28:31], a[40:43], v[56:59]
s_waitcnt vmcnt(11)
s_waitcnt lgkmcnt(1)
v_mfma_f32_16x16x32_bf16 v[32:35], v[16:19], a[48:51], v[32:35]
ds_read_b128 v[28:31], v1 offset:27648
v_mfma_f32_16x16x32_bf16 v[36:39], v[16:19], a[52:55], v[36:39]
global_load_dwordx4 v[84:87], v1, s[100:101] offset:-3072 sc1
v_mfma_f32_16x16x32_bf16 v[44:47], v[20:23], a[52:55], v[44:47]
ds_read_b128 v[16:19], v1 offset:28672
v_mfma_f32_16x16x32_bf16 v[40:43], v[20:23], a[48:51], v[40:43]
global_load_dwordx4 v[88:91], v1, s[100:101] offset:-2048 sc1
s_waitcnt lgkmcnt(1)
v_mfma_f32_16x16x32_bf16 v[48:51], v[24:27], a[48:51], v[48:51]
ds_read_b128 v[20:23], v1 offset:29696
v_mfma_f32_16x16x32_bf16 v[52:55], v[24:27], a[52:55], v[52:55]
global_load_dwordx4 v[92:95], v1, s[100:101] offset:-1024 sc1
v_mfma_f32_16x16x32_bf16 v[60:63], v[28:31], a[52:55], v[60:63]
ds_read_b128 v[24:27], v1 offset:30720
v_mfma_f32_16x16x32_bf16 v[56:59], v[28:31], a[48:51], v[56:59]
s_barrier
s_waitcnt vmcnt(12)
s_waitcnt lgkmcnt(1)
v_mfma_f32_16x16x32_bf16 v[32:35], v[16:19], a[56:59], v[32:35]
ds_read_b128 v[28:31], v1 offset:31744
v_mfma_f32_16x16x32_bf16 v[36:39], v[16:19], a[60:63], v[36:39]
s_add_u32 s100, s54, 0x947000
s_add_u32 s100, s100, s4
s_addc_u32 s101, s5, 0
global_load_dwordx4 a[96:99], v1, s[100:101] offset:-4096 sc1
v_mfma_f32_16x16x32_bf16 v[44:47], v[20:23], a[60:63], v[44:47]
ds_read_b128 v[16:19], v1 offset:32768
v_mfma_f32_16x16x32_bf16 v[40:43], v[20:23], a[56:59], v[40:43]
global_load_dwordx4 a[100:103], v1, s[100:101] offset:-3072 sc1
s_waitcnt lgkmcnt(1)
v_mfma_f32_16x16x32_bf16 v[48:51], v[24:27], a[56:59], v[48:51]
ds_read_b128 v[20:23], v1 offset:33792
v_mfma_f32_16x16x32_bf16 v[52:55], v[24:27], a[60:63], v[52:55]
v_mfma_f32_16x16x32_bf16 v[60:63], v[28:31], a[60:63], v[60:63]
ds_read_b128 v[24:27], v1 offset:34816
v_mfma_f32_16x16x32_bf16 v[56:59], v[28:31], a[56:59], v[56:59]
s_waitcnt vmcnt(12)
s_waitcnt lgkmcnt(1)
v_mfma_f32_16x16x32_bf16 v[32:35], v[16:19], a[64:67], v[32:35]
ds_read_b128 v[28:31], v1 offset:35840
v_mfma_f32_16x16x32_bf16 v[36:39], v[16:19], a[68:71], v[36:39]
global_load_dwordx4 a[104:107], v1, s[100:101] offset:-2048 sc1
v_mfma_f32_16x16x32_bf16 v[44:47], v[20:23], a[68:71], v[44:47]
ds_read_b128 v[16:19], v1 offset:36864
v_mfma_f32_16x16x32_bf16 v[40:43], v[20:23], a[64:67], v[40:43]
global_load_dwordx4 a[108:111], v1, s[100:101] offset:-1024 sc1
s_waitcnt lgkmcnt(1)
v_mfma_f32_16x16x32_bf16 v[48:51], v[24:27], a[64:67], v[48:51]
ds_read_b128 v[20:23], v1 offset:37888
v_mfma_f32_16x16x32_bf16 v[52:55], v[24:27], a[68:71], v[52:55]
v_mfma_f32_16x16x32_bf16 v[60:63], v[28:31], a[68:71], v[60:63]
ds_read_b128 v[24:27], v1 offset:38912
v_mfma_f32_16x16x32_bf16 v[56:59], v[28:31], a[64:67], v[56:59]
s_waitcnt vmcnt(12)
s_waitcnt lgkmcnt(1)
v_mfma_f32_16x16x32_bf16 v[32:35], v[16:19], a[72:75], v[32:35]
ds_read_b128 v[28:31], v1 offset:39936
v_mfma_f32_16x16x32_bf16 v[36:39], v[16:19], a[76:79], v[36:39]
global_load_dwordx4 a[112:115], v1, s[100:101] offset:0 sc1
v_mfma_f32_16x16x32_bf16 v[44:47], v[20:23], a[76:79], v[44:47]
ds_read_b128 v[16:19], v1 offset:40960
v_mfma_f32_16x16x32_bf16 v[40:43], v[20:23], a[72:75], v[40:43]
global_load_dwordx4 a[116:119], v1, s[100:101] offset:1024 sc1
s_waitcnt lgkmcnt(1)
v_mfma_f32_16x16x32_bf16 v[48:51], v[24:27], a[72:75], v[48:51]
ds_read_b128 v[20:23], v1 offset:41984
v_mfma_f32_16x16x32_bf16 v[52:55], v[24:27], a[76:79], v[52:55]
v_mfma_f32_16x16x32_bf16 v[60:63], v[28:31], a[76:79], v[60:63]
ds_read_b128 v[24:27], v1 offset:43008
v_mfma_f32_16x16x32_bf16 v[56:59], v[28:31], a[72:75], v[56:59]
s_waitcnt vmcnt(12)
s_waitcnt lgkmcnt(1)
v_mfma_f32_16x16x32_bf16 v[32:35], v[16:19], a[80:83], v[32:35]
ds_read_b128 v[28:31], v1 offset:44032
v_mfma_f32_16x16x32_bf16 v[36:39], v[16:19], a[84:87], v[36:39]
global_load_dwordx4 a[120:123], v1, s[100:101] offset:2048 sc1
v_mfma_f32_16x16x32_bf16 v[44:47], v[20:23], a[84:87], v[44:47]
ds_read_b128 v[16:19], v1 offset:45056
v_mfma_f32_16x16x32_bf16 v[40:43], v[20:23], a[80:83], v[40:43]
global_load_dwordx4 a[124:127], v1, s[100:101] offset:3072 sc1
s_waitcnt lgkmcnt(1)
v_mfma_f32_16x16x32_bf16 v[48:51], v[24:27], a[80:83], v[48:51]
ds_read_b128 v[20:23], v1 offset:46080
v_mfma_f32_16x16x32_bf16 v[52:55], v[24:27], a[84:87], v[52:55]
v_mfma_f32_16x16x32_bf16 v[60:63], v[28:31], a[84:87], v[60:63]
ds_read_b128 v[24:27], v1 offset:47104
v_mfma_f32_16x16x32_bf16 v[56:59], v[28:31], a[80:83], v[56:59]
s_barrier
s_waitcnt vmcnt(12)
s_waitcnt lgkmcnt(1)
v_mfma_f32_16x16x32_bf16 v[32:35], v[16:19], a[88:91], v[32:35]
ds_read_b128 v[28:31], v1 offset:48128
v_mfma_f32_16x16x32_bf16 v[36:39], v[16:19], a[92:95], v[36:39]
v_mfma_f32_16x16x32_bf16 v[44:47], v[20:23], a[92:95], v[44:47]
ds_read_b128 v[16:19], v1 offset:49152
v_mfma_f32_16x16x32_bf16 v[40:43], v[20:23], a[88:91], v[40:43]
s_waitcnt lgkmcnt(1)
v_mfma_f32_16x16x32_bf16 v[48:51], v[24:27], a[88:91], v[48:51]
ds_read_b128 v[20:23], v1 offset:50176
v_mfma_f32_16x16x32_bf16 v[52:55], v[24:27], a[92:95], v[52:55]
v_mfma_f32_16x16x32_bf16 v[60:63], v[28:31], a[92:95], v[60:63]
ds_read_b128 v[24:27], v1 offset:51200
v_mfma_f32_16x16x32_bf16 v[56:59], v[28:31], a[88:91], v[56:59]
s_waitcnt vmcnt(6)
s_waitcnt lgkmcnt(1)
v_mfma_f32_16x16x32_bf16 v[32:35], v[16:19], a[96:99], v[32:35]
ds_read_b128 v[28:31], v1 offset:52224
v_max3_u32 v96, v80, v81, v82
v_mfma_f32_16x16x32_bf16 v[36:39], v[16:19], a[100:103], v[36:39]
v_max3_u32 v96, v96, v83, v84
v_mfma_f32_16x16x32_bf16 v[44:47], v[20:23], a[100:103], v[44:47]
ds_read_b128 v[16:19], v1 offset:53248
v_max3_u32 v96, v96, v85, v86
v_mfma_f32_16x16x32_bf16 v[40:43], v[20:23], a[96:99], v[40:43]
v_max3_u32 v96, v96, v87, v88
s_waitcnt lgkmcnt(1)
v_mfma_f32_16x16x32_bf16 v[48:51], v[24:27], a[96:99], v[48:51]
ds_read_b128 v[20:23], v1 offset:54272
v_max3_u32 v96, v96, v89, v90
v_mfma_f32_16x16x32_bf16 v[52:55], v[24:27], a[100:103], v[52:55]
v_max3_u32 v96, v96, v91, v92
v_mfma_f32_16x16x32_bf16 v[60:63], v[28:31], a[100:103], v[60:63]
ds_read_b128 v[24:27], v1 offset:55296
v_max3_u32 v96, v96, v93, v94
v_mfma_f32_16x16x32_bf16 v[56:59], v[28:31], a[96:99], v[56:59]
v_max_u32 v96, v96, v95
v_cmp_eq_u32 vcc, -1, v96
s_cbranch_vccnz L_c_tsl_40
L_c_tok_41:
v_pk_add_f32 v[80:81], v[80:81], v[84:85]
s_waitcnt vmcnt(4)
s_waitcnt lgkmcnt(1)
v_mfma_f32_16x16x32_bf16 v[32:35], v[16:19], a[104:107], v[32:35]
ds_read_b128 v[28:31], v1 offset:56320
v_pk_add_f32 v[88:89], v[88:89], v[92:93]
v_mfma_f32_16x16x32_bf16 v[36:39], v[16:19], a[108:111], v[36:39]
v_pk_add_f32 v[82:83], v[82:83], v[86:87]
v_pk_add_f32 v[90:91], v[90:91], v[94:95]
v_mfma_f32_16x16x32_bf16 v[44:47], v[20:23], a[108:111], v[44:47]
ds_read_b128 v[16:19], v1 offset:57344
v_pk_add_f32 v[80:81], v[80:81], v[82:83]
v_mfma_f32_16x16x32_bf16 v[40:43], v[20:23], a[104:107], v[40:43]
v_pk_add_f32 v[88:89], v[88:89], v[90:91]
s_waitcnt lgkmcnt(1)
v_mfma_f32_16x16x32_bf16 v[48:51], v[24:27], a[104:107], v[48:51]
ds_read_b128 v[20:23], v1 offset:58368
v_pk_add_f32 v[80:81], v[80:81], v[88:89]
v_mfma_f32_16x16x32_bf16 v[52:55], v[24:27], a[108:111], v[52:55]
v_add_f32 v80, v80, v81
v_mfma_f32_16x16x32_bf16 v[60:63], v[28:31], a[108:111], v[60:63]
ds_read_b128 v[24:27], v1 offset:59392
v_mul_f32 v80, 0x3b000000, v80
v_mfma_f32_16x16x32_bf16 v[56:59], v[28:31], a[104:107], v[56:59]
v_mov_b32 v81, v80
s_waitcnt vmcnt(2)
s_waitcnt lgkmcnt(1)
v_mfma_f32_16x16x32_bf16 v[32:35], v[16:19], a[112:115], v[32:35]
ds_read_b128 v[28:31], v1 offset:60416
s_nop 1
v_mfma_f32_16x16x32_bf16 v[36:39], v[16:19], a[116:119], v[36:39]
v_permlane16_swap_b32 v80, v81
v_mfma_f32_16x16x32_bf16 v[44:47], v[20:23], a[116:119], v[44:47]
ds_read_b128 v[16:19], v1 offset:61440
v_fma_f32 v81, -v80, v80, v81
v_mfma_f32_16x16x32_bf16 v[40:43], v[20:23], a[112:115], v[40:43]
v_max_f32 v81, 0, v81
s_waitcnt lgkmcnt(1)
v_mfma_f32_16x16x32_bf16 v[48:51], v[24:27], a[112:115], v[48:51]
ds_read_b128 v[20:23], v1 offset:62464
v_add_f32 v81, 0x3727c5ac, v81
v_mfma_f32_16x16x32_bf16 v[52:55], v[24:27], a[116:119], v[52:55]
v_rsq_f32 v96, v81
v_mfma_f32_16x16x32_bf16 v[60:63], v[28:31], a[116:119], v[60:63]
ds_read_b128 v[24:27], v1 offset:63488
v_mfma_f32_16x16x32_bf16 v[56:59], v[28:31], a[112:115], v[56:59]
s_barrier
s_waitcnt vmcnt(0)
s_waitcnt lgkmcnt(1)
v_mfma_f32_16x16x32_bf16 v[32:35], v[16:19], a[120:123], v[32:35]
ds_read_b128 v[28:31], v1 offset:64512
v_mfma_f32_16x16x32_bf16 v[36:39], v[16:19], a[124:127], v[36:39]
v_sqrt_f32 v98, v81
s_nop 0
v_mfma_f32_16x16x32_bf16 v[44:47], v[20:23], a[124:127], v[44:47]
ds_read_b128 v[16:19], v2 offset:0
v_mov_b32 v99, v98
v_mfma_f32_16x16x32_bf16 v[40:43], v[20:23], a[120:123], v[40:43]
v_mul_f32 v96, 0xbfb8aa3b, v96
s_waitcnt lgkmcnt(1)
v_mfma_f32_16x16x32_bf16 v[48:51], v[24:27], a[120:123], v[48:51]
ds_read_b128 v[20:23], v2 offset:1024
v_mov_b32 v97, v96
v_mfma_f32_16x16x32_bf16 v[52:55], v[24:27], a[124:127], v[52:55]
s_nop 1
v_permlane32_swap_b32 v96, v97
v_permlane32_swap_b32 v98, v99
v_mfma_f32_16x16x32_bf16 v[60:63], v[28:31], a[124:127], v[60:63]
ds_read_b128 v[24:27], v2 offset:2048
v_mfma_f32_16x16x32_bf16 v[56:59], v[28:31], a[120:123], v[56:59]
s_waitcnt lgkmcnt(1)
v_mfma_f32_16x16x32_bf16 v[64:67], v[16:19], a[0:3], 0
ds_read_b128 v[28:31], v2 offset:3072
v_mfma_f32_16x16x32_bf16 v[68:71], v[16:19], a[4:7], 0
v_mfma_f32_16x16x32_bf16 v[76:79], v[20:23], a[4:7], 0
ds_read_b128 v[16:19], v2 offset:4096
v_mul_f32 v32, v32, v96
v_mfma_f32_16x16x32_bf16 v[72:75], v[20:23], a[0:3], 0
v_exp_f32 v32, v32
s_waitcnt lgkmcnt(1)
v_mfma_f32_16x16x32_bf16 v[80:83], v[24:27], a[0:3], 0
ds_read_b128 v[20:23], v2 offset:5120
v_mul_f32 v33, v33, v96
v_mfma_f32_16x16x32_bf16 v[84:87], v[24:27], a[4:7], 0
v_fma_f32 v32, v32, v98, v98
v_exp_f32 v33, v33
v_mfma_f32_16x16x32_bf16 v[92:95], v[28:31], a[4:7], 0
ds_read_b128 v[24:27], v2 offset:6144
v_mul_f32 v34, v34, v96
v_mfma_f32_16x16x32_bf16 v[88:91], v[28:31], a[0:3], 0
v_fma_f32 v33, v33, v98, v98
s_waitcnt lgkmcnt(1)
v_mfma_f32_16x16x32_bf16 v[64:67], v[16:19], a[8:11], v[64:67]
ds_read_b128 v[28:31], v2 offset:7168
v_mul_f32 v35, v35, v96
v_mfma_f32_16x16x32_bf16 v[68:71], v[16:19], a[12:15], v[68:71]
v_rcp_f32 v32, v32
v_mfma_f32_16x16x32_bf16 v[76:79], v[20:23], a[12:15], v[76:79]
ds_read_b128 v[16:19], v2 offset:8192
v_mul_f32 v40, v40, v32
v_mfma_f32_16x16x32_bf16 v[72:75], v[20:23], a[8:11], v[72:75]
v_mul_f32 v48, v48, v96
s_waitcnt lgkmcnt(1)
v_mfma_f32_16x16x32_bf16 v[80:83], v[24:27], a[8:11], v[80:83]
ds_read_b128 v[20:23], v2 offset:9216
v_mfma_f32_16x16x32_bf16 v[84:87], v[24:27], a[12:15], v[84:87]
v_exp_f32 v34, v34
v_mfma_f32_16x16x32_bf16 v[92:95], v[28:31], a[12:15], v[92:95]
ds_read_b128 v[24:27], v2 offset:10240
v_fma_f32 v34, v34, v98, v98
v_mfma_f32_16x16x32_bf16 v[88:91], v[28:31], a[8:11], v[88:91]
s_waitcnt lgkmcnt(1)
v_mfma_f32_16x16x32_bf16 v[64:67], v[16:19], a[16:19], v[64:67]
ds_read_b128 v[28:31], v2 offset:11264
v_mfma_f32_16x16x32_bf16 v[68:71], v[16:19], a[20:23], v[68:71]
v_rcp_f32 v33, v33
v_mfma_f32_16x16x32_bf16 v[76:79], v[20:23], a[20:23], v[76:79]
ds_read_b128 v[16:19], v2 offset:12288
v_mul_f32 v41, v41, v33
v_mfma_f32_16x16x32_bf16 v[72:75], v[20:23], a[16:19], v[72:75]
v_mul_f32 v49, v49, v96
s_waitcnt lgkmcnt(1)
v_mfma_f32_16x16x32_bf16 v[80:83], v[24:27], a[16:19], v[80:83]
ds_read_b128 v[20:23], v2 offset:13312
v_cvt_pk_bf16_f32 v104, v40, v41
v_mfma_f32_16x16x32_bf16 v[84:87], v[24:27], a[20:23], v[84:87]
v_exp_f32 v35, v35
v_mfma_f32_16x16x32_bf16 v[92:95], v[28:31], a[20:23], v[92:95]
ds_read_b128 v[24:27], v2 offset:14336
v_fma_f32 v35, v35, v98, v98
v_mfma_f32_16x16x32_bf16 v[88:91], v[28:31], a[16:19], v[88:91]
s_waitcnt lgkmcnt(1)
v_mfma_f32_16x16x32_bf16 v[64:67], v[16:19], a[24:27], v[64:67]
ds_read_b128 v[28:31], v2 offset:15360
v_mfma_f32_16x16x32_bf16 v[68:71], v[16:19], a[28:31], v[68:71]
v_rcp_f32 v34, v34
v_mfma_f32_16x16x32_bf16 v[76:79], v[20:23], a[28:31], v[76:79]
ds_read_b128 v[16:19], v2 offset:16384
v_mul_f32 v42, v42, v34
v_mfma_f32_16x16x32_bf16 v[72:75], v[20:23], a[24:27], v[72:75]
v_mul_f32 v50, v50, v96
s_waitcnt lgkmcnt(1)
v_mfma_f32_16x16x32_bf16 v[80:83], v[24:27], a[24:27], v[80:83]
ds_read_b128 v[20:23], v2 offset:17408
v_mfma_f32_16x16x32_bf16 v[84:87], v[24:27], a[28:31], v[84:87]
v_exp_f32 v48, v48
v_mfma_f32_16x16x32_bf16 v[92:95], v[28:31], a[28:31], v[92:95]
ds_read_b128 v[24:27], v2 offset:18432
v_fma_f32 v48, v48, v98, v98
v_mfma_f32_16x16x32_bf16 v[88:91], v[28:31], a[24:27], v[88:91]
s_waitcnt lgkmcnt(1)
v_mfma_f32_16x16x32_bf16 v[64:67], v[16:19], a[32:35], v[64:67]
ds_read_b128 v[28:31], v2 offset:19456
v_mfma_f32_16x16x32_bf16 v[68:71], v[16:19], a[36:39], v[68:71]
v_rcp_f32 v35, v35
v_mfma_f32_16x16x32_bf16 v[76:79], v[20:23], a[36:39], v[76:79]
ds_read_b128 v[16:19], v2 offset:20480
v_mul_f32 v43, v43, v35
v_mfma_f32_16x16x32_bf16 v[72:75], v[20:23], a[32:35], v[72:75]
v_mul_f32 v51, v51, v96
s_waitcnt lgkmcnt(1)
v_mfma_f32_16x16x32_bf16 v[80:83], v[24:27], a[32:35], v[80:83]
ds_read_b128 v[20:23], v2 offset:21504
v_cvt_pk_bf16_f32 v105, v42, v43
v_mfma_f32_16x16x32_bf16 v[84:87], v[24:27], a[36:39], v[84:87]
v_exp_f32 v49, v49
v_mfma_f32_16x16x32_bf16 v[92:95], v[28:31], a[36:39], v[92:95]
ds_read_b128 v[24:27], v2 offset:22528
v_fma_f32 v49, v49, v98, v98
v_mfma_f32_16x16x32_bf16 v[88:91], v[28:31], a[32:35], v[88:91]
s_waitcnt lgkmcnt(1)
v_mfma_f32_16x16x32_bf16 v[64:67], v[16:19], a[40:43], v[64:67]
ds_read_b128 v[28:31], v2 offset:23552
v_mfma_f32_16x16x32_bf16 v[68:71], v[16:19], a[44:47], v[68:71]
v_rcp_f32 v48, v48
v_mfma_f32_16x16x32_bf16 v[76:79], v[20:23], a[44:47], v[76:79]
ds_read_b128 v[16:19], v2 offset:24576
v_mul_f32 v56, v56, v48
v_mfma_f32_16x16x32_bf16 v[72:75], v[20:23], a[40:43], v[72:75]
v_mul_f32 v36, v36, v97
s_waitcnt lgkmcnt(1)
v_mfma_f32_16x16x32_bf16 v[80:83], v[24:27], a[40:43], v[80:83]
ds_read_b128 v[20:23], v2 offset:25600
v_mfma_f32_16x16x32_bf16 v[84:87], v[24:27], a[44:47], v[84:87]
v_exp_f32 v50, v50
v_mfma_f32_16x16x32_bf16 v[92:95], v[28:31], a[44:47], v[92:95]
ds_read_b128 v[24:27], v2 offset:26624
v_fma_f32 v50, v50, v98, v98
v_mfma_f32_16x16x32_bf16 v[88:91], v[28:31], a[40:43], v[88:91]
s_waitcnt lgkmcnt(1)
v_mfma_f32_16x16x32_bf16 v[64:67], v[16:19], a[48:51], v[64:67]
ds_read_b128 v[28:31], v2 offset:27648
v_mfma_f32_16x16x32_bf16 v[68:71], v[16:19], a[52:55], v[68:71]
v_rcp_f32 v49, v49
v_mul_f32 v37, v37, v97
v_mfma_f32_16x16x32_bf16 v[76:79], v[20:23], a[52:55], v[76:79]
ds_read_b128 v[16:19], v2 offset:28672
v_mul_f32 v57, v57, v49
v_mfma_f32_16x16x32_bf16 v[72:75], v[20:23], a[48:51], v[72:75]
v_cvt_pk_bf16_f32 v106, v56, v57
s_waitcnt lgkmcnt(1)
v_mfma_f32_16x16x32_bf16 v[80:83], v[24:27], a[48:51], v[80:83]
ds_read_b128 v[20:23], v2 offset:29696
v_mfma_f32_16x16x32_bf16 v[84:87], v[24:27], a[52:55], v[84:87]
v_exp_f32 v51, v51
v_mfma_f32_16x16x32_bf16 v[92:95], v[28:31], a[52:55], v[92:95]
ds_read_b128 v[24:27], v2 offset:30720
v_fma_f32 v51, v51, v98, v98
v_mfma_f32_16x16x32_bf16 v[88:91], v[28:31], a[48:51], v[88:91]
s_barrier
s_waitcnt lgkmcnt(1)
v_mfma_f32_16x16x32_bf16 v[64:67], v[16:19], a[56:59], v[64:67]
ds_read_b128 v[28:31], v2 offset:31744
v_mfma_f32_16x16x32_bf16 v[68:71], v[16:19], a[60:63], v[68:71]
v_rcp_f32 v50, v50
v_mul_f32 v38, v38, v97
v_mfma_f32_16x16x32_bf16 v[76:79], v[20:23], a[60:63], v[76:79]
ds_read_b128 v[16:19], v2 offset:32768
v_mul_f32 v58, v58, v50
v_mfma_f32_16x16x32_bf16 v[72:75], v[20:23], a[56:59], v[72:75]
s_waitcnt lgkmcnt(1)
v_mfma_f32_16x16x32_bf16 v[80:83], v[24:27], a[56:59], v[80:83]
ds_read_b128 v[20:23], v2 offset:33792
v_mfma_f32_16x16x32_bf16 v[84:87], v[24:27], a[60:63], v[84:87]
v_exp_f32 v36, v36
v_mfma_f32_16x16x32_bf16 v[92:95], v[28:31], a[60:63], v[92:95]
ds_read_b128 v[24:27], v2 offset:34816
v_fma_f32 v36, v36, v99, v99
v_mfma_f32_16x16x32_bf16 v[88:91], v[28:31], a[56:59], v[88:91]
v_rcp_f32 v51, v51
s_waitcnt lgkmcnt(1)
v_mfma_f32_16x16x32_bf16 v[64:67], v[16:19], a[64:67], v[64:67]
ds_read_b128 v[28:31], v2 offset:35840
v_mul_f32 v59, v59, v51
v_mfma_f32_16x16x32_bf16 v[68:71], v[16:19], a[68:71], v[68:71]
v_exp_f32 v37, v37
v_mul_f32 v39, v39, v97
v_mfma_f32_16x16x32_bf16 v[76:79], v[20:23], a[68:71], v[76:79]
ds_read_b128 v[16:19], v2 offset:36864
v_fma_f32 v37, v37, v99, v99
v_mfma_f32_16x16x32_bf16 v[72:75], v[20:23], a[64:67], v[72:75]
v_cvt_pk_bf16_f32 v107, v58, v59
s_waitcnt lgkmcnt(1)
v_mfma_f32_16x16x32_bf16 v[80:83], v[24:27], a[64:67], v[80:83]
ds_read_b128 v[20:23], v2 offset:37888
v_mfma_f32_16x16x32_bf16 v[84:87], v[24:27], a[68:71], v[84:87]
v_rcp_f32 v36, v36
v_mfma_f32_16x16x32_bf16 v[92:95], v[28:31], a[68:71], v[92:95]
ds_read_b128 v[24:27], v2 offset:38912
v_mul_f32 v44, v44, v36
v_mfma_f32_16x16x32_bf16 v[88:91], v[28:31], a[64:67], v[88:91]
v_mul_f32 v52, v52, v97
s_waitcnt lgkmcnt(1)
v_mfma_f32_16x16x32_bf16 v[64:67], v[16:19], a[72:75], v[64:67]
ds_read_b128 v[28:31], v2 offset:39936
v_mfma_f32_16x16x32_bf16 v[68:71], v[16:19], a[76:79], v[68:71]
v_exp_f32 v38, v38
v_mfma_f32_16x16x32_bf16 v[76:79], v[20:23], a[76:79], v[76:79]
ds_read_b128 v[16:19], v2 offset:40960
v_fma_f32 v38, v38, v99, v99
v_mfma_f32_16x16x32_bf16 v[72:75], v[20:23], a[72:75], v[72:75]
s_waitcnt lgkmcnt(1)
v_mfma_f32_16x16x32_bf16 v[80:83], v[24:27], a[72:75], v[80:83]
ds_read_b128 v[20:23], v2 offset:41984
v_mfma_f32_16x16x32_bf16 v[84:87], v[24:27], a[76:79], v[84:87]
v_rcp_f32 v37, v37
v_mfma_f32_16x16x32_bf16 v[92:95], v[28:31], a[76:79], v[92:95]
ds_read_b128 v[24:27], v2 offset:43008
v_mul_f32 v45, v45, v37
v_mfma_f32_16x16x32_bf16 v[88:91], v[28:31], a[72:75], v[88:91]
v_mul_f32 v53, v53, v97
s_waitcnt lgkmcnt(1)
v_mfma_f32_16x16x32_bf16 v[64:67], v[16:19], a[80:83], v[64:67]
ds_read_b128 v[28:31], v2 offset:44032
v_cvt_pk_bf16_f32 v108, v44, v45
v_mfma_f32_16x16x32_bf16 v[68:71], v[16:19], a[84:87], v[68:71]
v_exp_f32 v39, v39
v_mfma_f32_16x16x32_bf16 v[76:79], v[20:23], a[84:87], v[76:79]
ds_read_b128 v[16:19], v2 offset:45056
v_fma_f32 v39, v39, v99, v99
v_mfma_f32_16x16x32_bf16 v[72:75], v[20:23], a[80:83], v[72:75]
s_waitcnt lgkmcnt(1)
v_mfma_f32_16x16x32_bf16 v[80:83], v[24:27], a[80:83], v[80:83]
ds_read_b128 v[20:23], v2 offset:46080
v_mfma_f32_16x16x32_bf16 v[84:87], v[24:27], a[84:87], v[84:87]
v_rcp_f32 v38, v38
v_mfma_f32_16x16x32_bf16 v[92:95], v[28:31], a[84:87], v[92:95]
ds_read_b128 v[24:27], v2 offset:47104
v_mul_f32 v46, v46, v38
v_mfma_f32_16x16x32_bf16 v[88:91], v[28:31], a[80:83], v[88:91]
v_mul_f32 v54, v54, v97
s_waitcnt lgkmcnt(1)
v_mfma_f32_16x16x32_bf16 v[64:67], v[16:19], a[88:91], v[64:67]
ds_read_b128 v[28:31], v2 offset:48128
v_mfma_f32_16x16x32_bf16 v[68:71], v[16:19], a[92:95], v[68:71]
v_exp_f32 v52, v52
v_mfma_f32_16x16x32_bf16 v[76:79], v[20:23], a[92:95], v[76:79]
ds_read_b128 v[16:19], v2 offset:49152
v_fma_f32 v52, v52, v99, v99
v_mfma_f32_16x16x32_bf16 v[72:75], v[20:23], a[88:91], v[72:75]
s_waitcnt lgkmcnt(1)
v_mfma_f32_16x16x32_bf16 v[80:83], v[24:27], a[88:91], v[80:83]
ds_read_b128 v[20:23], v2 offset:50176
v_mfma_f32_16x16x32_bf16 v[84:87], v[24:27], a[92:95], v[84:87]
v_rcp_f32 v39, v39
v_mul_f32 v55, v55, v97
v_mfma_f32_16x16x32_bf16 v[92:95], v[28:31], a[92:95], v[92:95]
ds_read_b128 v[24:27], v2 offset:51200
v_mul_f32 v47, v47, v39
v_mfma_f32_16x16x32_bf16 v[88:91], v[28:31], a[88:91], v[88:91]
v_cvt_pk_bf16_f32 v109, v46, v47
s_waitcnt lgkmcnt(1)
v_mfma_f32_16x16x32_bf16 v[64:67], v[16:19], a[96:99], v[64:67]
ds_read_b128 v[28:31], v2 offset:52224
v_mfma_f32_16x16x32_bf16 v[68:71], v[16:19], a[100:103], v[68:71]
v_exp_f32 v53, v53
v_mfma_f32_16x16x32_bf16 v[76:79], v[20:23], a[100:103], v[76:79]
ds_read_b128 v[16:19], v2 offset:53248
v_fma_f32 v53, v53, v99, v99
v_mfma_f32_16x16x32_bf16 v[72:75], v[20:23], a[96:99], v[72:75]
s_waitcnt lgkmcnt(1)
v_mfma_f32_16x16x32_bf16 v[80:83], v[24:27], a[96:99], v[80:83]
ds_read_b128 v[20:23], v2 offset:54272
v_mfma_f32_16x16x32_bf16 v[84:87], v[24:27], a[100:103], v[84:87]
v_rcp_f32 v52, v52
v_mfma_f32_16x16x32_bf16 v[92:95], v[28:31], a[100:103], v[92:95]
ds_read_b128 v[24:27], v2 offset:55296
v_mul_f32 v60, v60, v52
v_mfma_f32_16x16x32_bf16 v[88:91], v[28:31], a[96:99], v[88:91]
v_exp_f32 v54, v54
s_waitcnt lgkmcnt(1)
v_mfma_f32_16x16x32_bf16 v[64:67], v[16:19], a[104:107], v[64:67]
ds_read_b128 v[28:31], v2 offset:56320
v_fma_f32 v54, v54, v99, v99
v_mfma_f32_16x16x32_bf16 v[68:71], v[16:19], a[108:111], v[68:71]
v_rcp_f32 v53, v53
v_mfma_f32_16x16x32_bf16 v[76:79], v[20:23], a[108:111], v[76:79]
ds_read_b128 v[16:19], v2 offset:57344
v_mul_f32 v61, v61, v53
v_mfma_f32_16x16x32_bf16 v[72:75], v[20:23], a[104:107], v[72:75]
v_cvt_pk_bf16_f32 v110, v60, v61
s_waitcnt lgkmcnt(1)
v_mfma_f32_16x16x32_bf16 v[80:83], v[24:27], a[104:107], v[80:83]
ds_read_b128 v[20:23], v2 offset:58368
v_mfma_f32_16x16x32_bf16 v[84:87], v[24:27], a[108:111], v[84:87]
v_exp_f32 v55, v55
v_mfma_f32_16x16x32_bf16 v[92:95], v[28:31], a[108:111], v[92:95]
ds_read_b128 v[24:27], v2 offset:59392
v_fma_f32 v55, v55, v99, v99
v_mfma_f32_16x16x32_bf16 v[88:91], v[28:31], a[104:107], v[88:91]
s_waitcnt lgkmcnt(1)
v_mfma_f32_16x16x32_bf16 v[64:67], v[16:19], a[112:115], v[64:67]
ds_read_b128 v[28:31], v2 offset:60416
v_mfma_f32_16x16x32_bf16 v[68:71], v[16:19], a[116:119], v[68:71]
v_rcp_f32 v54, v54
v_mfma_f32_16x16x32_bf16 v[76:79], v[20:23], a[116:119], v[76:79]
ds_read_b128 v[16:19], v2 offset:61440
v_mul_f32 v62, v62, v54
v_mfma_f32_16x16x32_bf16 v[72:75], v[20:23], a[112:115], v[72:75]
s_waitcnt lgkmcnt(1)
v_mfma_f32_16x16x32_bf16 v[80:83], v[24:27], a[112:115], v[80:83]
ds_read_b128 v[20:23], v2 offset:62464
v_mfma_f32_16x16x32_bf16 v[84:87], v[24:27], a[116:119], v[84:87]
v_rcp_f32 v55, v55
v_mfma_f32_16x16x32_bf16 v[92:95], v[28:31], a[116:119], v[92:95]
ds_read_b128 v[24:27], v2 offset:63488
v_mul_f32 v63, v63, v55
v_mfma_f32_16x16x32_bf16 v[88:91], v[28:31], a[112:115], v[88:91]
v_cvt_pk_bf16_f32 v111, v62, v63
s_add_u32 s49, s58, 0xb40000
buffer_store_dwordx4 v[104:107], v1, s[4:7], s49 offen offset:0 sc1
buffer_store_dwordx4 v[108:111], v1, s[4:7], s49 offen offset:1024 sc1
s_barrier
s_waitcnt lgkmcnt(1)
v_mfma_f32_16x16x32_bf16 v[64:67], v[16:19], a[120:123], v[64:67]
ds_read_b128 v[28:31], v2 offset:64512
v_mfma_f32_16x16x32_bf16 v[68:71], v[16:19], a[124:127], v[68:71]
v_mfma_f32_16x16x32_bf16 v[76:79], v[20:23], a[124:127], v[76:79]
ds_read_b128 v[16:19], v3 offset:0
v_mfma_f32_16x16x32_bf16 v[72:75], v[20:23], a[120:123], v[72:75]
s_waitcnt lgkmcnt(1)
v_mfma_f32_16x16x32_bf16 v[80:83], v[24:27], a[120:123], v[80:83]
ds_read_b128 v[20:23], v3 offset:1024
v_mfma_f32_16x16x32_bf16 v[84:87], v[24:27], a[124:127], v[84:87]
v_mfma_f32_16x16x32_bf16 v[92:95], v[28:31], a[124:127], v[92:95]
ds_read_b128 v[24:27], v3 offset:2048
v_mfma_f32_16x16x32_bf16 v[88:91], v[28:31], a[120:123], v[88:91]
s_waitcnt lgkmcnt(1)
v_mfma_f32_16x16x32_bf16 v[32:35], v[16:19], a[0:3], 0
ds_read_b128 v[28:31], v3 offset:3072
v_mfma_f32_16x16x32_bf16 v[36:39], v[16:19], a[4:7], 0
v_mfma_f32_16x16x32_bf16 v[44:47], v[20:23], a[4:7], 0
ds_read_b128 v[16:19], v3 offset:4096
v_mul_f32 v64, v64, v96
v_mfma_f32_16x16x32_bf16 v[40:43], v[20:23], a[0:3], 0
v_exp_f32 v64, v64
s_waitcnt lgkmcnt(1)
v_mfma_f32_16x16x32_bf16 v[48:51], v[24:27], a[0:3], 0
ds_read_b128 v[20:23], v3 offset:5120
v_mul_f32 v65, v65, v96
v_mfma_f32_16x16x32_bf16 v[52:55], v[24:27], a[4:7], 0
v_fma_f32 v64, v64, v98, v98
v_exp_f32 v65, v65
v_mfma_f32_16x16x32_bf16 v[60:63], v[28:31], a[4:7], 0
ds_read_b128 v[24:27], v3 offset:6144
v_mul_f32 v66, v66, v96
v_mfma_f32_16x16x32_bf16 v[56:59], v[28:31], a[0:3], 0
v_fma_f32 v65, v65, v98, v98
s_waitcnt lgkmcnt(1)
v_mfma_f32_16x16x32_bf16 v[32:35], v[16:19], a[8:11], v[32:35]
ds_read_b128 v[28:31], v3 offset:7168
v_mul_f32 v67, v67, v96
v_mfma_f32_16x16x32_bf16 v[36:39], v[16:19], a[12:15], v[36:39]
v_rcp_f32 v64, v64
v_mfma_f32_16x16x32_bf16 v[44:47], v[20:23], a[12:15], v[44:47]
ds_read_b128 v[16:19], v3 offset:8192
v_mul_f32 v72, v72, v64
v_mfma_f32_16x16x32_bf16 v[40:43], v[20:23], a[8:11], v[40:43]
v_mul_f32 v80, v80, v96
s_waitcnt lgkmcnt(1)
v_mfma_f32_16x16x32_bf16 v[48:51], v[24:27], a[8:11], v[48:51]
ds_read_b128 v[20:23], v3 offset:9216
v_mfma_f32_16x16x32_bf16 v[52:55], v[24:27], a[12:15], v[52:55]
v_exp_f32 v66, v66
v_mfma_f32_16x16x32_bf16 v[60:63], v[28:31], a[12:15], v[60:63]
ds_read_b128 v[24:27], v3 offset:10240
v_fma_f32 v66, v66, v98, v98
v_mfma_f32_16x16x32_bf16 v[56:59], v[28:31], a[8:11], v[56:59]
s_waitcnt lgkmcnt(1)
v_mfma_f32_16x16x32_bf16 v[32:35], v[16:19], a[16:19], v[32:35]
ds_read_b128 v[28:31], v3 offset:11264
v_mfma_f32_16x16x32_bf16 v[36:39], v[16:19], a[20:23], v[36:39]
v_rcp_f32 v65, v65
v_mfma_f32_16x16x32_bf16 v[44:47], v[20:23], a[20:23], v[44:47]
ds_read_b128 v[16:19], v3 offset:12288
v_mul_f32 v73, v73, v65
v_mfma_f32_16x16x32_bf16 v[40:43], v[20:23], a[16:19], v[40:43]
v_mul_f32 v81, v81, v96
s_waitcnt lgkmcnt(1)
v_mfma_f32_16x16x32_bf16 v[48:51], v[24:27], a[16:19], v[48:51]
ds_read_b128 v[20:23], v3 offset:13312
v_cvt_pk_bf16_f32 v104, v72, v73
v_mfma_f32_16x16x32_bf16 v[52:55], v[24:27], a[20:23], v[52:55]
v_exp_f32 v67, v67
v_mfma_f32_16x16x32_bf16 v[60:63], v[28:31], a[20:23], v[60:63]
ds_read_b128 v[24:27], v3 offset:14336
v_fma_f32 v67, v67, v98, v98
v_mfma_f32_16x16x32_bf16 v[56:59], v[28:31], a[16:19], v[56:59]
s_waitcnt lgkmcnt(1)
v_mfma_f32_16x16x32_bf16 v[32:35], v[16:19], a[24:27], v[32:35]
ds_read_b128 v[28:31], v3 offset:15360
v_mfma_f32_16x16x32_bf16 v[36:39], v[16:19], a[28:31], v[36:39]
v_rcp_f32 v66, v66
v_mfma_f32_16x16x32_bf16 v[44:47], v[20:23], a[28:31], v[44:47]
ds_read_b128 v[16:19], v1 offset:0
v_mul_f32 v74, v74, v66
v_mfma_f32_16x16x32_bf16 v[40:43], v[20:23], a[24:27], v[40:43]
v_mul_f32 v82, v82, v96
s_waitcnt lgkmcnt(1)
v_mfma_f32_16x16x32_bf16 v[48:51], v[24:27], a[24:27], v[48:51]
ds_read_b128 v[20:23], v1 offset:1024
v_mfma_f32_16x16x32_bf16 v[52:55], v[24:27], a[28:31], v[52:55]
v_exp_f32 v80, v80
v_mfma_f32_16x16x32_bf16 v[60:63], v[28:31], a[28:31], v[60:63]
ds_read_b128 v[24:27], v1 offset:2048
v_fma_f32 v80, v80, v98, v98
v_mfma_f32_16x16x32_bf16 v[56:59], v[28:31], a[24:27], v[56:59]
s_waitcnt lgkmcnt(1)
v_mfma_f32_16x16x32_bf16 v[32:35], v[16:19], a[32:35], v[32:35]
ds_read_b128 v[28:31], v1 offset:3072
v_mfma_f32_16x16x32_bf16 v[36:39], v[16:19], a[36:39], v[36:39]
v_rcp_f32 v67, v67
v_mfma_f32_16x16x32_bf16 v[44:47], v[20:23], a[36:39], v[44:47]
ds_read_b128 v[16:19], v1 offset:4096
v_mul_f32 v75, v75, v67
v_mfma_f32_16x16x32_bf16 v[40:43], v[20:23], a[32:35], v[40:43]
v_mul_f32 v83, v83, v96
s_waitcnt lgkmcnt(1)
v_mfma_f32_16x16x32_bf16 v[48:51], v[24:27], a[32:35], v[48:51]
ds_read_b128 v[20:23], v1 offset:5120
v_cvt_pk_bf16_f32 v105, v74, v75
v_mfma_f32_16x16x32_bf16 v[52:55], v[24:27], a[36:39], v[52:55]
v_exp_f32 v81, v81
v_mfma_f32_16x16x32_bf16 v[60:63], v[28:31], a[36:39], v[60:63]
ds_read_b128 v[24:27], v1 offset:6144
v_fma_f32 v81, v81, v98, v98
v_mfma_f32_16x16x32_bf16 v[56:59], v[28:31], a[32:35], v[56:59]
s_waitcnt lgkmcnt(1)
v_mfma_f32_16x16x32_bf16 v[32:35], v[16:19], a[40:43], v[32:35]
ds_read_b128 v[28:31], v1 offset:7168
v_mfma_f32_16x16x32_bf16 v[36:39], v[16:19], a[44:47], v[36:39]
v_rcp_f32 v80, v80
v_mfma_f32_16x16x32_bf16 v[44:47], v[20:23], a[44:47], v[44:47]
ds_read_b128 v[16:19], v1 offset:8192
v_mul_f32 v88, v88, v80
v_mfma_f32_16x16x32_bf16 v[40:43], v[20:23], a[40:43], v[40:43]
v_mul_f32 v68, v68, v97
s_waitcnt lgkmcnt(1)
v_mfma_f32_16x16x32_bf16 v[48:51], v[24:27], a[40:43], v[48:51]
ds_read_b128 v[20:23], v1 offset:9216
v_mfma_f32_16x16x32_bf16 v[52:55], v[24:27], a[44:47], v[52:55]
v_exp_f32 v82, v82
v_mfma_f32_16x16x32_bf16 v[60:63], v[28:31], a[44:47], v[60:63]
ds_read_b128 v[24:27], v1 offset:10240
v_fma_f32 v82, v82, v98, v98
v_mfma_f32_16x16x32_bf16 v[56:59], v[28:31], a[40:43], v[56:59]
s_waitcnt lgkmcnt(1)
v_mfma_f32_16x16x32_bf16 v[32:35], v[16:19], a[48:51], v[32:35]
ds_read_b128 v[28:31], v1 offset:11264
v_mfma_f32_16x16x32_bf16 v[36:39], v[16:19], a[52:55], v[36:39]
s_waitcnt vmcnt(0)
v_mov_b32 v6, 2
s_mov_b64 exec, 1
s_cmp_lg_u32 s39, 0
s_cbranch_scc1 L_c_stg_44
buffer_store_dword v6, off, s[4:7], s81  offset:0
L_c_stb_45:
s_mov_b64 exec, -1
v_mfma_f32_16x16x32_bf16 v[44:47], v[20:23], a[52:55], v[44:47]
ds_read_b128 v[16:19], v1 offset:12288
v_rcp_f32 v81, v81
v_mfma_f32_16x16x32_bf16 v[40:43], v[20:23], a[48:51], v[40:43]
v_exp_f32 v83, v83
s_waitcnt lgkmcnt(1)
v_mfma_f32_16x16x32_bf16 v[48:51], v[24:27], a[48:51], v[48:51]
ds_read_b128 v[20:23], v1 offset:13312
v_mul_f32 v89, v89, v81
v_mfma_f32_16x16x32_bf16 v[52:55], v[24:27], a[52:55], v[52:55]
v_rcp_f32 v82, v82
v_fma_f32 v83, v83, v98, v98
v_mfma_f32_16x16x32_bf16 v[60:63], v[28:31], a[52:55], v[60:63]
ds_read_b128 v[24:27], v1 offset:14336
v_mul_f32 v69, v69, v97
v_mfma_f32_16x16x32_bf16 v[56:59], v[28:31], a[48:51], v[56:59]
v_cvt_pk_bf16_f32 v106, v88, v89
s_barrier
s_waitcnt lgkmcnt(1)
v_mfma_f32_16x16x32_bf16 v[32:35], v[16:19], a[56:59], v[32:35]
ds_read_b128 v[28:31], v1 offset:15360
v_mul_f32 v90, v90, v82
v_mfma_f32_16x16x32_bf16 v[36:39], v[16:19], a[60:63], v[36:39]
v_exp_f32 v68, v68
v_mfma_f32_16x16x32_bf16 v[44:47], v[20:23], a[60:63], v[44:47]
ds_read_b128 v[16:19], v1 offset:16384
v_fma_f32 v68, v68, v99, v99
v_mfma_f32_16x16x32_bf16 v[40:43], v[20:23], a[56:59], v[40:43]
v_mul_f32 v70, v70, v97
s_waitcnt lgkmcnt(1)
v_mfma_f32_16x16x32_bf16 v[48:51], v[24:27], a[56:59], v[48:51]
ds_read_b128 v[20:23], v1 offset:17408
v_mfma_f32_16x16x32_bf16 v[52:55], v[24:27], a[60:63], v[52:55]
v_rcp_f32 v83, v83
v_mfma_f32_16x16x32_bf16 v[60:63], v[28:31], a[60:63], v[60:63]
ds_read_b128 v[24:27], v1 offset:18432
v_mul_f32 v91, v91, v83
v_mfma_f32_16x16x32_bf16 v[56:59], v[28:31], a[56:59], v[56:59]
v_mul_f32 v71, v71, v97
s_waitcnt lgkmcnt(1)
v_mfma_f32_16x16x32_bf16 v[32:35], v[16:19], a[64:67], v[32:35]
ds_read_b128 v[28:31], v1 offset:19456
v_cvt_pk_bf16_f32 v107, v90, v91
v_mfma_f32_16x16x32_bf16 v[36:39], v[16:19], a[68:71], v[36:39]
v_exp_f32 v69, v69
v_mfma_f32_16x16x32_bf16 v[44:47], v[20:23], a[68:71], v[44:47]
ds_read_b128 v[16:19], v1 offset:20480
v_fma_f32 v69, v69, v99, v99
v_mfma_f32_16x16x32_bf16 v[40:43], v[20:23], a[64:67], v[40:43]
s_waitcnt lgkmcnt(1)
v_mfma_f32_16x16x32_bf16 v[48:51], v[24:27], a[64:67], v[48:51]
ds_read_b128 v[20:23], v1 offset:21504
v_mfma_f32_16x16x32_bf16 v[52:55], v[24:27], a[68:71], v[52:55]
v_rcp_f32 v68, v68
v_mfma_f32_16x16x32_bf16 v[60:63], v[28:31], a[68:71], v[60:63]
ds_read_b128 v[24:27], v1 offset:22528
v_mul_f32 v76, v76, v68
v_mfma_f32_16x16x32_bf16 v[56:59], v[28:31], a[64:67], v[56:59]
v_mul_f32 v84, v84, v97
s_waitcnt lgkmcnt(1)
v_mfma_f32_16x16x32_bf16 v[32:35], v[16:19], a[72:75], v[32:35]
ds_read_b128 v[28:31], v1 offset:23552
v_mfma_f32_16x16x32_bf16 v[36:39], v[16:19], a[76:79], v[36:39]
v_exp_f32 v70, v70
v_mfma_f32_16x16x32_bf16 v[44:47], v[20:23], a[76:79], v[44:47]
ds_read_b128 v[16:19], v1 offset:24576
v_fma_f32 v70, v70, v99, v99
v_mfma_f32_16x16x32_bf16 v[40:43], v[20:23], a[72:75], v[40:43]
s_waitcnt lgkmcnt(1)
v_mfma_f32_16x16x32_bf16 v[48:51], v[24:27], a[72:75], v[48:51]
ds_read_b128 v[20:23], v1 offset:25600
v_mfma_f32_16x16x32_bf16 v[52:55], v[24:27], a[76:79], v[52:55]
v_rcp_f32 v69, v69
v_mfma_f32_16x16x32_bf16 v[60:63], v[28:31], a[76:79], v[60:63]
ds_read_b128 v[24:27], v1 offset:26624
v_mul_f32 v77, v77, v69
v_mfma_f32_16x16x32_bf16 v[56:59], v[28:31], a[72:75], v[56:59]
v_mul_f32 v85, v85, v97
s_waitcnt lgkmcnt(1)
v_mfma_f32_16x16x32_bf16 v[32:35], v[16:19], a[80:83], v[32:35]
ds_read_b128 v[28:31], v1 offset:27648
v_cvt_pk_bf16_f32 v108, v76, v77
v_mfma_f32_16x16x32_bf16 v[36:39], v[16:19], a[84:87], v[36:39]
v_exp_f32 v71, v71
v_mfma_f32_16x16x32_bf16 v[44:47], v[20:23], a[84:87], v[44:47]
ds_read_b128 v[16:19], v1 offset:28672
v_fma_f32 v71, v71, v99, v99
v_mfma_f32_16x16x32_bf16 v[40:43], v[20:23], a[80:83], v[40:43]
s_waitcnt lgkmcnt(1)
v_mfma_f32_16x16x32_bf16 v[48:51], v[24:27], a[80:83], v[48:51]
ds_read_b128 v[20:23], v1 offset:29696
v_mfma_f32_16x16x32_bf16 v[52:55], v[24:27], a[84:87], v[52:55]
v_rcp_f32 v70, v70
v_mfma_f32_16x16x32_bf16 v[60:63], v[28:31], a[84:87], v[60:63]
ds_read_b128 v[24:27], v1 offset:30720
v_mul_f32 v78, v78, v70
v_mfma_f32_16x16x32_bf16 v[56:59], v[28:31], a[80:83], v[56:59]
v_mul_f32 v86, v86, v97
s_waitcnt lgkmcnt(1)
v_mfma_f32_16x16x32_bf16 v[32:35], v[16:19], a[88:91], v[32:35]
ds_read_b128 v[28:31], v1 offset:31744
v_mfma_f32_16x16x32_bf16 v[36:39], v[16:19], a[92:95], v[36:39]
v_exp_f32 v84, v84
v_mfma_f32_16x16x32_bf16 v[44:47], v[20:23], a[92:95], v[44:47]
ds_read_b128 v[16:19], v1 offset:32768
v_fma_f32 v84, v84, v99, v99
v_mfma_f32_16x16x32_bf16 v[40:43], v[20:23], a[88:91], v[40:43]
s_waitcnt lgkmcnt(1)
v_mfma_f32_16x16x32_bf16 v[48:51], v[24:27], a[88:91], v[48:51]
ds_read_b128 v[20:23], v1 offset:33792
v_mfma_f32_16x16x32_bf16 v[52:55], v[24:27], a[92:95], v[52:55]
v_rcp_f32 v71, v71
v_mul_f32 v87, v87, v97
v_mfma_f32_16x16x32_bf16 v[60:63], v[28:31], a[92:95], v[60:63]
ds_read_b128 v[24:27], v1 offset:34816
v_mul_f32 v79, v79, v71
v_mfma_f32_16x16x32_bf16 v[56:59], v[28:31], a[88:91], v[56:59]
v_cvt_pk_bf16_f32 v109, v78, v79
s_waitcnt lgkmcnt(1)
v_mfma_f32_16x16x32_bf16 v[32:35], v[16:19], a[96:99], v[32:35]
ds_read_b128 v[28:31], v1 offset:35840
v_mfma_f32_16x16x32_bf16 v[36:39], v[16:19], a[100:103], v[36:39]
v_exp_f32 v85, v85
v_mfma_f32_16x16x32_bf16 v[44:47], v[20:23], a[100:103], v[44:47]
ds_read_b128 v[16:19], v1 offset:36864
v_fma_f32 v85, v85, v99, v99
v_mfma_f32_16x16x32_bf16 v[40:43], v[20:23], a[96:99], v[40:43]
s_waitcnt lgkmcnt(1)
v_mfma_f32_16x16x32_bf16 v[48:51], v[24:27], a[96:99], v[48:51]
ds_read_b128 v[20:23], v1 offset:37888
v_mfma_f32_16x16x32_bf16 v[52:55], v[24:27], a[100:103], v[52:55]
buffer_load_dword v114, v5, s[4:7], s57 offen nt
v_rcp_f32 v84, v84
v_mfma_f32_16x16x32_bf16 v[60:63], v[28:31], a[100:103], v[60:63]
ds_read_b128 v[24:27], v1 offset:38912
v_mul_f32 v92, v92, v84
v_mfma_f32_16x16x32_bf16 v[56:59], v[28:31], a[96:99], v[56:59]
v_exp_f32 v86, v86
s_waitcnt lgkmcnt(1)
v_mfma_f32_16x16x32_bf16 v[32:35], v[16:19], a[104:107], v[32:35]
ds_read_b128 v[28:31], v1 offset:39936
v_fma_f32 v86, v86, v99, v99
v_mfma_f32_16x16x32_bf16 v[36:39], v[16:19], a[108:111], v[36:39]
v_rcp_f32 v85, v85
v_mfma_f32_16x16x32_bf16 v[44:47], v[20:23], a[108:111], v[44:47]
ds_read_b128 v[16:19], v1 offset:40960
v_mul_f32 v93, v93, v85
v_mfma_f32_16x16x32_bf16 v[40:43], v[20:23], a[104:107], v[40:43]
v_cvt_pk_bf16_f32 v110, v92, v93
s_waitcnt lgkmcnt(1)
v_mfma_f32_16x16x32_bf16 v[48:51], v[24:27], a[104:107], v[48:51]
ds_read_b128 v[20:23], v1 offset:41984
v_mfma_f32_16x16x32_bf16 v[52:55], v[24:27], a[108:111], v[52:55]
v_exp_f32 v87, v87
v_mfma_f32_16x16x32_bf16 v[60:63], v[28:31], a[108:111], v[60:63]
ds_read_b128 v[24:27], v1 offset:43008
v_fma_f32 v87, v87, v99, v99
v_mfma_f32_16x16x32_bf16 v[56:59], v[28:31], a[104:107], v[56:59]
s_waitcnt lgkmcnt(1)
v_mfma_f32_16x16x32_bf16 v[32:35], v[16:19], a[112:115], v[32:35]
ds_read_b128 v[28:31], v1 offset:44032
v_mfma_f32_16x16x32_bf16 v[36:39], v[16:19], a[116:119], v[36:39]
v_rcp_f32 v86, v86
v_mfma_f32_16x16x32_bf16 v[44:47], v[20:23], a[116:119], v[44:47]
ds_read_b128 v[16:19], v1 offset:45056
v_mul_f32 v94, v94, v86
v_mfma_f32_16x16x32_bf16 v[40:43], v[20:23], a[112:115], v[40:43]
s_waitcnt lgkmcnt(1)
v_mfma_f32_16x16x32_bf16 v[48:51], v[24:27], a[112:115], v[48:51]
ds_read_b128 v[20:23], v1 offset:46080
v_mfma_f32_16x16x32_bf16 v[52:55], v[24:27], a[116:119], v[52:55]
v_rcp_f32 v87, v87
v_mfma_f32_16x16x32_bf16 v[60:63], v[28:31], a[116:119], v[60:63]
ds_read_b128 v[24:27], v1 offset:47104
v_mul_f32 v95, v95, v87
v_mfma_f32_16x16x32_bf16 v[56:59], v[28:31], a[112:115], v[56:59]
v_cvt_pk_bf16_f32 v111, v94, v95
s_add_u32 s49, s58, 0xb44000
buffer_store_dwordx4 v[104:107], v1, s[4:7], s49 offen offset:0 sc1
buffer_store_dwordx4 v[108:111], v1, s[4:7], s49 offen offset:1024 sc1
s_barrier
s_waitcnt lgkmcnt(1)
v_mfma_f32_16x16x32_bf16 v[32:35], v[16:19], a[120:123], v[32:35]
ds_read_b128 v[28:31], v1 offset:48128
v_mfma_f32_16x16x32_bf16 v[36:39], v[16:19], a[124:127], v[36:39]
v_mfma_f32_16x16x32_bf16 v[44:47], v[20:23], a[124:127], v[44:47]
ds_read_b128 v[16:19], v1 offset:49152
v_mfma_f32_16x16x32_bf16 v[40:43], v[20:23], a[120:123], v[40:43]
s_waitcnt lgkmcnt(1)
v_mfma_f32_16x16x32_bf16 v[48:51], v[24:27], a[120:123], v[48:51]
ds_read_b128 v[20:23], v1 offset:50176
v_mfma_f32_16x16x32_bf16 v[52:55], v[24:27], a[124:127], v[52:55]
v_mfma_f32_16x16x32_bf16 v[60:63], v[28:31], a[124:127], v[60:63]
ds_read_b128 v[24:27], v1 offset:51200
v_mfma_f32_16x16x32_bf16 v[56:59], v[28:31], a[120:123], v[56:59]
s_waitcnt lgkmcnt(1)
v_mfma_f32_16x16x32_bf16 v[64:67], v[16:19], a[0:3], 0
ds_read_b128 v[28:31], v1 offset:52224
v_mfma_f32_16x16x32_bf16 v[68:71], v[16:19], a[4:7], 0
v_mfma_f32_16x16x32_bf16 v[76:79], v[20:23], a[4:7], 0
ds_read_b128 v[16:19], v1 offset:53248
s_lshl_b32 s51, s46, 13
v_mul_f32 v32, v32, v96
v_mfma_f32_16x16x32_bf16 v[72:75], v[20:23], a[0:3], 0
v_add_u32 v80, s51, v1
v_add_u32 v81, s51, v2
s_waitcnt lgkmcnt(1)
v_mfma_f32_16x16x32_bf16 v[64:67], v[24:27], a[8:11], v[64:67]
ds_read_b128 v[20:23], v1 offset:54272
v_add_u32 v82, s51, v3
v_mul_f32 v33, v33, v96
v_mfma_f32_16x16x32_bf16 v[68:71], v[24:27], a[12:15], v[68:71]
v_exp_f32 v32, v32
v_mul_f32 v34, v34, v96
v_mfma_f32_16x16x32_bf16 v[76:79], v[28:31], a[12:15], v[76:79]
ds_read_b128 v[24:27], v1 offset:55296
v_fma_f32 v32, v32, v98, v98
v_mfma_f32_16x16x32_bf16 v[72:75], v[28:31], a[8:11], v[72:75]
v_exp_f32 v33, v33
s_waitcnt lgkmcnt(1)
v_mfma_f32_16x16x32_bf16 v[64:67], v[16:19], a[16:19], v[64:67]
ds_read_b128 v[28:31], v1 offset:56320
v_rcp_f32 v32, v32
v_mfma_f32_16x16x32_bf16 v[68:71], v[16:19], a[20:23], v[68:71]
v_fma_f32 v33, v33, v98, v98
v_exp_f32 v34, v34
v_mfma_f32_16x16x32_bf16 v[76:79], v[20:23], a[20:23], v[76:79]
ds_read_b128 v[16:19], v1 offset:57344
v_mul_f32 v35, v35, v96
v_mfma_f32_16x16x32_bf16 v[72:75], v[20:23], a[16:19], v[72:75]
v_mul_f32 v40, v40, v32
v_fma_f32 v34, v34, v98, v98
s_waitcnt lgkmcnt(1)
v_mfma_f32_16x16x32_bf16 v[64:67], v[24:27], a[24:27], v[64:67]
ds_read_b128 v[20:23], v1 offset:58368
v_rcp_f32 v33, v33
v_mfma_f32_16x16x32_bf16 v[68:71], v[24:27], a[28:31], v[68:71]
v_exp_f32 v35, v35
v_mul_f32 v48, v48, v96
v_mfma_f32_16x16x32_bf16 v[76:79], v[28:31], a[28:31], v[76:79]
ds_read_b128 v[24:27], v1 offset:59392
v_mul_f32 v41, v41, v33
v_mfma_f32_16x16x32_bf16 v[72:75], v[28:31], a[24:27], v[72:75]
v_rcp_f32 v34, v34
s_waitcnt lgkmcnt(1)
v_mfma_f32_16x16x32_bf16 v[64:67], v[16:19], a[32:35], v[64:67]
ds_read_b128 v[28:31], v1 offset:60416
v_fma_f32 v35, v35, v98, v98
v_mul_f32 v49, v49, v96
v_mfma_f32_16x16x32_bf16 v[68:71], v[16:19], a[36:39], v[68:71]
v_exp_f32 v48, v48
v_cvt_pk_bf16_f32 v104, v40, v41
v_mfma_f32_16x16x32_bf16 v[76:79], v[20:23], a[36:39], v[76:79]
ds_read_b128 v[16:19], v1 offset:61440
v_mul_f32 v42, v42, v34
v_mfma_f32_16x16x32_bf16 v[72:75], v[20:23], a[32:35], v[72:75]
v_rcp_f32 v35, v35
s_waitcnt lgkmcnt(1)
v_mfma_f32_16x16x32_bf16 v[64:67], v[24:27], a[40:43], v[64:67]
ds_read_b128 v[20:23], v1 offset:62464
v_fma_f32 v48, v48, v98, v98
v_mul_f32 v50, v50, v96
v_mfma_f32_16x16x32_bf16 v[68:71], v[24:27], a[44:47], v[68:71]
v_exp_f32 v49, v49
v_mul_f32 v43, v43, v35
v_mfma_f32_16x16x32_bf16 v[76:79], v[28:31], a[44:47], v[76:79]
ds_read_b128 v[24:27], v1 offset:63488
v_fma_f32 v49, v49, v98, v98
v_mfma_f32_16x16x32_bf16 v[72:75], v[28:31], a[40:43], v[72:75]
v_rcp_f32 v48, v48
s_waitcnt lgkmcnt(1)
v_mfma_f32_16x16x32_bf16 v[64:67], v[16:19], a[48:51], v[64:67]
ds_read_b128 v[28:31], v1 offset:64512
v_exp_f32 v50, v50
v_mfma_f32_16x16x32_bf16 v[68:71], v[16:19], a[52:55], v[68:71]
v_mul_f32 v51, v51, v96
v_cvt_pk_bf16_f32 v105, v42, v43
v_mul_f32 v56, v56, v48
v_mfma_f32_16x16x32_bf16 v[76:79], v[20:23], a[52:55], v[76:79]
ds_read_b128 v[16:19], v2 offset:0
v_fma_f32 v50, v50, v98, v98
v_mfma_f32_16x16x32_bf16 v[72:75], v[20:23], a[48:51], v[72:75]
v_rcp_f32 v49, v49
s_waitcnt lgkmcnt(1)
v_mfma_f32_16x16x32_bf16 v[64:67], v[24:27], a[56:59], v[64:67]
ds_read_b128 v[20:23], v2 offset:1024
v_exp_f32 v51, v51
v_mfma_f32_16x16x32_bf16 v[68:71], v[24:27], a[60:63], v[68:71]
v_mul_f32 v36, v36, v97
v_mul_f32 v57, v57, v49
v_fma_f32 v51, v51, v98, v98
v_mfma_f32_16x16x32_bf16 v[76:79], v[28:31], a[60:63], v[76:79]
ds_read_b128 v[24:27], v2 offset:2048
v_mul_f32 v37, v37, v97
v_mfma_f32_16x16x32_bf16 v[72:75], v[28:31], a[56:59], v[72:75]
v_rcp_f32 v50, v50
s_waitcnt lgkmcnt(1)
v_mfma_f32_16x16x32_bf16 v[64:67], v[16:19], a[64:67], v[64:67]
ds_read_b128 v[28:31], v2 offset:3072
v_exp_f32 v36, v36
v_mfma_f32_16x16x32_bf16 v[68:71], v[16:19], a[68:71], v[68:71]
v_cvt_pk_bf16_f32 v106, v56, v57
v_mul_f32 v58, v58, v50
v_fma_f32 v36, v36, v99, v99
v_mfma_f32_16x16x32_bf16 v[76:79], v[20:23], a[68:71], v[76:79]
ds_read_b128 v[16:19], v2 offset:4096
v_mul_f32 v38, v38, v97
v_mfma_f32_16x16x32_bf16 v[72:75], v[20:23], a[64:67], v[72:75]
v_rcp_f32 v51, v51
s_waitcnt lgkmcnt(1)
v_mfma_f32_16x16x32_bf16 v[64:67], v[24:27], a[72:75], v[64:67]
ds_read_b128 v[20:23], v2 offset:5120
v_exp_f32 v37, v37
v_mfma_f32_16x16x32_bf16 v[68:71], v[24:27], a[76:79], v[68:71]
s_waitcnt vmcnt(0)
v_mov_b32 v6, 3
s_mov_b64 exec, 1
s_cmp_lg_u32 s39, 0
s_cbranch_scc1 L_c_stg_48
buffer_store_dword v6, off, s[4:7], s81  offset:0
L_c_stb_49:
s_mov_b64 exec, -1
v_mfma_f32_16x16x32_bf16 v[76:79], v[28:31], a[76:79], v[76:79]
ds_read_b128 v[24:27], v2 offset:6144
v_mul_f32 v59, v59, v51
v_fma_f32 v37, v37, v99, v99
v_mfma_f32_16x16x32_bf16 v[72:75], v[28:31], a[72:75], v[72:75]
v_cmp_gt_u32 vcc, 2, v114
s_cbranch_vccnz L_c_psl_51
L_c_pok_50:
s_waitcnt lgkmcnt(1)
v_mfma_f32_16x16x32_bf16 v[64:67], v[16:19], a[80:83], v[64:67]
ds_read_b128 v[28:31], v2 offset:7168
v_rcp_f32 v36, v36
v_mfma_f32_16x16x32_bf16 v[68:71], v[16:19], a[84:87], v[68:71]
s_add_u32 s100, s83, 0xb41000
s_add_u32 s100, s100, s4
s_addc_u32 s101, s5, 0
global_load_dwordx4 a[0:3], v1, s[100:101] offset:-4096 sc1
v_mfma_f32_16x16x32_bf16 v[76:79], v[20:23], a[84:87], v[76:79]
ds_read_b128 v[16:19], v2 offset:8192
v_exp_f32 v38, v38
v_mfma_f32_16x16x32_bf16 v[72:75], v[20:23], a[80:83], v[72:75]
global_load_dwordx4 a[4:7], v1, s[100:101] offset:-3072 sc1
v_mul_f32 v39, v39, v97
v_cvt_pk_bf16_f32 v107, v58, v59
s_waitcnt lgkmcnt(1)
v_mfma_f32_16x16x32_bf16 v[64:67], v[24:27], a[88:91], v[64:67]
ds_read_b128 v[20:23], v2 offset:9216
v_mul_f32 v44, v44, v36
v_fma_f32 v38, v38, v99, v99
v_mfma_f32_16x16x32_bf16 v[68:71], v[24:27], a[92:95], v[68:71]
global_load_dwordx4 a[8:11], v1, s[100:101] offset:-2048 sc1
v_rcp_f32 v37, v37
v_mul_f32 v52, v52, v97
v_mfma_f32_16x16x32_bf16 v[76:79], v[28:31], a[92:95], v[76:79]
ds_read_b128 v[24:27], v2 offset:10240
v_exp_f32 v39, v39
v_mfma_f32_16x16x32_bf16 v[72:75], v[28:31], a[88:91], v[72:75]
global_load_dwordx4 a[12:15], v1, s[100:101] offset:-1024 sc1
v_mul_f32 v45, v45, v37
v_fma_f32 v39, v39, v99, v99
s_waitcnt lgkmcnt(1)
v_mfma_f32_16x16x32_bf16 v[64:67], v[16:19], a[96:99], v[64:67]
ds_read_b128 v[28:31], v2 offset:11264
v_rcp_f32 v38, v38
v_mfma_f32_16x16x32_bf16 v[68:71], v[16:19], a[100:103], v[68:71]
global_load_dwordx4 a[16:19], v1, s[100:101] offset:0 sc1
v_exp_f32 v52, v52
v_mul_f32 v53, v53, v97
v_mfma_f32_16x16x32_bf16 v[76:79], v[20:23], a[100:103], v[76:79]
ds_read_b128 v[16:19], v2 offset:12288
v_cvt_pk_bf16_f32 v108, v44, v45
v_mul_f32 v46, v46, v38
v_mfma_f32_16x16x32_bf16 v[72:75], v[20:23], a[96:99], v[72:75]
global_load_dwordx4 a[20:23], v1, s[100:101] offset:1024 sc1
v_rcp_f32 v39, v39
s_waitcnt lgkmcnt(1)
v_mfma_f32_16x16x32_bf16 v[64:67], v[24:27], a[104:107], v[64:67]
ds_read_b128 v[20:23], v2 offset:13312
v_fma_f32 v52, v52, v99, v99
v_mul_f32 v54, v54, v97
v_mfma_f32_16x16x32_bf16 v[68:71], v[24:27], a[108:111], v[68:71]
global_load_dwordx4 a[24:27], v1, s[100:101] offset:2048 sc1
v_exp_f32 v53, v53
v_mul_f32 v47, v47, v39
v_mfma_f32_16x16x32_bf16 v[76:79], v[28:31], a[108:111], v[76:79]
ds_read_b128 v[24:27], v2 offset:14336
v_rcp_f32 v52, v52
v_mfma_f32_16x16x32_bf16 v[72:75], v[28:31], a[104:107], v[72:75]
global_load_dwordx4 a[28:31], v1, s[100:101] offset:3072 sc1
v_fma_f32 v53, v53, v99, v99
v_mul_f32 v55, v55, v97
s_barrier
s_waitcnt lgkmcnt(1)
v_mfma_f32_16x16x32_bf16 v[64:67], v[16:19], a[112:115], v[64:67]
ds_read_b128 v[28:31], v2 offset:15360
v_exp_f32 v54, v54
v_mfma_f32_16x16x32_bf16 v[68:71], v[16:19], a[116:119], v[68:71]
s_add_u32 s100, s100, 0x2000
s_addc_u32 s101, s101, 0
global_load_dwordx4 a[32:35], v1, s[100:101] offset:-4096 sc1
v_cvt_pk_bf16_f32 v109, v46, v47
v_mfma_f32_16x16x32_bf16 v[76:79], v[20:23], a[116:119], v[76:79]
ds_read_b128 v[16:19], v81 offset:16384
v_mul_f32 v60, v60, v52
v_fma_f32 v54, v54, v99, v99
v_mfma_f32_16x16x32_bf16 v[72:75], v[20:23], a[112:115], v[72:75]
buffer_load_dword v114, v5, s[4:7], s57 offen nt
global_load_dwordx4 a[36:39], v1, s[100:101] offset:-3072 sc1
s_waitcnt lgkmcnt(1)
v_mfma_f32_16x16x32_bf16 v[64:67], v[24:27], a[120:123], v[64:67]
ds_read_b128 v[20:23], v81 offset:17408
v_rcp_f32 v53, v53
v_mfma_f32_16x16x32_bf16 v[68:71], v[24:27], a[124:127], v[68:71]
global_load_dwordx4 a[40:43], v1, s[100:101] offset:-2048 sc1
v_exp_f32 v55, v55
v_mul_f32 v61, v61, v53
v_mfma_f32_16x16x32_bf16 v[76:79], v[28:31], a[124:127], v[76:79]
ds_read_b128 v[24:27], v81 offset:18432
v_rcp_f32 v54, v54
v_mfma_f32_16x16x32_bf16 v[72:75], v[28:31], a[120:123], v[72:75]
global_load_dwordx4 a[44:47], v1, s[100:101] offset:-1024 sc1
v_fma_f32 v55, v55, v99, v99
v_cvt_pk_bf16_f32 v110, v60, v61
v_mul_f32 v62, v62, v54
v_rcp_f32 v55, v55
s_nop 0
v_mul_f32 v63, v63, v55
v_cvt_pk_bf16_f32 v111, v62, v63
s_add_u32 s49, s58, 0xb48000
buffer_store_dwordx4 v[104:107], v1, s[4:7], s49 offen offset:0 sc1
buffer_store_dwordx4 v[108:111], v1, s[4:7], s49 offen offset:1024 sc1
L_ph4_0:
v_lshlrev_b32 v32, 16, v8
v_and_b32 v33, 0xffff0000, v8
v_lshlrev_b32 v34, 16, v9
v_and_b32 v35, 0xffff0000, v9
v_lshlrev_b32 v40, 16, v10
v_and_b32 v41, 0xffff0000, v10
v_lshlrev_b32 v42, 16, v11
v_and_b32 v43, 0xffff0000, v11
v_lshlrev_b32 v36, 16, v12
v_and_b32 v37, 0xffff0000, v12
v_lshlrev_b32 v38, 16, v13
v_and_b32 v39, 0xffff0000, v13
v_lshlrev_b32 v44, 16, v14
v_and_b32 v45, 0xffff0000, v14
v_lshlrev_b32 v46, 16, v15
v_and_b32 v47, 0xffff0000, v15
s_waitcnt vmcnt(13)
s_waitcnt lgkmcnt(1)
v_mfma_f32_16x16x32_bf16 v[32:35], v[16:19], a[0:3], v[32:35]
ds_read_b128 v[28:31], v81 offset:19456
v_mul_f32 v64, v64, v96
v_mfma_f32_16x16x32_bf16 v[36:39], v[16:19], a[4:7], v[36:39]
global_load_dwordx4 a[48:51], v1, s[100:101] offset:0 sc1
v_exp_f32 v64, v64
v_mfma_f32_16x16x32_bf16 v[44:47], v[20:23], a[4:7], v[44:47]
ds_read_b128 v[16:19], v81 offset:20480
v_mul_f32 v65, v65, v96
v_mfma_f32_16x16x32_bf16 v[40:43], v[20:23], a[0:3], v[40:43]
global_load_dwordx4 a[52:55], v1, s[100:101] offset:1024 sc1
v_fma_f32 v64, v64, v98, v98
s_waitcnt lgkmcnt(1)
v_mfma_f32_16x16x32_bf16 v[48:51], v[24:27], a[0:3], 0
ds_read_b128 v[20:23], v81 offset:21504
v_mul_f32 v66, v66, v96
v_mfma_f32_16x16x32_bf16 v[52:55], v[24:27], a[4:7], 0
v_exp_f32 v65, v65
v_mul_f32 v67, v67, v96
v_mfma_f32_16x16x32_bf16 v[60:63], v[28:31], a[4:7], 0
ds_read_b128 v[24:27], v81 offset:22528
v_fma_f32 v65, v65, v98, v98
v_mfma_f32_16x16x32_bf16 v[56:59], v[28:31], a[0:3], 0
s_barrier
s_waitcnt vmcnt(13)
s_waitcnt lgkmcnt(1)
v_mfma_f32_16x16x32_bf16 v[32:35], v[16:19], a[8:11], v[32:35]
ds_read_b128 v[28:31], v81 offset:23552
v_mfma_f32_16x16x32_bf16 v[36:39], v[16:19], a[12:15], v[36:39]
global_load_dwordx4 a[56:59], v1, s[100:101] offset:2048 sc1
v_mfma_f32_16x16x32_bf16 v[44:47], v[20:23], a[12:15], v[44:47]
ds_read_b128 v[16:19], v81 offset:32768
v_mfma_f32_16x16x32_bf16 v[40:43], v[20:23], a[8:11], v[40:43]
global_load_dwordx4 a[60:63], v1, s[100:101] offset:3072 sc1
s_waitcnt lgkmcnt(1)
v_mfma_f32_16x16x32_bf16 v[48:51], v[24:27], a[8:11], v[48:51]
ds_read_b128 v[20:23], v81 offset:33792
v_rcp_f32 v64, v64
v_mfma_f32_16x16x32_bf16 v[52:55], v[24:27], a[12:15], v[52:55]
v_exp_f32 v66, v66
v_mul_f32 v72, v72, v64
v_mfma_f32_16x16x32_bf16 v[60:63], v[28:31], a[12:15], v[60:63]
ds_read_b128 v[24:27], v81 offset:34816
v_fma_f32 v66, v66, v98, v98
v_mfma_f32_16x16x32_bf16 v[56:59], v[28:31], a[8:11], v[56:59]
v_rcp_f32 v65, v65
s_waitcnt vmcnt(13)
s_waitcnt lgkmcnt(1)
v_mfma_f32_16x16x32_bf16 v[32:35], v[16:19], a[16:19], v[32:35]
ds_read_b128 v[28:31], v81 offset:35840
v_mul_f32 v68, v68, v97
v_mfma_f32_16x16x32_bf16 v[36:39], v[16:19], a[20:23], v[36:39]
s_waitcnt vmcnt(9)
v_cmp_gt_u32 vcc, 3, v114
s_cbranch_vccnz L_c_psl_57
L_c_pok_56:
s_add_u32 s100, s100, 0x2000
s_addc_u32 s101, s101, 0
global_load_dwordx4 a[64:67], v1, s[100:101] offset:-4096 sc1
v_mfma_f32_16x16x32_bf16 v[44:47], v[20:23], a[20:23], v[44:47]
ds_read_b128 v[16:19], v81 offset:36864
v_mul_f32 v73, v73, v65
v_mfma_f32_16x16x32_bf16 v[40:43], v[20:23], a[16:19], v[40:43]
global_load_dwordx4 a[68:71], v1, s[100:101] offset:-3072 sc1
v_mul_f32 v69, v69, v97
s_waitcnt lgkmcnt(1)
v_mfma_f32_16x16x32_bf16 v[48:51], v[24:27], a[16:19], v[48:51]
ds_read_b128 v[20:23], v81 offset:37888
v_cvt_pk_bf16_f32 v104, v72, v73
v_mfma_f32_16x16x32_bf16 v[52:55], v[24:27], a[20:23], v[52:55]
v_exp_f32 v67, v67
v_mfma_f32_16x16x32_bf16 v[60:63], v[28:31], a[20:23], v[60:63]
ds_read_b128 v[24:27], v81 offset:38912
v_fma_f32 v67, v67, v98, v98
v_mfma_f32_16x16x32_bf16 v[56:59], v[28:31], a[16:19], v[56:59]
v_rcp_f32 v66, v66
s_waitcnt lgkmcnt(1)
v_mfma_f32_16x16x32_bf16 v[32:35], v[16:19], a[24:27], v[32:35]
ds_read_b128 v[28:31], v81 offset:39936
v_mul_f32 v74, v74, v66
v_mfma_f32_16x16x32_bf16 v[36:39], v[16:19], a[28:31], v[36:39]
global_load_dwordx4 a[72:75], v1, s[100:101] offset:-2048 sc1
v_mul_f32 v70, v70, v97
v_mfma_f32_16x16x32_bf16 v[44:47], v[20:23], a[28:31], v[44:47]
ds_read_b128 v[16:19], v81 offset:49152
v_mfma_f32_16x16x32_bf16 v[40:43], v[20:23], a[24:27], v[40:43]
global_load_dwordx4 a[76:79], v1, s[100:101] offset:-1024 sc1
s_waitcnt lgkmcnt(1)
v_mfma_f32_16x16x32_bf16 v[48:51], v[24:27], a[24:27], v[48:51]
ds_read_b128 v[20:23], v81 offset:50176
v_exp_f32 v68, v68
v_mfma_f32_16x16x32_bf16 v[52:55], v[24:27], a[28:31], v[52:55]
v_rcp_f32 v67, v67
v_fma_f32 v68, v68, v99, v99
v_mfma_f32_16x16x32_bf16 v[60:63], v[28:31], a[28:31], v[60:63]
ds_read_b128 v[24:27], v81 offset:51200
v_mul_f32 v75, v75, v67
v_mfma_f32_16x16x32_bf16 v[56:59], v[28:31], a[24:27], v[56:59]
v_mul_f32 v71, v71, v97
s_waitcnt vmcnt(12)
s_waitcnt lgkmcnt(1)
v_mfma_f32_16x16x32_bf16 v[32:35], v[16:19], a[32:35], v[32:35]
ds_read_b128 v[28:31], v81 offset:52224
v_cvt_pk_bf16_f32 v105, v74, v75
v_mfma_f32_16x16x32_bf16 v[36:39], v[16:19], a[36:39], v[36:39]
global_load_dwordx4 a[80:83], v1, s[100:101] offset:0 sc1
v_mfma_f32_16x16x32_bf16 v[44:47], v[20:23], a[36:39], v[44:47]
ds_read_b128 v[16:19], v81 offset:53248
v_mfma_f32_16x16x32_bf16 v[40:43], v[20:23], a[32:35], v[40:43]
global_load_dwordx4 a[84:87], v1, s[100:101] offset:1024 sc1
s_waitcnt lgkmcnt(1)
v_mfma_f32_16x16x32_bf16 v[48:51], v[24:27], a[32:35], v[48:51]
ds_read_b128 v[20:23], v81 offset:54272
v_exp_f32 v69, v69
v_mfma_f32_16x16x32_bf16 v[52:55], v[24:27], a[36:39], v[52:55]
v_rcp_f32 v68, v68
v_fma_f32 v69, v69, v99, v99
v_mfma_f32_16x16x32_bf16 v[60:63], v[28:31], a[36:39], v[60:63]
ds_read_b128 v[24:27], v81 offset:55296
v_mul_f32 v76, v76, v68
v_mfma_f32_16x16x32_bf16 v[56:59], v[28:31], a[32:35], v[56:59]
s_barrier
s_waitcnt vmcnt(12)
s_waitcnt lgkmcnt(1)
v_mfma_f32_16x16x32_bf16 v[32:35], v[16:19], a[40:43], v[32:35]
ds_read_b128 v[28:31], v81 offset:56320
v_mfma_f32_16x16x32_bf16 v[36:39], v[16:19], a[44:47], v[36:39]
s_waitcnt vmcnt(10)
v_mov_b32 v6, 4
s_mov_b64 exec, 1
s_cmp_lg_u32 s39, 0
s_cbranch_scc1 L_c_stg_60
buffer_store_dword v6, off, s[4:7], s81  offset:0
L_c_stb_61:
s_mov_b64 exec, -1
global_load_dwordx4 a[88:91], v1, s[100:101] offset:2048 sc1
v_mfma_f32_16x16x32_bf16 v[44:47], v[20:23], a[44:47], v[44:47]
ds_read_b128 v[16:19], v82 offset:0
v_exp_f32 v70, v70
v_mfma_f32_16x16x32_bf16 v[40:43], v[20:23], a[40:43], v[40:43]
global_load_dwordx4 a[92:95], v1, s[100:101] offset:3072 sc1
v_fma_f32 v70, v70, v99, v99
s_waitcnt lgkmcnt(1)
v_mfma_f32_16x16x32_bf16 v[48:51], v[24:27], a[40:43], v[48:51]
ds_read_b128 v[20:23], v82 offset:1024
v_rcp_f32 v69, v69
v_mfma_f32_16x16x32_bf16 v[52:55], v[24:27], a[44:47], v[52:55]
v_exp_f32 v71, v71
v_mul_f32 v77, v77, v69
v_mfma_f32_16x16x32_bf16 v[60:63], v[28:31], a[44:47], v[60:63]
ds_read_b128 v[24:27], v82 offset:2048
v_fma_f32 v71, v71, v99, v99
v_mfma_f32_16x16x32_bf16 v[56:59], v[28:31], a[40:43], v[56:59]
v_cvt_pk_bf16_f32 v106, v76, v77
s_waitcnt vmcnt(11)
s_waitcnt lgkmcnt(1)
v_mfma_f32_16x16x32_bf16 v[32:35], v[16:19], a[48:51], v[32:35]
ds_read_b128 v[28:31], v82 offset:3072
v_mfma_f32_16x16x32_bf16 v[36:39], v[16:19], a[52:55], v[36:39]
s_add_u32 s100, s100, 0x2000
s_addc_u32 s101, s101, 0
global_load_dwordx4 a[96:99], v1, s[100:101] offset:-4096 sc1
v_mfma_f32_16x16x32_bf16 v[44:47], v[20:23], a[52:55], v[44:47]
ds_read_b128 v[16:19], v82 offset:4096
v_mfma_f32_16x16x32_bf16 v[40:43], v[20:23], a[48:51], v[40:43]
global_load_dwordx4 a[100:103], v1, s[100:101] offset:-3072 sc1
s_waitcnt lgkmcnt(1)
v_mfma_f32_16x16x32_bf16 v[48:51], v[24:27], a[48:51], v[48:51]
ds_read_b128 v[20:23], v82 offset:5120
v_rcp_f32 v70, v70
v_mfma_f32_16x16x32_bf16 v[52:55], v[24:27], a[52:55], v[52:55]
v_mul_f32 v78, v78, v70
v_rcp_f32 v71, v71
v_mfma_f32_16x16x32_bf16 v[60:63], v[28:31], a[52:55], v[60:63]
ds_read_b128 v[24:27], v82 offset:6144
v_mul_f32 v79, v79, v71
v_mfma_f32_16x16x32_bf16 v[56:59], v[28:31], a[48:51], v[56:59]
v_cvt_pk_bf16_f32 v107, v78, v79
s_add_u32 s49, s59, 0xb40000
buffer_store_dwordx4 v[104:107], v1, s[4:7], s49 offen offset:0 sc1
s_waitcnt vmcnt(12)
s_waitcnt lgkmcnt(1)
v_mfma_f32_16x16x32_bf16 v[32:35], v[16:19], a[56:59], v[32:35]
ds_read_b128 v[28:31], v82 offset:7168
v_mfma_f32_16x16x32_bf16 v[36:39], v[16:19], a[60:63], v[36:39]
global_load_dwordx4 a[104:107], v1, s[100:101] offset:-2048 sc1
v_mfma_f32_16x16x32_bf16 v[44:47], v[20:23], a[60:63], v[44:47]
ds_read_b128 v[16:19], v80 offset:0
v_mfma_f32_16x16x32_bf16 v[40:43], v[20:23], a[56:59], v[40:43]
buffer_load_dword v114, v5, s[4:7], s57 offen nt
global_load_dwordx4 a[108:111], v1, s[100:101] offset:-1024 sc1
s_waitcnt lgkmcnt(1)
v_mfma_f32_16x16x32_bf16 v[48:51], v[24:27], a[56:59], v[48:51]
ds_read_b128 v[20:23], v80 offset:1024
v_mfma_f32_16x16x32_bf16 v[52:55], v[24:27], a[60:63], v[52:55]
v_mfma_f32_16x16x32_bf16 v[60:63], v[28:31], a[60:63], v[60:63]
ds_read_b128 v[24:27], v80 offset:2048
v_mfma_f32_16x16x32_bf16 v[56:59], v[28:31], a[56:59], v[56:59]
s_waitcnt vmcnt(13)
s_waitcnt lgkmcnt(1)
v_mfma_f32_16x16x32_bf16 v[32:35], v[16:19], a[64:67], v[32:35]
ds_read_b128 v[28:31], v80 offset:3072
v_mfma_f32_16x16x32_bf16 v[36:39], v[16:19], a[68:71], v[36:39]
global_load_dwordx4 a[112:115], v1, s[100:101] offset:0 sc1
v_mfma_f32_16x16x32_bf16 v[44:47], v[20:23], a[68:71], v[44:47]
ds_read_b128 v[16:19], v80 offset:4096
v_mfma_f32_16x16x32_bf16 v[40:43], v[20:23], a[64:67], v[40:43]
global_load_dwordx4 a[116:119], v1, s[100:101] offset:1024 sc1
s_waitcnt lgkmcnt(1)
v_mfma_f32_16x16x32_bf16 v[48:51], v[24:27], a[64:67], v[48:51]
ds_read_b128 v[20:23], v80 offset:5120
v_mfma_f32_16x16x32_bf16 v[52:55], v[24:27], a[68:71], v[52:55]
v_mfma_f32_16x16x32_bf16 v[60:63], v[28:31], a[68:71], v[60:63]
ds_read_b128 v[24:27], v80 offset:6144
v_mfma_f32_16x16x32_bf16 v[56:59], v[28:31], a[64:67], v[56:59]
s_barrier
s_waitcnt vmcnt(13)
s_waitcnt lgkmcnt(1)
v_mfma_f32_16x16x32_bf16 v[32:35], v[16:19], a[72:75], v[32:35]
ds_read_b128 v[28:31], v80 offset:7168
v_mfma_f32_16x16x32_bf16 v[36:39], v[16:19], a[76:79], v[36:39]
global_load_dwordx4 a[120:123], v1, s[100:101] offset:2048 sc1
v_mfma_f32_16x16x32_bf16 v[44:47], v[20:23], a[76:79], v[44:47]
ds_read_b128 v[16:19], v80 offset:16384
v_mfma_f32_16x16x32_bf16 v[40:43], v[20:23], a[72:75], v[40:43]
global_load_dwordx4 a[124:127], v1, s[100:101] offset:3072 sc1
s_waitcnt lgkmcnt(1)
v_mfma_f32_16x16x32_bf16 v[48:51], v[24:27], a[72:75], v[48:51]
ds_read_b128 v[20:23], v80 offset:17408
v_mfma_f32_16x16x32_bf16 v[52:55], v[24:27], a[76:79], v[52:55]
v_mfma_f32_16x16x32_bf16 v[60:63], v[28:31], a[76:79], v[60:63]
ds_read_b128 v[24:27], v80 offset:18432
v_mfma_f32_16x16x32_bf16 v[56:59], v[28:31], a[72:75], v[56:59]
s_waitcnt vmcnt(13)
s_waitcnt lgkmcnt(1)
v_mfma_f32_16x16x32_bf16 v[32:35], v[16:19], a[80:83], v[32:35]
ds_read_b128 v[28:31], v80 offset:19456
v_mfma_f32_16x16x32_bf16 v[36:39], v[16:19], a[84:87], v[36:39]
s_waitcnt vmcnt(5)
v_cmp_gt_u32 vcc, 4, v114
s_cbranch_vccnz L_c_psl_65
L_c_pok_64:
s_add_u32 s100, s100, 0x2000
s_addc_u32 s101, s101, 0
global_load_dwordx4 a[0:3], v1, s[100:101] offset:-4096 sc1
v_mfma_f32_16x16x32_bf16 v[44:47], v[20:23], a[84:87], v[44:47]
ds_read_b128 v[16:19], v80 offset:20480
v_mfma_f32_16x16x32_bf16 v[40:43], v[20:23], a[80:83], v[40:43]
global_load_dwordx4 a[4:7], v1, s[100:101] offset:-3072 sc1
s_waitcnt lgkmcnt(1)
v_mfma_f32_16x16x32_bf16 v[48:51], v[24:27], a[80:83], v[48:51]
ds_read_b128 v[20:23], v80 offset:21504
v_mfma_f32_16x16x32_bf16 v[52:55], v[24:27], a[84:87], v[52:55]
v_mfma_f32_16x16x32_bf16 v[60:63], v[28:31], a[84:87], v[60:63]
ds_read_b128 v[24:27], v80 offset:22528
v_mfma_f32_16x16x32_bf16 v[56:59], v[28:31], a[80:83], v[56:59]
s_waitcnt lgkmcnt(1)
v_mfma_f32_16x16x32_bf16 v[32:35], v[16:19], a[88:91], v[32:35]
ds_read_b128 v[28:31], v80 offset:23552
v_mfma_f32_16x16x32_bf16 v[36:39], v[16:19], a[92:95], v[36:39]
global_load_dwordx4 a[8:11], v1, s[100:101] offset:-2048 sc1
v_mfma_f32_16x16x32_bf16 v[44:47], v[20:23], a[92:95], v[44:47]
ds_read_b128 v[16:19], v80 offset:32768
v_mfma_f32_16x16x32_bf16 v[40:43], v[20:23], a[88:91], v[40:43]
global_load_dwordx4 a[12:15], v1, s[100:101] offset:-1024 sc1
s_waitcnt lgkmcnt(1)
v_mfma_f32_16x16x32_bf16 v[48:51], v[24:27], a[88:91], v[48:51]
ds_read_b128 v[20:23], v80 offset:33792
v_mfma_f32_16x16x32_bf16 v[52:55], v[24:27], a[92:95], v[52:55]
v_mfma_f32_16x16x32_bf16 v[60:63], v[28:31], a[92:95], v[60:63]
ds_read_b128 v[24:27], v80 offset:34816
v_mfma_f32_16x16x32_bf16 v[56:59], v[28:31], a[88:91], v[56:59]
s_waitcnt lgkmcnt(1)
v_mfma_f32_16x16x32_bf16 v[32:35], v[16:19], a[96:99], v[32:35]
ds_read_b128 v[28:31], v80 offset:35840
v_mfma_f32_16x16x32_bf16 v[36:39], v[16:19], a[100:103], v[36:39]
v_mov_b32 v6, 5
s_mov_b64 exec, 1
s_cmp_lg_u32 s39, 0
s_cbranch_scc1 L_c_stg_68
buffer_store_dword v6, off, s[4:7], s81  offset:0
L_c_stb_69:
s_mov_b64 exec, -1
global_load_dwordx4 a[16:19], v1, s[100:101] offset:0 sc1
v_mfma_f32_16x16x32_bf16 v[44:47], v[20:23], a[100:103], v[44:47]
ds_read_b128 v[16:19], v80 offset:36864
v_mfma_f32_16x16x32_bf16 v[40:43], v[20:23], a[96:99], v[40:43]
global_load_dwordx4 a[20:23], v1, s[100:101] offset:1024 sc1
s_waitcnt lgkmcnt(1)
v_mfma_f32_16x16x32_bf16 v[48:51], v[24:27], a[96:99], v[48:51]
ds_read_b128 v[20:23], v80 offset:37888
v_mfma_f32_16x16x32_bf16 v[52:55], v[24:27], a[100:103], v[52:55]
v_mfma_f32_16x16x32_bf16 v[60:63], v[28:31], a[100:103], v[60:63]
ds_read_b128 v[24:27], v80 offset:38912
v_mfma_f32_16x16x32_bf16 v[56:59], v[28:31], a[96:99], v[56:59]
s_barrier
s_waitcnt vmcnt(11)
s_waitcnt lgkmcnt(1)
v_mfma_f32_16x16x32_bf16 v[32:35], v[16:19], a[104:107], v[32:35]
ds_read_b128 v[28:31], v80 offset:39936
v_mfma_f32_16x16x32_bf16 v[36:39], v[16:19], a[108:111], v[36:39]
global_load_dwordx4 a[24:27], v1, s[100:101] offset:2048 sc1
v_mfma_f32_16x16x32_bf16 v[44:47], v[20:23], a[108:111], v[44:47]
ds_read_b128 v[16:19], v80 offset:49152
v_mfma_f32_16x16x32_bf16 v[40:43], v[20:23], a[104:107], v[40:43]
global_load_dwordx4 a[28:31], v1, s[100:101] offset:3072 sc1
s_waitcnt lgkmcnt(1)
v_mfma_f32_16x16x32_bf16 v[48:51], v[24:27], a[104:107], v[48:51]
ds_read_b128 v[20:23], v80 offset:50176
v_mfma_f32_16x16x32_bf16 v[52:55], v[24:27], a[108:111], v[52:55]
v_mfma_f32_16x16x32_bf16 v[60:63], v[28:31], a[108:111], v[60:63]
ds_read_b128 v[24:27], v80 offset:51200
v_mfma_f32_16x16x32_bf16 v[56:59], v[28:31], a[104:107], v[56:59]
s_waitcnt vmcnt(11)
s_waitcnt lgkmcnt(1)
v_mfma_f32_16x16x32_bf16 v[32:35], v[16:19], a[112:115], v[32:35]
ds_read_b128 v[28:31], v80 offset:52224
v_mfma_f32_16x16x32_bf16 v[36:39], v[16:19], a[116:119], v[36:39]
s_add_u32 s100, s100, 0x2000
s_addc_u32 s101, s101, 0
global_load_dwordx4 a[32:35], v1, s[100:101] offset:-4096 sc1
v_mfma_f32_16x16x32_bf16 v[44:47], v[20:23], a[116:119], v[44:47]
ds_read_b128 v[16:19], v80 offset:53248
v_mfma_f32_16x16x32_bf16 v[40:43], v[20:23], a[112:115], v[40:43]
buffer_load_dword v114, v5, s[4:7], s57 offen nt
global_load_dwordx4 a[36:39], v1, s[100:101] offset:-3072 sc1
s_waitcnt lgkmcnt(1)
v_mfma_f32_16x16x32_bf16 v[48:51], v[24:27], a[112:115], v[48:51]
ds_read_b128 v[20:23], v80 offset:54272
v_mfma_f32_16x16x32_bf16 v[52:55], v[24:27], a[116:119], v[52:55]
v_mfma_f32_16x16x32_bf16 v[60:63], v[28:31], a[116:119], v[60:63]
ds_read_b128 v[24:27], v80 offset:55296
v_mfma_f32_16x16x32_bf16 v[56:59], v[28:31], a[112:115], v[56:59]
s_waitcnt vmcnt(12)
s_waitcnt lgkmcnt(1)
v_mfma_f32_16x16x32_bf16 v[32:35], v[16:19], a[120:123], v[32:35]
ds_read_b128 v[28:31], v80 offset:56320
v_mfma_f32_16x16x32_bf16 v[36:39], v[16:19], a[124:127], v[36:39]
global_load_dwordx4 a[40:43], v1, s[100:101] offset:-2048 sc1
v_mfma_f32_16x16x32_bf16 v[44:47], v[20:23], a[124:127], v[44:47]
ds_read_b128 v[16:19], v81 offset:0
v_mfma_f32_16x16x32_bf16 v[40:43], v[20:23], a[120:123], v[40:43]
global_load_dwordx4 a[44:47], v1, s[100:101] offset:-1024 sc1
s_waitcnt lgkmcnt(1)
v_mfma_f32_16x16x32_bf16 v[48:51], v[24:27], a[120:123], v[48:51]
ds_read_b128 v[20:23], v81 offset:1024
v_mfma_f32_16x16x32_bf16 v[52:55], v[24:27], a[124:127], v[52:55]
v_mfma_f32_16x16x32_bf16 v[60:63], v[28:31], a[124:127], v[60:63]
ds_read_b128 v[24:27], v81 offset:2048
v_mfma_f32_16x16x32_bf16 v[56:59], v[28:31], a[120:123], v[56:59]
s_waitcnt vmcnt(12)
s_waitcnt lgkmcnt(1)
v_mfma_f32_16x16x32_bf16 v[32:35], v[16:19], a[0:3], v[32:35]
ds_read_b128 v[28:31], v81 offset:3072
v_mfma_f32_16x16x32_bf16 v[36:39], v[16:19], a[4:7], v[36:39]
global_load_dwordx4 a[48:51], v1, s[100:101] offset:0 sc1
v_mfma_f32_16x16x32_bf16 v[44:47], v[20:23], a[4:7], v[44:47]
ds_read_b128 v[16:19], v81 offset:4096
v_mfma_f32_16x16x32_bf16 v[40:43], v[20:23], a[0:3], v[40:43]
global_load_dwordx4 a[52:55], v1, s[100:101] offset:1024 sc1
s_waitcnt lgkmcnt(1)
v_mfma_f32_16x16x32_bf16 v[48:51], v[24:27], a[0:3], v[48:51]
ds_read_b128 v[20:23], v81 offset:5120
v_mfma_f32_16x16x32_bf16 v[52:55], v[24:27], a[4:7], v[52:55]
v_mfma_f32_16x16x32_bf16 v[60:63], v[28:31], a[4:7], v[60:63]
ds_read_b128 v[24:27], v81 offset:6144
v_mfma_f32_16x16x32_bf16 v[56:59], v[28:31], a[0:3], v[56:59]
s_barrier
s_waitcnt vmcnt(12)
s_waitcnt lgkmcnt(1)
v_mfma_f32_16x16x32_bf16 v[32:35], v[16:19], a[8:11], v[32:35]
ds_read_b128 v[28:31], v81 offset:7168
v_mfma_f32_16x16x32_bf16 v[36:39], v[16:19], a[12:15], v[36:39]
global_load_dwordx4 a[56:59], v1, s[100:101] offset:2048 sc1
v_mfma_f32_16x16x32_bf16 v[44:47], v[20:23], a[12:15], v[44:47]
ds_read_b128 v[16:19], v81 offset:16384
v_mfma_f32_16x16x32_bf16 v[40:43], v[20:23], a[8:11], v[40:43]
global_load_dwordx4 a[60:63], v1, s[100:101] offset:3072 sc1
s_waitcnt lgkmcnt(1)
v_mfma_f32_16x16x32_bf16 v[48:51], v[24:27], a[8:11], v[48:51]
ds_read_b128 v[20:23], v81 offset:17408
v_mfma_f32_16x16x32_bf16 v[52:55], v[24:27], a[12:15], v[52:55]
v_mfma_f32_16x16x32_bf16 v[60:63], v[28:31], a[12:15], v[60:63]
ds_read_b128 v[24:27], v81 offset:18432
v_mfma_f32_16x16x32_bf16 v[56:59], v[28:31], a[8:11], v[56:59]
s_waitcnt vmcnt(11)
s_waitcnt lgkmcnt(1)
v_mfma_f32_16x16x32_bf16 v[32:35], v[16:19], a[16:19], v[32:35]
ds_read_b128 v[28:31], v81 offset:19456
v_mfma_f32_16x16x32_bf16 v[36:39], v[16:19], a[20:23], v[36:39]
s_waitcnt vmcnt(7)
v_cmp_gt_u32 vcc, 5, v114
s_cbranch_vccnz L_c_psl_71
L_c_pok_70:
s_add_u32 s100, s100, 0x2000
s_addc_u32 s101, s101, 0
global_load_dwordx4 v[64:67], v1, s[100:101] offset:-4096 sc1
v_mfma_f32_16x16x32_bf16 v[44:47], v[20:23], a[20:23], v[44:47]
ds_read_b128 v[16:19], v81 offset:20480
v_mfma_f32_16x16x32_bf16 v[40:43], v[20:23], a[16:19], v[40:43]
global_load_dwordx4 v[68:71], v1, s[100:101] offset:-3072 sc1
s_waitcnt lgkmcnt(1)
v_mfma_f32_16x16x32_bf16 v[48:51], v[24:27], a[16:19], v[48:51]
ds_read_b128 v[20:23], v81 offset:21504
v_mfma_f32_16x16x32_bf16 v[52:55], v[24:27], a[20:23], v[52:55]
v_mfma_f32_16x16x32_bf16 v[60:63], v[28:31], a[20:23], v[60:63]
ds_read_b128 v[24:27], v81 offset:22528
v_mfma_f32_16x16x32_bf16 v[56:59], v[28:31], a[16:19], v[56:59]
s_waitcnt lgkmcnt(1)
v_mfma_f32_16x16x32_bf16 v[32:35], v[16:19], a[24:27], v[32:35]
ds_read_b128 v[28:31], v81 offset:23552
v_mfma_f32_16x16x32_bf16 v[36:39], v[16:19], a[28:31], v[36:39]
global_load_dwordx4 v[72:75], v1, s[100:101] offset:-2048 sc1
v_mfma_f32_16x16x32_bf16 v[44:47], v[20:23], a[28:31], v[44:47]
ds_read_b128 v[16:19], v81 offset:32768
v_mfma_f32_16x16x32_bf16 v[40:43], v[20:23], a[24:27], v[40:43]
global_load_dwordx4 v[76:79], v1, s[100:101] offset:-1024 sc1
s_waitcnt lgkmcnt(1)
v_mfma_f32_16x16x32_bf16 v[48:51], v[24:27], a[24:27], v[48:51]
ds_read_b128 v[20:23], v81 offset:33792
v_mfma_f32_16x16x32_bf16 v[52:55], v[24:27], a[28:31], v[52:55]
v_mfma_f32_16x16x32_bf16 v[60:63], v[28:31], a[28:31], v[60:63]
ds_read_b128 v[24:27], v81 offset:34816
v_mfma_f32_16x16x32_bf16 v[56:59], v[28:31], a[24:27], v[56:59]
s_waitcnt vmcnt(10)
s_waitcnt lgkmcnt(1)
v_mfma_f32_16x16x32_bf16 v[32:35], v[16:19], a[32:35], v[32:35]
ds_read_b128 v[28:31], v81 offset:35840
v_mfma_f32_16x16x32_bf16 v[36:39], v[16:19], a[36:39], v[36:39]
global_load_dwordx4 v[84:87], v1, s[100:101] offset:0 sc1
v_mfma_f32_16x16x32_bf16 v[44:47], v[20:23], a[36:39], v[44:47]
ds_read_b128 v[16:19], v81 offset:36864
v_mfma_f32_16x16x32_bf16 v[40:43], v[20:23], a[32:35], v[40:43]
global_load_dwordx4 v[88:91], v1, s[100:101] offset:1024 sc1
s_waitcnt lgkmcnt(1)
v_mfma_f32_16x16x32_bf16 v[48:51], v[24:27], a[32:35], v[48:51]
ds_read_b128 v[20:23], v81 offset:37888
v_mfma_f32_16x16x32_bf16 v[52:55], v[24:27], a[36:39], v[52:55]
v_mfma_f32_16x16x32_bf16 v[60:63], v[28:31], a[36:39], v[60:63]
ds_read_b128 v[24:27], v81 offset:38912
v_mfma_f32_16x16x32_bf16 v[56:59], v[28:31], a[32:35], v[56:59]
s_barrier
s_waitcnt vmcnt(10)
s_waitcnt lgkmcnt(1)
v_mfma_f32_16x16x32_bf16 v[32:35], v[16:19], a[40:43], v[32:35]
ds_read_b128 v[28:31], v81 offset:39936
v_mfma_f32_16x16x32_bf16 v[36:39], v[16:19], a[44:47], v[36:39]
global_load_dwordx4 v[92:95], v1, s[100:101] offset:2048 sc1
v_mfma_f32_16x16x32_bf16 v[44:47], v[20:23], a[44:47], v[44:47]
ds_read_b128 v[16:19], v81 offset:49152
v_mfma_f32_16x16x32_bf16 v[40:43], v[20:23], a[40:43], v[40:43]
global_load_dwordx4 v[96:99], v1, s[100:101] offset:3072 sc1
s_add_u32 s49, s69, 0x940000
s_bfm_b64 exec, 16, 0
buffer_load_dword v6, v125, s[4:7], s49 offen sc1
s_mov_b64 exec, -1
s_add_u32 s49, s61, 0x13c0000
s_bfm_b64 exec, 8, 0
buffer_load_dword v6, v125, s[4:7], s49 offen sc1
s_mov_b64 exec, -1
s_waitcnt lgkmcnt(1)
v_mfma_f32_16x16x32_bf16 v[48:51], v[24:27], a[40:43], v[48:51]
ds_read_b128 v[20:23], v81 offset:50176
v_mfma_f32_16x16x32_bf16 v[52:55], v[24:27], a[44:47], v[52:55]
v_mfma_f32_16x16x32_bf16 v[60:63], v[28:31], a[44:47], v[60:63]
ds_read_b128 v[24:27], v81 offset:51200
v_mfma_f32_16x16x32_bf16 v[56:59], v[28:31], a[40:43], v[56:59]
s_waitcnt vmcnt(12)
s_waitcnt lgkmcnt(1)
v_mfma_f32_16x16x32_bf16 v[32:35], v[16:19], a[48:51], v[32:35]
ds_read_b128 v[28:31], v81 offset:52224
v_mfma_f32_16x16x32_bf16 v[36:39], v[16:19], a[52:55], v[36:39]
v_mfma_f32_16x16x32_bf16 v[44:47], v[20:23], a[52:55], v[44:47]
ds_read_b128 v[16:19], v81 offset:53248
v_mfma_f32_16x16x32_bf16 v[40:43], v[20:23], a[48:51], v[40:43]
s_waitcnt lgkmcnt(1)
v_mfma_f32_16x16x32_bf16 v[48:51], v[24:27], a[48:51], v[48:51]
ds_read_b128 v[20:23], v81 offset:54272
v_mfma_f32_16x16x32_bf16 v[52:55], v[24:27], a[52:55], v[52:55]
v_mfma_f32_16x16x32_bf16 v[60:63], v[28:31], a[52:55], v[60:63]
ds_read_b128 v[24:27], v81 offset:55296
v_mfma_f32_16x16x32_bf16 v[56:59], v[28:31], a[48:51], v[56:59]
s_waitcnt vmcnt(10)
s_waitcnt lgkmcnt(1)
v_mfma_f32_16x16x32_bf16 v[32:35], v[16:19], a[56:59], v[32:35]
ds_read_b128 v[28:31], v81 offset:56320
v_mfma_f32_16x16x32_bf16 v[36:39], v[16:19], a[60:63], v[36:39]
v_mfma_f32_16x16x32_bf16 v[44:47], v[20:23], a[60:63], v[44:47]
ds_read_b128 v[16:19], v82 offset:0
v_mfma_f32_16x16x32_bf16 v[40:43], v[20:23], a[56:59], v[40:43]
s_waitcnt lgkmcnt(1)
v_mfma_f32_16x16x32_bf16 v[48:51], v[24:27], a[56:59], v[48:51]
ds_read_b128 v[20:23], v82 offset:1024
v_mfma_f32_16x16x32_bf16 v[52:55], v[24:27], a[60:63], v[52:55]
v_mfma_f32_16x16x32_bf16 v[60:63], v[28:31], a[60:63], v[60:63]
ds_read_b128 v[24:27], v82 offset:2048
v_mfma_f32_16x16x32_bf16 v[56:59], v[28:31], a[56:59], v[56:59]
s_waitcnt vmcnt(8)
v_swap_b32 v66, v68
v_swap_b32 v67, v69
s_waitcnt lgkmcnt(1)
s_nop 0
v_mfma_f32_16x16x32_bf16 v[32:35], v[16:19], v[64:67], v[32:35]
ds_read_b128 v[28:31], v82 offset:3072
v_mfma_f32_16x16x32_bf16 v[36:39], v[16:19], v[68:71], v[36:39]
v_mfma_f32_16x16x32_bf16 v[44:47], v[20:23], v[68:71], v[44:47]
ds_read_b128 v[16:19], v82 offset:4096
v_mfma_f32_16x16x32_bf16 v[40:43], v[20:23], v[64:67], v[40:43]
s_waitcnt lgkmcnt(1)
v_mfma_f32_16x16x32_bf16 v[48:51], v[24:27], v[64:67], v[48:51]
ds_read_b128 v[20:23], v82 offset:5120
v_mfma_f32_16x16x32_bf16 v[52:55], v[24:27], v[68:71], v[52:55]
v_mfma_f32_16x16x32_bf16 v[60:63], v[28:31], v[68:71], v[60:63]
ds_read_b128 v[24:27], v82 offset:6144
v_mfma_f32_16x16x32_bf16 v[56:59], v[28:31], v[64:67], v[56:59]
s_barrier
s_waitcnt vmcnt(6)
v_swap_b32 v74, v76
v_swap_b32 v75, v77
s_waitcnt lgkmcnt(1)
s_nop 0
v_mfma_f32_16x16x32_bf16 v[32:35], v[16:19], v[72:75], v[32:35]
ds_read_b128 v[28:31], v82 offset:7168
v_mfma_f32_16x16x32_bf16 v[36:39], v[16:19], v[76:79], v[36:39]
v_mfma_f32_16x16x32_bf16 v[44:47], v[20:23], v[76:79], v[44:47]
ds_read_b128 v[16:19], v80 offset:2048
v_mfma_f32_16x16x32_bf16 v[40:43], v[20:23], v[72:75], v[40:43]
s_waitcnt lgkmcnt(1)
v_mfma_f32_16x16x32_bf16 v[48:51], v[24:27], v[72:75], v[48:51]
ds_read_b128 v[20:23], v80 offset:3072
v_mfma_f32_16x16x32_bf16 v[52:55], v[24:27], v[76:79], v[52:55]
v_mfma_f32_16x16x32_bf16 v[60:63], v[28:31], v[76:79], v[60:63]
ds_read_b128 v[24:27], v80 offset:6144
v_mfma_f32_16x16x32_bf16 v[56:59], v[28:31], v[72:75], v[56:59]
s_waitcnt vmcnt(4)
v_swap_b32 v86, v88
v_swap_b32 v87, v89
s_waitcnt lgkmcnt(1)
s_nop 0
v_mfma_f32_16x16x32_bf16 v[48:51], v[16:19], v[84:87], v[48:51]
ds_read_b128 v[28:31], v80 offset:7168
v_mfma_f32_16x16x32_bf16 v[52:55], v[16:19], v[88:91], v[52:55]
v_mfma_f32_16x16x32_bf16 v[60:63], v[20:23], v[88:91], v[60:63]
ds_read_b128 v[16:19], v80 offset:0
v_mfma_f32_16x16x32_bf16 v[56:59], v[20:23], v[84:87], v[56:59]
v_add_u32 v120, s73, v1
s_xor_b32 s51, s73, 0x2000
v_add_u32 v121, s51, v1
s_waitcnt vmcnt(2)
v_swap_b32 v94, v96
v_swap_b32 v95, v97
s_waitcnt lgkmcnt(1)
s_nop 0
v_mfma_f32_16x16x32_bf16 v[48:51], v[24:27], v[92:95], v[48:51]
ds_read_b128 v[20:23], v80 offset:1024
v_mfma_f32_16x16x32_bf16 v[52:55], v[24:27], v[96:99], v[52:55]
v_mfma_f32_16x16x32_bf16 v[60:63], v[28:31], v[96:99], v[60:63]
ds_read_b128 v[24:27], v80 offset:4096
v_mfma_f32_16x16x32_bf16 v[56:59], v[28:31], v[92:95], v[56:59]
s_waitcnt lgkmcnt(1)
v_mfma_f32_16x16x32_bf16 v[32:35], v[16:19], v[84:87], v[32:35]
ds_read_b128 v[28:31], v80 offset:5120
v_mfma_f32_16x16x32_bf16 v[36:39], v[16:19], v[88:91], v[36:39]
ds_write_b128 v120, v[48:51] offset:0
ds_write_b128 v120, v[52:55] offset:1024
v_mfma_f32_16x16x32_bf16 v[44:47], v[20:23], v[88:91], v[44:47]
v_mfma_f32_16x16x32_bf16 v[40:43], v[20:23], v[84:87], v[40:43]
ds_write_b128 v120, v[56:59] offset:2048
ds_write_b128 v120, v[60:63] offset:3072
s_waitcnt lgkmcnt(4)
v_mfma_f32_16x16x32_bf16 v[32:35], v[24:27], v[92:95], v[32:35]
v_mfma_f32_16x16x32_bf16 v[36:39], v[24:27], v[96:99], v[36:39]
s_waitcnt lgkmcnt(0)
s_barrier
ds_read_b128 v[48:51], v121 offset:0
ds_read_b128 v[52:55], v121 offset:1024
ds_read_b128 v[56:59], v121 offset:2048
ds_read_b128 v[60:63], v121 offset:3072
v_mfma_f32_16x16x32_bf16 v[44:47], v[28:31], v[96:99], v[44:47]
v_mfma_f32_16x16x32_bf16 v[40:43], v[28:31], v[92:95], v[40:43]
s_waitcnt lgkmcnt(1)
v_pk_add_f32 v[32:33], v[32:33], v[48:49]
v_pk_add_f32 v[34:35], v[34:35], v[50:51]
s_nop 4
v_pk_add_f32 v[40:41], v[40:41], v[56:57]
v_pk_add_f32 v[42:43], v[42:43], v[58:59]
v_cvt_pk_bf16_f32 v8, v32, v33
v_cvt_pk_bf16_f32 v9, v34, v35
v_cvt_pk_bf16_f32 v10, v40, v41
v_cvt_pk_bf16_f32 v11, v42, v43
s_waitcnt lgkmcnt(0)
v_pk_add_f32 v[36:37], v[36:37], v[52:53]
v_pk_add_f32 v[38:39], v[38:39], v[54:55]
v_pk_add_f32 v[44:45], v[44:45], v[60:61]
v_pk_add_f32 v[46:47], v[46:47], v[62:63]
v_cvt_pk_bf16_f32 v12, v36, v37
v_cvt_pk_bf16_f32 v13, v38, v39
v_cvt_pk_bf16_f32 v14, v44, v45
v_cvt_pk_bf16_f32 v15, v46, v47
s_cmp_lg_u32 s39, 0
s_cbranch_scc1 L_c_stg_74
s_add_u32 s49, s69, 0x940000
buffer_store_dwordx4 v[8:11], v1, s[4:7], s49 offen offset:0
buffer_store_dwordx4 v[12:15], v1, s[4:7], s49 offen offset:1024
L_c_stb_75:
v_pk_add_f32 v[48:49], v[32:33], v[34:35]
v_pk_mul_f32 v[50:51], v[32:33], v[32:33]
v_pk_add_f32 v[48:49], v[48:49], v[40:41]
v_pk_fma_f32 v[50:51], v[34:35], v[34:35], v[50:51]
v_pk_add_f32 v[48:49], v[48:49], v[42:43]
v_pk_fma_f32 v[50:51], v[40:41], v[40:41], v[50:51]
v_pk_fma_f32 v[50:51], v[42:43], v[42:43], v[50:51]
v_pk_add_f32 v[52:53], v[36:37], v[38:39]
v_pk_mul_f32 v[54:55], v[36:37], v[36:37]
v_pk_add_f32 v[52:53], v[52:53], v[44:45]
v_pk_fma_f32 v[54:55], v[38:39], v[38:39], v[54:55]
v_pk_add_f32 v[52:53], v[52:53], v[46:47]
v_pk_fma_f32 v[54:55], v[44:45], v[44:45], v[54:55]
v_pk_fma_f32 v[54:55], v[46:47], v[46:47], v[54:55]
v_add_f32 v48, v48, v49
v_add_f32 v50, v50, v51
v_add_f32 v52, v52, v53
v_add_f32 v54, v54, v55
s_nop 0
v_permlane32_swap_b32 v48, v52
v_permlane32_swap_b32 v50, v54
v_add_f32 v48, v48, v52
v_add_f32 v50, v50, v54
s_nop 1
v_permlane16_swap_b32 v48, v50
v_add_f32 v48, v48, v50
v_min_u32 v48, -2, v48
s_cmp_lg_u32 s39, 0
s_cbranch_scc1 L_c_stg_76
s_add_u32 s49, s61, 0x13c0000
buffer_store_dword v48, v1, s[4:7], s49 offen offset:0
L_c_stb_77:
L_ph1_1:
ds_read_b128 v[16:19], v1 offset:16384
ds_read_b128 v[20:23], v1 offset:17408
ds_read_b128 v[24:27], v1 offset:18432
s_waitcnt vmcnt(1)
v_mov_b32 v6, 2
s_mov_b64 exec, 1
s_cmp_lg_u32 s39, 0
s_cbranch_scc1 L_c_stg_78
buffer_store_dword v6, off, s[4:7], s82  offset:0
L_c_stb_79:
s_mov_b64 exec, -1
buffer_load_dword v116, v4, s[4:7], s56 offen nt
s_waitcnt vmcnt(0)
v_cmp_gt_u32 vcc, 2, v116
s_cbranch_vccnz L_c_psl_81
L_c_pok_80:
s_add_u32 s100, s54, 0x941000
s_add_u32 s100, s100, s4
s_addc_u32 s101, s5, 0
global_load_dwordx4 a[0:3], v1, s[100:101] offset:-4096 sc1
global_load_dwordx4 a[4:7], v1, s[100:101] offset:-3072 sc1
global_load_dwordx4 a[8:11], v1, s[100:101] offset:-2048 sc1
global_load_dwordx4 a[12:15], v1, s[100:101] offset:-1024 sc1
global_load_dwordx4 a[16:19], v1, s[100:101] offset:0 sc1
global_load_dwordx4 a[20:23], v1, s[100:101] offset:1024 sc1
global_load_dwordx4 a[24:27], v1, s[100:101] offset:2048 sc1
global_load_dwordx4 a[28:31], v1, s[100:101] offset:3072 sc1
s_add_u32 s100, s100, 0x2000
s_addc_u32 s101, s101, 0
global_load_dwordx4 a[32:35], v1, s[100:101] offset:-4096 sc1
global_load_dwordx4 a[36:39], v1, s[100:101] offset:-3072 sc1
global_load_dwordx4 a[40:43], v1, s[100:101] offset:-2048 sc1
global_load_dwordx4 a[44:47], v1, s[100:101] offset:-1024 sc1
s_waitcnt vmcnt(10)
s_waitcnt lgkmcnt(1)
v_mfma_f32_16x16x32_bf16 v[32:35], a[0:3], v[16:19], 0
ds_read_b128 v[28:31], v1 offset:19456
v_mfma_f32_16x16x32_bf16 v[36:39], a[4:7], v[16:19], 0
global_load_dwordx4 a[48:51], v1, s[100:101] offset:0 sc1
v_mfma_f32_16x16x32_bf16 v[44:47], a[4:7], v[20:23], 0
ds_read_b128 v[16:19], v1 offset:20480
v_mfma_f32_16x16x32_bf16 v[40:43], a[0:3], v[20:23], 0
global_load_dwordx4 a[52:55], v1, s[100:101] offset:1024 sc1
s_waitcnt lgkmcnt(1)
v_mfma_f32_16x16x32_bf16 v[48:51], a[0:3], v[24:27], 0
ds_read_b128 v[20:23], v1 offset:21504
v_mfma_f32_16x16x32_bf16 v[52:55], a[4:7], v[24:27], 0
v_mfma_f32_16x16x32_bf16 v[60:63], a[4:7], v[28:31], 0
ds_read_b128 v[24:27], v1 offset:22528
v_mfma_f32_16x16x32_bf16 v[56:59], a[0:3], v[28:31], 0
s_waitcnt vmcnt(10)
s_waitcnt lgkmcnt(1)
v_mfma_f32_16x16x32_bf16 v[32:35], a[8:11], v[16:19], v[32:35]
ds_read_b128 v[28:31], v1 offset:23552
v_mfma_f32_16x16x32_bf16 v[36:39], a[12:15], v[16:19], v[36:39]
global_load_dwordx4 a[56:59], v1, s[100:101] offset:2048 sc1
v_mfma_f32_16x16x32_bf16 v[44:47], a[12:15], v[20:23], v[44:47]
ds_read_b128 v[16:19], v1 offset:24576
v_mfma_f32_16x16x32_bf16 v[40:43], a[8:11], v[20:23], v[40:43]
global_load_dwordx4 a[60:63], v1, s[100:101] offset:3072 sc1
s_waitcnt lgkmcnt(1)
v_mfma_f32_16x16x32_bf16 v[48:51], a[8:11], v[24:27], v[48:51]
ds_read_b128 v[20:23], v1 offset:25600
v_mfma_f32_16x16x32_bf16 v[52:55], a[12:15], v[24:27], v[52:55]
s_add_u32 s100, s60, 0x13c1000
s_add_u32 s100, s100, s4
s_addc_u32 s101, s5, 0
global_load_dwordx4 v[80:83], v1, s[100:101] offset:-4096 sc1
v_mfma_f32_16x16x32_bf16 v[60:63], a[12:15], v[28:31], v[60:63]
ds_read_b128 v[24:27], v1 offset:26624
v_mfma_f32_16x16x32_bf16 v[56:59], a[8:11], v[28:31], v[56:59]
s_waitcnt vmcnt(11)
s_waitcnt lgkmcnt(1)
v_mfma_f32_16x16x32_bf16 v[32:35], a[16:19], v[16:19], v[32:35]
ds_read_b128 v[28:31], v1 offset:27648
v_mfma_f32_16x16x32_bf16 v[36:39], a[20:23], v[16:19], v[36:39]
global_load_dwordx4 v[84:87], v1, s[100:101] offset:-3072 sc1
v_mfma_f32_16x16x32_bf16 v[44:47], a[20:23], v[20:23], v[44:47]
ds_read_b128 v[16:19], v1 offset:28672
v_mfma_f32_16x16x32_bf16 v[40:43], a[16:19], v[20:23], v[40:43]
global_load_dwordx4 v[88:91], v1, s[100:101] offset:-2048 sc1
s_waitcnt lgkmcnt(1)
v_mfma_f32_16x16x32_bf16 v[48:51], a[16:19], v[24:27], v[48:51]
ds_read_b128 v[20:23], v1 offset:29696
v_mfma_f32_16x16x32_bf16 v[52:55], a[20:23], v[24:27], v[52:55]
global_load_dwordx4 v[92:95], v1, s[100:101] offset:-1024 sc1
v_mfma_f32_16x16x32_bf16 v[60:63], a[20:23], v[28:31], v[60:63]
ds_read_b128 v[24:27], v1 offset:30720
v_mfma_f32_16x16x32_bf16 v[56:59], a[16:19], v[28:31], v[56:59]
s_barrier
s_waitcnt vmcnt(12)
s_waitcnt lgkmcnt(1)
v_mfma_f32_16x16x32_bf16 v[32:35], a[24:27], v[16:19], v[32:35]
ds_read_b128 v[28:31], v1 offset:31744
v_mfma_f32_16x16x32_bf16 v[36:39], a[28:31], v[16:19], v[36:39]
s_add_u32 s100, s54, 0x945000
s_add_u32 s100, s100, s4
s_addc_u32 s101, s5, 0
global_load_dwordx4 a[64:67], v1, s[100:101] offset:-4096 sc1
v_mfma_f32_16x16x32_bf16 v[44:47], a[28:31], v[20:23], v[44:47]
ds_read_b128 v[16:19], v1 offset:32768
v_mfma_f32_16x16x32_bf16 v[40:43], a[24:27], v[20:23], v[40:43]
global_load_dwordx4 a[68:71], v1, s[100:101] offset:-3072 sc1
s_waitcnt lgkmcnt(1)
v_mfma_f32_16x16x32_bf16 v[48:51], a[24:27], v[24:27], v[48:51]
ds_read_b128 v[20:23], v1 offset:33792
v_mfma_f32_16x16x32_bf16 v[52:55], a[28:31], v[24:27], v[52:55]
v_mfma_f32_16x16x32_bf16 v[60:63], a[28:31], v[28:31], v[60:63]
ds_read_b128 v[24:27], v1 offset:34816
v_mfma_f32_16x16x32_bf16 v[56:59], a[24:27], v[28:31], v[56:59]
s_waitcnt vmcnt(12)
s_waitcnt lgkmcnt(1)
v_mfma_f32_16x16x32_bf16 v[32:35], a[32:35], v[16:19], v[32:35]
ds_read_b128 v[28:31], v1 offset:35840
v_mfma_f32_16x16x32_bf16 v[36:39], a[36:39], v[16:19], v[36:39]
global_load_dwordx4 a[72:75], v1, s[100:101] offset:-2048 sc1
v_mfma_f32_16x16x32_bf16 v[44:47], a[36:39], v[20:23], v[44:47]
ds_read_b128 v[16:19], v1 offset:36864
v_mfma_f32_16x16x32_bf16 v[40:43], a[32:35], v[20:23], v[40:43]
global_load_dwordx4 a[76:79], v1, s[100:101] offset:-1024 sc1
s_waitcnt lgkmcnt(1)
v_mfma_f32_16x16x32_bf16 v[48:51], a[32:35], v[24:27], v[48:51]
ds_read_b128 v[20:23], v1 offset:37888
v_mfma_f32_16x16x32_bf16 v[52:55], a[36:39], v[24:27], v[52:55]
v_mfma_f32_16x16x32_bf16 v[60:63], a[36:39], v[28:31], v[60:63]
ds_read_b128 v[24:27], v1 offset:38912
v_mfma_f32_16x16x32_bf16 v[56:59], a[32:35], v[28:31], v[56:59]
s_waitcnt vmcnt(12)
s_waitcnt lgkmcnt(1)
v_mfma_f32_16x16x32_bf16 v[32:35], a[40:43], v[16:19], v[32:35]
ds_read_b128 v[28:31], v1 offset:39936
v_mfma_f32_16x16x32_bf16 v[36:39], a[44:47], v[16:19], v[36:39]
global_load_dwordx4 a[80:83], v1, s[100:101] offset:0 sc1
v_mfma_f32_16x16x32_bf16 v[44:47], a[44:47], v[20:23], v[44:47]
ds_read_b128 v[16:19], v1 offset:40960
v_mfma_f32_16x16x32_bf16 v[40:43], a[40:43], v[20:23], v[40:43]
global_load_dwordx4 a[84:87], v1, s[100:101] offset:1024 sc1
s_waitcnt lgkmcnt(1)
v_mfma_f32_16x16x32_bf16 v[48:51], a[40:43], v[24:27], v[48:51]
ds_read_b128 v[20:23], v1 offset:41984
v_mfma_f32_16x16x32_bf16 v[52:55], a[44:47], v[24:27], v[52:55]
v_mfma_f32_16x16x32_bf16 v[60:63], a[44:47], v[28:31], v[60:63]
ds_read_b128 v[24:27], v1 offset:43008
v_mfma_f32_16x16x32_bf16 v[56:59], a[40:43], v[28:31], v[56:59]
s_waitcnt vmcnt(12)
s_waitcnt lgkmcnt(1)
v_mfma_f32_16x16x32_bf16 v[32:35], a[48:51], v[16:19], v[32:35]
ds_read_b128 v[28:31], v1 offset:44032
v_mfma_f32_16x16x32_bf16 v[36:39], a[52:55], v[16:19], v[36:39]
global_load_dwordx4 a[88:91], v1, s[100:101] offset:2048 sc1
v_mfma_f32_16x16x32_bf16 v[44:47], a[52:55], v[20:23], v[44:47]
ds_read_b128 v[16:19], v1 offset:45056
v_mfma_f32_16x16x32_bf16 v[40:43], a[48:51], v[20:23], v[40:43]
global_load_dwordx4 a[92:95], v1, s[100:101] offset:3072 sc1
s_waitcnt lgkmcnt(1)
v_mfma_f32_16x16x32_bf16 v[48:51], a[48:51], v[24:27], v[48:51]
ds_read_b128 v[20:23], v1 offset:46080
v_mfma_f32_16x16x32_bf16 v[52:55], a[52:55], v[24:27], v[52:55]
v_mfma_f32_16x16x32_bf16 v[60:63], a[52:55], v[28:31], v[60:63]
ds_read_b128 v[24:27], v1 offset:47104
v_mfma_f32_16x16x32_bf16 v[56:59], a[48:51], v[28:31], v[56:59]
s_barrier
s_waitcnt vmcnt(12)
s_waitcnt lgkmcnt(1)
v_mfma_f32_16x16x32_bf16 v[32:35], a[56:59], v[16:19], v[32:35]
ds_read_b128 v[28:31], v1 offset:48128
v_mfma_f32_16x16x32_bf16 v[36:39], a[60:63], v[16:19], v[36:39]
s_add_u32 s100, s100, 0x2000
s_addc_u32 s101, s101, 0
global_load_dwordx4 a[96:99], v1, s[100:101] offset:-4096 sc1
v_mfma_f32_16x16x32_bf16 v[44:47], a[60:63], v[20:23], v[44:47]
ds_read_b128 v[16:19], v1 offset:49152
v_mfma_f32_16x16x32_bf16 v[40:43], a[56:59], v[20:23], v[40:43]
global_load_dwordx4 a[100:103], v1, s[100:101] offset:-3072 sc1
s_waitcnt lgkmcnt(1)
v_mfma_f32_16x16x32_bf16 v[48:51], a[56:59], v[24:27], v[48:51]
ds_read_b128 v[20:23], v1 offset:50176
v_mfma_f32_16x16x32_bf16 v[52:55], a[60:63], v[24:27], v[52:55]
v_mfma_f32_16x16x32_bf16 v[60:63], a[60:63], v[28:31], v[60:63]
ds_read_b128 v[24:27], v1 offset:51200
v_mfma_f32_16x16x32_bf16 v[56:59], a[56:59], v[28:31], v[56:59]
s_waitcnt vmcnt(8)
s_waitcnt lgkmcnt(1)
v_mfma_f32_16x16x32_bf16 v[32:35], a[64:67], v[16:19], v[32:35]
ds_read_b128 v[28:31], v1 offset:52224
v_mfma_f32_16x16x32_bf16 v[36:39], a[68:71], v[16:19], v[36:39]
global_load_dwordx4 a[104:107], v1, s[100:101] offset:-2048 sc1
v_mfma_f32_16x16x32_bf16 v[44:47], a[68:71], v[20:23], v[44:47]
ds_read_b128 v[16:19], v1 offset:53248
v_mfma_f32_16x16x32_bf16 v[40:43], a[64:67], v[20:23], v[40:43]
global_load_dwordx4 a[108:111], v1, s[100:101] offset:-1024 sc1
s_waitcnt lgkmcnt(1)
v_mfma_f32_16x16x32_bf16 v[48:51], a[64:67], v[24:27], v[48:51]
ds_read_b128 v[20:23], v1 offset:54272
v_max3_u32 v112, v80, v81, v82
v_mfma_f32_16x16x32_bf16 v[52:55], a[68:71], v[24:27], v[52:55]
v_max3_u32 v112, v112, v83, v84
v_mfma_f32_16x16x32_bf16 v[60:63], a[68:71], v[28:31], v[60:63]
ds_read_b128 v[24:27], v1 offset:55296
v_max3_u32 v112, v112, v85, v86
v_mfma_f32_16x16x32_bf16 v[56:59], a[64:67], v[28:31], v[56:59]
v_max3_u32 v112, v112, v87, v88
s_waitcnt vmcnt(8)
s_waitcnt lgkmcnt(1)
v_mfma_f32_16x16x32_bf16 v[32:35], a[72:75], v[16:19], v[32:35]
ds_read_b128 v[28:31], v1 offset:56320
v_max3_u32 v112, v112, v89, v90
v_mfma_f32_16x16x32_bf16 v[36:39], a[76:79], v[16:19], v[36:39]
global_load_dwordx4 a[112:115], v1, s[100:101] offset:0 sc1
v_max3_u32 v112, v112, v91, v92
v_mfma_f32_16x16x32_bf16 v[44:47], a[76:79], v[20:23], v[44:47]
ds_read_b128 v[16:19], v1 offset:57344
v_max3_u32 v112, v112, v93, v94
v_mfma_f32_16x16x32_bf16 v[40:43], a[72:75], v[20:23], v[40:43]
global_load_dwordx4 a[116:119], v1, s[100:101] offset:1024 sc1
v_max_u32 v112, v112, v95
s_waitcnt lgkmcnt(1)
v_mfma_f32_16x16x32_bf16 v[48:51], a[72:75], v[24:27], v[48:51]
ds_read_b128 v[20:23], v1 offset:58368
v_cmp_eq_u32 vcc, -1, v112
s_cbranch_vccnz L_c_tsl_84
L_c_tok_85:
v_pk_add_f32 v[80:81], v[80:81], v[84:85]
v_mfma_f32_16x16x32_bf16 v[52:55], a[76:79], v[24:27], v[52:55]
v_pk_add_f32 v[88:89], v[88:89], v[92:93]
v_pk_add_f32 v[82:83], v[82:83], v[86:87]
v_pk_add_f32 v[90:91], v[90:91], v[94:95]
v_mfma_f32_16x16x32_bf16 v[60:63], a[76:79], v[28:31], v[60:63]
ds_read_b128 v[24:27], v1 offset:59392
v_pk_add_f32 v[80:81], v[80:81], v[82:83]
v_mfma_f32_16x16x32_bf16 v[56:59], a[72:75], v[28:31], v[56:59]
v_pk_add_f32 v[88:89], v[88:89], v[90:91]
s_waitcnt vmcnt(8)
s_waitcnt lgkmcnt(1)
v_mfma_f32_16x16x32_bf16 v[32:35], a[80:83], v[16:19], v[32:35]
ds_read_b128 v[28:31], v1 offset:60416
v_pk_add_f32 v[80:81], v[80:81], v[88:89]
v_mfma_f32_16x16x32_bf16 v[36:39], a[84:87], v[16:19], v[36:39]
global_load_dwordx4 a[120:123], v1, s[100:101] offset:2048 sc1
v_add_f32 v80, v80, v81
v_mfma_f32_16x16x32_bf16 v[44:47], a[84:87], v[20:23], v[44:47]
ds_read_b128 v[16:19], v1 offset:61440
v_mul_f32 v80, 0x3b000000, v80
v_mfma_f32_16x16x32_bf16 v[40:43], a[80:83], v[20:23], v[40:43]
global_load_dwordx4 a[124:127], v1, s[100:101] offset:3072 sc1
s_waitcnt lgkmcnt(1)
v_mfma_f32_16x16x32_bf16 v[48:51], a[80:83], v[24:27], v[48:51]
ds_read_b128 v[20:23], v1 offset:62464
v_mov_b32 v81, v80
v_mfma_f32_16x16x32_bf16 v[52:55], a[84:87], v[24:27], v[52:55]
s_nop 1
v_permlane16_swap_b32 v80, v81
v_mfma_f32_16x16x32_bf16 v[60:63], a[84:87], v[28:31], v[60:63]
ds_read_b128 v[24:27], v1 offset:63488
v_fma_f32 v81, -v80, v80, v81
v_mfma_f32_16x16x32_bf16 v[56:59], a[80:83], v[28:31], v[56:59]
v_max_f32 v81, 0, v81
s_barrier
s_lshl_b32 s51, s38, 2
s_add_u32 s51, s51, 0x26200
v_mov_b32 v122, s51
v_mov_b32 v123, 0
ds_write_b32 v122, v123
s_waitcnt vmcnt(8)
s_waitcnt lgkmcnt(2)
v_mfma_f32_16x16x32_bf16 v[32:35], a[88:91], v[16:19], v[32:35]
ds_read_b128 v[28:31], v1 offset:64512
v_add_f32 v81, 0x3727c5ac, v81
v_mfma_f32_16x16x32_bf16 v[36:39], a[92:95], v[16:19], v[36:39]
v_rsq_f32 v112, v81
v_mfma_f32_16x16x32_bf16 v[44:47], a[92:95], v[20:23], v[44:47]
ds_read_b128 v[16:19], v2 offset:0
v_lshrrev_b32 v82, 5, v0
v_mfma_f32_16x16x32_bf16 v[40:43], a[88:91], v[20:23], v[40:43]
v_lshlrev_b32 v82, 6, v82
s_waitcnt lgkmcnt(1)
v_mfma_f32_16x16x32_bf16 v[48:51], a[88:91], v[24:27], v[48:51]
ds_read_b128 v[20:23], v2 offset:1024
v_add3_u32 v82, v82, v4, s73
v_mfma_f32_16x16x32_bf16 v[52:55], a[92:95], v[24:27], v[52:55]
v_lshrrev_b32 v83, 4, v0
v_mfma_f32_16x16x32_bf16 v[60:63], a[92:95], v[28:31], v[60:63]
ds_read_b128 v[24:27], v2 offset:2048
v_lshlrev_b32 v83, 4, v83
v_mfma_f32_16x16x32_bf16 v[56:59], a[88:91], v[28:31], v[56:59]
v_add_u32 v83, s73, v83
s_waitcnt vmcnt(6)
s_waitcnt lgkmcnt(1)
v_mfma_f32_16x16x32_bf16 v[32:35], a[96:99], v[16:19], v[32:35]
ds_read_b128 v[28:31], v2 offset:3072
ds_write_b32 v82, v112
ds_read_b128 v[96:99], v83
ds_read_b128 v[100:103], v83 offset:64
v_mov_b32 v113, v112
v_mfma_f32_16x16x32_bf16 v[36:39], a[100:103], v[16:19], v[36:39]
s_nop 1
v_permlane32_swap_b32 v112, v113
v_mfma_f32_16x16x32_bf16 v[44:47], a[100:103], v[20:23], v[44:47]
ds_read_b128 v[16:19], v2 offset:4096
v_mfma_f32_16x16x32_bf16 v[40:43], a[96:99], v[20:23], v[40:43]
s_waitcnt lgkmcnt(4)
v_mfma_f32_16x16x32_bf16 v[48:51], a[96:99], v[24:27], v[48:51]
ds_read_b128 v[20:23], v2 offset:5120
v_mul_f32 v114, 0x3fb8aa3b, v112
v_mfma_f32_16x16x32_bf16 v[52:55], a[100:103], v[24:27], v[52:55]
v_mul_f32 v115, 0x3fb8aa3b, v113
s_waitcnt lgkmcnt(2)
v_mul_f32 v104, 0x3fb8aa3b, v96
v_mfma_f32_16x16x32_bf16 v[60:63], a[100:103], v[28:31], v[60:63]
ds_read_b128 v[24:27], v2 offset:6144
v_mul_f32 v105, 0x3fb8aa3b, v97
v_mfma_f32_16x16x32_bf16 v[56:59], a[96:99], v[28:31], v[56:59]
v_mul_f32 v106, 0x3fb8aa3b, v98
s_waitcnt vmcnt(4)
s_waitcnt lgkmcnt(1)
v_mfma_f32_16x16x32_bf16 v[32:35], a[104:107], v[16:19], v[32:35]
ds_read_b128 v[28:31], v2 offset:7168
v_mul_f32 v107, 0x3fb8aa3b, v99
v_mfma_f32_16x16x32_bf16 v[36:39], a[108:111], v[16:19], v[36:39]
v_mul_f32 v108, 0x3fb8aa3b, v100
v_mul_f32 v109, 0x3fb8aa3b, v101
v_mfma_f32_16x16x32_bf16 v[44:47], a[108:111], v[20:23], v[44:47]
ds_read_b128 v[16:19], v2 offset:8192
v_mfma_f32_16x16x32_bf16 v[40:43], a[104:107], v[20:23], v[40:43]
s_waitcnt lgkmcnt(1)
v_mfma_f32_16x16x32_bf16 v[48:51], a[104:107], v[24:27], v[48:51]
ds_read_b128 v[20:23], v2 offset:9216
v_mul_f32 v110, 0x3fb8aa3b, v102
v_mfma_f32_16x16x32_bf16 v[52:55], a[108:111], v[24:27], v[52:55]
v_mul_f32 v111, 0x3fb8aa3b, v103
v_mfma_f32_16x16x32_bf16 v[60:63], a[108:111], v[28:31], v[60:63]
ds_read_b128 v[24:27], v2 offset:10240
v_mfma_f32_16x16x32_bf16 v[56:59], a[104:107], v[28:31], v[56:59]
s_waitcnt vmcnt(2)
s_waitcnt lgkmcnt(1)
v_mfma_f32_16x16x32_bf16 v[32:35], a[112:115], v[16:19], v[32:35]
ds_read_b128 v[28:31], v2 offset:11264
v_mfma_f32_16x16x32_bf16 v[36:39], a[116:119], v[16:19], v[36:39]
v_mfma_f32_16x16x32_bf16 v[44:47], a[116:119], v[20:23], v[44:47]
ds_read_b128 v[16:19], v2 offset:12288
v_mfma_f32_16x16x32_bf16 v[40:43], a[112:115], v[20:23], v[40:43]
s_waitcnt lgkmcnt(1)
v_mfma_f32_16x16x32_bf16 v[48:51], a[112:115], v[24:27], v[48:51]
ds_read_b128 v[20:23], v2 offset:13312
v_mfma_f32_16x16x32_bf16 v[52:55], a[116:119], v[24:27], v[52:55]
v_mfma_f32_16x16x32_bf16 v[60:63], a[116:119], v[28:31], v[60:63]
ds_read_b128 v[24:27], v2 offset:14336
v_mfma_f32_16x16x32_bf16 v[56:59], a[112:115], v[28:31], v[56:59]
s_barrier
s_waitcnt vmcnt(0)
s_waitcnt lgkmcnt(1)
v_mfma_f32_16x16x32_bf16 v[32:35], a[120:123], v[16:19], v[32:35]
ds_read_b128 v[28:31], v2 offset:15360
v_mfma_f32_16x16x32_bf16 v[36:39], a[124:127], v[16:19], v[36:39]
v_mfma_f32_16x16x32_bf16 v[44:47], a[124:127], v[20:23], v[44:47]
v_mfma_f32_16x16x32_bf16 v[40:43], a[120:123], v[20:23], v[40:43]
s_waitcnt lgkmcnt(0)
v_mfma_f32_16x16x32_bf16 v[48:51], a[120:123], v[24:27], v[48:51]
v_mfma_f32_16x16x32_bf16 v[52:55], a[124:127], v[24:27], v[52:55]
v_mfma_f32_16x16x32_bf16 v[60:63], a[124:127], v[28:31], v[60:63]
v_mfma_f32_16x16x32_bf16 v[56:59], a[120:123], v[28:31], v[56:59]
v_pk_mul_f32 v[64:65], v[32:33], v[104:105]
v_pk_mul_f32 v[66:67], v[34:35], v[106:107]
v_exp_f32_e64 v64, v64 clamp
v_exp_f32_e64 v65, v65 clamp
v_exp_f32_e64 v66, v66 clamp
v_exp_f32_e64 v67, v67 clamp
v_pk_fma_f32 v[32:33], v[32:33], v[96:97], s[74:75] op_sel_hi:[1,1,0]
v_pk_fma_f32 v[34:35], v[34:35], v[98:99], s[74:75] op_sel_hi:[1,1,0]
v_max_f32 v32, s74, v32
v_max_f32 v33, s74, v33
v_max_f32 v34, s74, v34
v_max_f32 v35, s74, v35
v_pk_add_f32 v[32:33], v[32:33], v[64:65]
v_pk_add_f32 v[34:35], v[34:35], v[66:67]
v_cvt_pk_bf16_f32 v116, v32, v33
v_cvt_pk_bf16_f32 v117, v34, v35
v_pk_mul_f32 v[68:69], v[36:37], v[108:109]
v_pk_mul_f32 v[70:71], v[38:39], v[110:111]
v_exp_f32_e64 v68, v68 clamp
v_exp_f32_e64 v69, v69 clamp
v_exp_f32_e64 v70, v70 clamp
v_exp_f32_e64 v71, v71 clamp
v_pk_fma_f32 v[36:37], v[36:37], v[100:101], s[74:75] op_sel_hi:[1,1,0]
v_pk_fma_f32 v[38:39], v[38:39], v[102:103], s[74:75] op_sel_hi:[1,1,0]
v_max_f32 v36, s74, v36
v_max_f32 v37, s74, v37
v_max_f32 v38, s74, v38
v_max_f32 v39, s74, v39
v_pk_add_f32 v[36:37], v[36:37], v[68:69]
v_pk_add_f32 v[38:39], v[38:39], v[70:71]
v_cvt_pk_bf16_f32 v118, v36, v37
v_cvt_pk_bf16_f32 v119, v38, v39
v_pk_mul_f32 v[48:49], v[48:49], v[96:97]
v_pk_mul_f32 v[50:51], v[50:51], v[98:99]
v_cvt_pk_bf16_f32 v80, v48, v49
v_cvt_pk_bf16_f32 v81, v50, v51
v_pk_mul_f32 v[52:53], v[52:53], v[100:101]
v_pk_mul_f32 v[54:55], v[54:55], v[102:103]
v_cvt_pk_bf16_f32 v82, v52, v53
v_cvt_pk_bf16_f32 v83, v54, v55
s_nop 1
v_mfma_f32_16x16x32_bf16 v[32:35], v[116:119], v[80:83], 0
v_pk_mul_f32 v[72:73], v[40:41], v[104:105]
v_pk_mul_f32 v[74:75], v[42:43], v[106:107]
v_exp_f32_e64 v72, v72 clamp
v_exp_f32_e64 v73, v73 clamp
v_exp_f32_e64 v74, v74 clamp
v_exp_f32_e64 v75, v75 clamp
v_pk_fma_f32 v[40:41], v[40:41], v[96:97], s[74:75] op_sel_hi:[1,1,0]
v_pk_fma_f32 v[42:43], v[42:43], v[98:99], s[74:75] op_sel_hi:[1,1,0]
v_max_f32 v40, s74, v40
v_max_f32 v41, s74, v41
v_max_f32 v42, s74, v42
v_max_f32 v43, s74, v43
v_pk_add_f32 v[40:41], v[40:41], v[72:73]
v_pk_add_f32 v[42:43], v[42:43], v[74:75]
v_cvt_pk_bf16_f32 v120, v40, v41
v_cvt_pk_bf16_f32 v121, v42, v43
v_pk_mul_f32 v[76:77], v[44:45], v[108:109]
v_pk_mul_f32 v[78:79], v[46:47], v[110:111]
v_exp_f32_e64 v76, v76 clamp
v_exp_f32_e64 v77, v77 clamp
v_exp_f32_e64 v78, v78 clamp
v_exp_f32_e64 v79, v79 clamp
v_pk_fma_f32 v[44:45], v[44:45], v[100:101], s[74:75] op_sel_hi:[1,1,0]
v_pk_fma_f32 v[46:47], v[46:47], v[102:103], s[74:75] op_sel_hi:[1,1,0]
v_max_f32 v44, s74, v44
v_max_f32 v45, s74, v45
v_max_f32 v46, s74, v46
v_max_f32 v47, s74, v47
v_pk_add_f32 v[44:45], v[44:45], v[76:77]
v_pk_add_f32 v[46:47], v[46:47], v[78:79]
v_cvt_pk_bf16_f32 v122, v44, v45
v_cvt_pk_bf16_f32 v123, v46, v47
v_mov_b32 v104, 0x3f803f80
v_mov_b32 v105, 0x3f803f80
v_mov_b32 v106, 0x3f803f80
v_mov_b32 v107, 0x3f803f80
v_pk_mul_f32 v[56:57], v[56:57], v[96:97]
v_pk_mul_f32 v[58:59], v[58:59], v[98:99]
v_cvt_pk_bf16_f32 v84, v56, v57
v_cvt_pk_bf16_f32 v85, v58, v59
v_pk_mul_f32 v[60:61], v[60:61], v[100:101]
v_pk_mul_f32 v[62:63], v[62:63], v[102:103]
v_cvt_pk_bf16_f32 v86, v60, v61
v_cvt_pk_bf16_f32 v87, v62, v63
s_nop 1
v_mfma_f32_16x16x32_bf16 v[40:43], v[120:123], v[84:87], 0
v_mfma_f32_16x16x32_bf16 v[36:39], v[116:119], v[104:107], 0
v_mfma_f32_16x16x32_bf16 v[44:47], v[120:123], v[104:107], 0
v_add_u32 v96, s72, v3
v_add_u32 v97, s73, v1
v_and_b32 v98, 0x30, v0
v_add_u32 v99, 0x20000, v98
v_add_u32 v99, s72, v99
v_add_u32 v98, s73, v98
s_cmp_lt_u32 s38, 2
s_cselect_b64 vcc, -1, 0
v_cndmask_b32 v97, v98, v97, vcc
ds_write_b128 v96, v[32:35] offset:16384
ds_write_b128 v96, v[40:43] offset:20480
ds_write_b128 v99, v[36:39] offset:24576
ds_write_b128 v99, v[44:47] offset:28672
s_lshl_b32 s51, s38, 2
v_mov_b32 v59, 1
v_mov_b32 v56, 0x26200
v_add_u32 v58, s51, v56
ds_write_b32 v58, v59
L_c_sa_86:
ds_read_b128 v[48:51], v56
ds_read_b128 v[52:55], v56 offset:16
s_add_u32 s66, s66, 1
s_cmp_lt_u32 s66, 0x800000
s_waitcnt lgkmcnt(0)
v_min3_u32 v48, v48, v49, v50
v_min3_u32 v52, v52, v53, v54
v_min3_u32 v48, v48, v51, v55
v_min_u32 v48, v48, v52
v_cmp_gt_u32 vcc, 1, v48
s_cbranch_scc0 L_c_sa_86_x
s_cbranch_vccnz L_c_sa_86
L_c_sa_86_x:
ds_read_b128 v[32:35], v97 offset:0
ds_read_b128 v[36:39], v97 offset:1024
ds_read_b128 v[40:43], v97 offset:2048
ds_read_b128 v[44:47], v97 offset:3072
ds_read_b128 v[16:19], v2 offset:16384
ds_read_b128 v[20:23], v2 offset:17408
ds_read_b128 v[24:27], v2 offset:18432
s_waitcnt lgkmcnt(5)
v_pk_add_f32 v[32:33], v[32:33], v[36:37]
v_pk_add_f32 v[34:35], v[34:35], v[38:39]
s_waitcnt lgkmcnt(3)
v_pk_add_f32 v[40:41], v[40:41], v[44:45]
v_pk_add_f32 v[42:43], v[42:43], v[46:47]
v_pk_add_f32 v[32:33], v[32:33], v[40:41]
v_pk_add_f32 v[34:35], v[34:35], v[42:43]
v_cvt_pk_bf16_f32 v32, v32, v33
v_cvt_pk_bf16_f32 v33, v34, v35
v_min_u32 v32, -2, v32
v_min_u32 v33, -2, v33
s_add_u32 s49, s63, 0x1300000
buffer_store_dwordx2 v[32:33], v126, s[4:7], s49 offen offset:0 sc1
s_add_u32 s49, s68, 0x740000
s_bfm_b64 exec, 16, 0
buffer_load_dword v6, v125, s[4:7], s49 offen sc1
s_mov_b64 exec, -1
s_add_u32 s49, s69, 0x940000
s_bfm_b64 exec, 16, 0
buffer_load_dword v6, v125, s[4:7], s49 offen sc1
s_mov_b64 exec, -1
s_add_u32 s49, s61, 0x1380000
s_bfm_b64 exec, 8, 0
buffer_load_dword v6, v125, s[4:7], s49 offen sc1
s_mov_b64 exec, -1
s_waitcnt lgkmcnt(1)
v_mfma_f32_16x16x32_bf16 v[64:67], v[16:19], a[0:3], 0
ds_read_b128 v[28:31], v2 offset:19456
v_mfma_f32_16x16x32_bf16 v[68:71], v[16:19], a[4:7], 0
v_mfma_f32_16x16x32_bf16 v[76:79], v[20:23], a[4:7], 0
ds_read_b128 v[16:19], v2 offset:20480
v_mfma_f32_16x16x32_bf16 v[72:75], v[20:23], a[0:3], 0
s_waitcnt lgkmcnt(1)
v_mfma_f32_16x16x32_bf16 v[64:67], v[24:27], a[8:11], v[64:67]
ds_read_b128 v[20:23], v2 offset:21504
v_mfma_f32_16x16x32_bf16 v[68:71], v[24:27], a[12:15], v[68:71]
v_mfma_f32_16x16x32_bf16 v[76:79], v[28:31], a[12:15], v[76:79]
ds_read_b128 v[24:27], v2 offset:22528
v_mfma_f32_16x16x32_bf16 v[72:75], v[28:31], a[8:11], v[72:75]
s_waitcnt lgkmcnt(1)
v_mfma_f32_16x16x32_bf16 v[64:67], v[16:19], a[16:19], v[64:67]
ds_read_b128 v[28:31], v2 offset:23552
v_mfma_f32_16x16x32_bf16 v[68:71], v[16:19], a[20:23], v[68:71]
v_mfma_f32_16x16x32_bf16 v[76:79], v[20:23], a[20:23], v[76:79]
ds_read_b128 v[16:19], v2 offset:24576
v_mfma_f32_16x16x32_bf16 v[72:75], v[20:23], a[16:19], v[72:75]
s_waitcnt lgkmcnt(1)
v_mfma_f32_16x16x32_bf16 v[64:67], v[24:27], a[24:27], v[64:67]
ds_read_b128 v[20:23], v2 offset:25600
v_mfma_f32_16x16x32_bf16 v[68:71], v[24:27], a[28:31], v[68:71]
v_mfma_f32_16x16x32_bf16 v[76:79], v[28:31], a[28:31], v[76:79]
ds_read_b128 v[24:27], v2 offset:26624
v_mfma_f32_16x16x32_bf16 v[72:75], v[28:31], a[24:27], v[72:75]
s_waitcnt lgkmcnt(1)
v_mfma_f32_16x16x32_bf16 v[64:67], v[16:19], a[32:35], v[64:67]
ds_read_b128 v[28:31], v2 offset:27648
v_mfma_f32_16x16x32_bf16 v[68:71], v[16:19], a[36:39], v[68:71]
v_mfma_f32_16x16x32_bf16 v[76:79], v[20:23], a[36:39], v[76:79]
ds_read_b128 v[16:19], v2 offset:28672
v_mfma_f32_16x16x32_bf16 v[72:75], v[20:23], a[32:35], v[72:75]
s_waitcnt lgkmcnt(1)
v_mfma_f32_16x16x32_bf16 v[64:67], v[24:27], a[40:43], v[64:67]
ds_read_b128 v[20:23], v2 offset:29696
v_mfma_f32_16x16x32_bf16 v[68:71], v[24:27], a[44:47], v[68:71]
v_mfma_f32_16x16x32_bf16 v[76:79], v[28:31], a[44:47], v[76:79]
ds_read_b128 v[24:27], v2 offset:30720
v_mfma_f32_16x16x32_bf16 v[72:75], v[28:31], a[40:43], v[72:75]
s_waitcnt lgkmcnt(1)
v_mfma_f32_16x16x32_bf16 v[64:67], v[16:19], a[48:51], v[64:67]
ds_read_b128 v[28:31], v2 offset:31744
v_mfma_f32_16x16x32_bf16 v[68:71], v[16:19], a[52:55], v[68:71]
v_mfma_f32_16x16x32_bf16 v[76:79], v[20:23], a[52:55], v[76:79]
ds_read_b128 v[16:19], v2 offset:32768
v_mfma_f32_16x16x32_bf16 v[72:75], v[20:23], a[48:51], v[72:75]
s_waitcnt lgkmcnt(1)
v_mfma_f32_16x16x32_bf16 v[64:67], v[24:27], a[56:59], v[64:67]
ds_read_b128 v[20:23], v2 offset:33792
v_mfma_f32_16x16x32_bf16 v[68:71], v[24:27], a[60:63], v[68:71]
v_mfma_f32_16x16x32_bf16 v[76:79], v[28:31], a[60:63], v[76:79]
ds_read_b128 v[24:27], v2 offset:34816
v_mfma_f32_16x16x32_bf16 v[72:75], v[28:31], a[56:59], v[72:75]
s_waitcnt lgkmcnt(1)
v_mfma_f32_16x16x32_bf16 v[64:67], v[16:19], a[64:67], v[64:67]
ds_read_b128 v[28:31], v2 offset:35840
v_mfma_f32_16x16x32_bf16 v[68:71], v[16:19], a[68:71], v[68:71]
v_mfma_f32_16x16x32_bf16 v[76:79], v[20:23], a[68:71], v[76:79]
ds_read_b128 v[16:19], v2 offset:36864
v_mfma_f32_16x16x32_bf16 v[72:75], v[20:23], a[64:67], v[72:75]
s_waitcnt lgkmcnt(1)
v_mfma_f32_16x16x32_bf16 v[64:67], v[24:27], a[72:75], v[64:67]
ds_read_b128 v[20:23], v2 offset:37888
v_mfma_f32_16x16x32_bf16 v[68:71], v[24:27], a[76:79], v[68:71]
v_mfma_f32_16x16x32_bf16 v[76:79], v[28:31], a[76:79], v[76:79]
ds_read_b128 v[24:27], v2 offset:38912
v_mfma_f32_16x16x32_bf16 v[72:75], v[28:31], a[72:75], v[72:75]
s_waitcnt lgkmcnt(1)
v_mfma_f32_16x16x32_bf16 v[64:67], v[16:19], a[80:83], v[64:67]
ds_read_b128 v[28:31], v2 offset:39936
v_mfma_f32_16x16x32_bf16 v[68:71], v[16:19], a[84:87], v[68:71]
v_mfma_f32_16x16x32_bf16 v[76:79], v[20:23], a[84:87], v[76:79]
ds_read_b128 v[16:19], v2 offset:40960
v_mfma_f32_16x16x32_bf16 v[72:75], v[20:23], a[80:83], v[72:75]
s_waitcnt lgkmcnt(1)
v_mfma_f32_16x16x32_bf16 v[64:67], v[24:27], a[88:91], v[64:67]
ds_read_b128 v[20:23], v2 offset:41984
v_mfma_f32_16x16x32_bf16 v[68:71], v[24:27], a[92:95], v[68:71]
v_mfma_f32_16x16x32_bf16 v[76:79], v[28:31], a[92:95], v[76:79]
ds_read_b128 v[24:27], v2 offset:43008
v_mfma_f32_16x16x32_bf16 v[72:75], v[28:31], a[88:91], v[72:75]
s_waitcnt lgkmcnt(1)
v_mfma_f32_16x16x32_bf16 v[64:67], v[16:19], a[96:99], v[64:67]
ds_read_b128 v[28:31], v2 offset:44032
v_mfma_f32_16x16x32_bf16 v[68:71], v[16:19], a[100:103], v[68:71]
v_mfma_f32_16x16x32_bf16 v[76:79], v[20:23], a[100:103], v[76:79]
ds_read_b128 v[16:19], v2 offset:45056
v_mfma_f32_16x16x32_bf16 v[72:75], v[20:23], a[96:99], v[72:75]
s_waitcnt lgkmcnt(1)
v_mfma_f32_16x16x32_bf16 v[64:67], v[24:27], a[104:107], v[64:67]
ds_read_b128 v[20:23], v2 offset:46080
v_mfma_f32_16x16x32_bf16 v[68:71], v[24:27], a[108:111], v[68:71]
v_mfma_f32_16x16x32_bf16 v[76:79], v[28:31], a[108:111], v[76:79]
ds_read_b128 v[24:27], v2 offset:47104
v_mfma_f32_16x16x32_bf16 v[72:75], v[28:31], a[104:107], v[72:75]
s_waitcnt lgkmcnt(1)
v_mfma_f32_16x16x32_bf16 v[64:67], v[16:19], a[112:115], v[64:67]
ds_read_b128 v[28:31], v2 offset:48128
v_mfma_f32_16x16x32_bf16 v[68:71], v[16:19], a[116:119], v[68:71]
v_mfma_f32_16x16x32_bf16 v[76:79], v[20:23], a[116:119], v[76:79]
v_mfma_f32_16x16x32_bf16 v[72:75], v[20:23], a[112:115], v[72:75]
s_waitcnt lgkmcnt(0)
v_mfma_f32_16x16x32_bf16 v[64:67], v[24:27], a[120:123], v[64:67]
v_mfma_f32_16x16x32_bf16 v[68:71], v[24:27], a[124:127], v[68:71]
v_mfma_f32_16x16x32_bf16 v[76:79], v[28:31], a[124:127], v[76:79]
v_mfma_f32_16x16x32_bf16 v[72:75], v[28:31], a[120:123], v[72:75]
s_add_u32 s49, s62, 0x1300000
buffer_load_dwordx2 v[32:33], v126, s[4:7], s49 offen offset:0
buffer_load_dwordx2 v[34:35], v126, s[4:7], s49 offen offset:1280
buffer_load_dwordx2 v[36:37], v126, s[4:7], s49 offen offset:2560
s_add_u32 s49, s62, 0x1300f00
buffer_load_dwordx2 v[38:39], v126, s[4:7], s49 offen offset:0
buffer_load_dwordx2 v[40:41], v126, s[4:7], s49 offen offset:1280
buffer_load_dwordx2 v[42:43], v126, s[4:7], s49 offen offset:2560
s_add_u32 s49, s62, 0x1301e00
buffer_load_dwordx2 v[44:45], v126, s[4:7], s49 offen offset:0
buffer_load_dwordx2 v[46:47], v126, s[4:7], s49 offen offset:1280
buffer_load_dwordx2 v[48:49], v126, s[4:7], s49 offen offset:2560
s_add_u32 s49, s62, 0x1302d00
buffer_load_dwordx2 v[50:51], v126, s[4:7], s49 offen offset:0
buffer_load_dwordx2 v[52:53], v126, s[4:7], s49 offen offset:1280
buffer_load_dwordx2 v[54:55], v126, s[4:7], s49 offen offset:2560
s_add_u32 s49, s62, 0x1303c00
buffer_load_dwordx2 v[56:57], v126, s[4:7], s49 offen offset:0
buffer_load_dwordx2 v[58:59], v126, s[4:7], s49 offen offset:1280
buffer_load_dwordx2 v[60:61], v126, s[4:7], s49 offen offset:2560
s_add_u32 s49, s62, 0x1304b00
buffer_load_dwordx2 v[62:63], v126, s[4:7], s49 offen offset:0
v_mul_f32 v96, v64, v114
v_mul_f32 v97, v65, v114
v_mul_f32 v98, v66, v114
v_mul_f32 v99, v67, v114
v_exp_f32_e64 v96, v96 clamp
v_exp_f32_e64 v97, v97 clamp
v_exp_f32_e64 v98, v98 clamp
v_exp_f32_e64 v99, v99 clamp
v_fma_f32 v64, v64, v112, s74
v_fma_f32 v65, v65, v112, s74
v_fma_f32 v66, v66, v112, s74
v_fma_f32 v67, v67, v112, s74
v_max_f32 v64, s74, v64
v_max_f32 v65, s74, v65
v_max_f32 v66, s74, v66
v_max_f32 v67, s74, v67
v_pk_add_f32 v[64:65], v[64:65], v[96:97]
v_pk_add_f32 v[66:67], v[66:67], v[98:99]
v_cvt_pk_bf16_f32 v116, v64, v65
v_cvt_pk_bf16_f32 v117, v66, v67
v_mul_f32 v100, v68, v115
v_mul_f32 v101, v69, v115
v_mul_f32 v102, v70, v115
v_mul_f32 v103, v71, v115
v_exp_f32_e64 v100, v100 clamp
v_exp_f32_e64 v101, v101 clamp
v_exp_f32_e64 v102, v102 clamp
v_exp_f32_e64 v103, v103 clamp
v_fma_f32 v68, v68, v113, s74
v_fma_f32 v69, v69, v113, s74
v_fma_f32 v70, v70, v113, s74
v_fma_f32 v71, v71, v113, s74
v_max_f32 v68, s74, v68
v_max_f32 v69, s74, v69
v_max_f32 v70, s74, v70
v_max_f32 v71, s74, v71
v_pk_add_f32 v[68:69], v[68:69], v[100:101]
v_pk_add_f32 v[70:71], v[70:71], v[102:103]
v_cvt_pk_bf16_f32 v120, v68, v69
v_cvt_pk_bf16_f32 v121, v70, v71
v_mul_f32 v96, v72, v114
v_mul_f32 v97, v73, v114
v_mul_f32 v98, v74, v114
v_mul_f32 v99, v75, v114
v_exp_f32_e64 v96, v96 clamp
v_exp_f32_e64 v97, v97 clamp
v_exp_f32_e64 v98, v98 clamp
v_exp_f32_e64 v99, v99 clamp
v_fma_f32 v72, v72, v112, s74
v_fma_f32 v73, v73, v112, s74
v_fma_f32 v74, v74, v112, s74
v_fma_f32 v75, v75, v112, s74
v_max_f32 v72, s74, v72
v_max_f32 v73, s74, v73
v_max_f32 v74, s74, v74
v_max_f32 v75, s74, v75
v_pk_add_f32 v[72:73], v[72:73], v[96:97]
v_pk_add_f32 v[74:75], v[74:75], v[98:99]
v_cvt_pk_bf16_f32 v118, v72, v73
v_cvt_pk_bf16_f32 v119, v74, v75
v_mul_f32 v100, v76, v115
v_mul_f32 v101, v77, v115
v_mul_f32 v102, v78, v115
v_mul_f32 v103, v79, v115
v_exp_f32_e64 v100, v100 clamp
v_exp_f32_e64 v101, v101 clamp
v_exp_f32_e64 v102, v102 clamp
v_exp_f32_e64 v103, v103 clamp
v_fma_f32 v76, v76, v113, s74
v_fma_f32 v77, v77, v113, s74
v_fma_f32 v78, v78, v113, s74
v_fma_f32 v79, v79, v113, s74
v_max_f32 v76, s74, v76
v_max_f32 v77, s74, v77
v_max_f32 v78, s74, v78
v_max_f32 v79, s74, v79
v_pk_add_f32 v[76:77], v[76:77], v[100:101]
v_pk_add_f32 v[78:79], v[78:79], v[102:103]
v_cvt_pk_bf16_f32 v122, v76, v77
v_cvt_pk_bf16_f32 v123, v78, v79
v_mov_b32 v66, 0
v_mov_b32 v67, 0
v_mov_b32 v68, 0
v_mov_b32 v69, 0
v_mov_b32 v74, 0
v_mov_b32 v75, 0
v_mov_b32 v76, 0
v_mov_b32 v77, 0
s_mov_b32 s51, 0x3f80
s_mov_b32 s52, 0x3f800000
v_lshrrev_b32 v97, 1, v1
s_lshr_b32 s53, s72, 1
s_add_u32 s53, s53, 0x24000
v_add_u32 v96, s53, v97
v_add_u32 v97, 0x24000, v97
s_waitcnt vmcnt(12)
v_max3_u32 v98, v32, v33, 0
v_dot2_f32_bf16 v100, v32, s51, 0
v_dot2_f32_bf16 v101, v32, s52, 0
v_dot2_f32_bf16 v102, v33, s51, 0
v_dot2_f32_bf16 v103, v33, s52, 0
v_max3_u32 v98, v34, v35, v98
v_dot2_f32_bf16 v100, v34, s51, v100
v_dot2_f32_bf16 v101, v34, s52, v101
v_dot2_f32_bf16 v102, v35, s51, v102
v_dot2_f32_bf16 v103, v35, s52, v103
v_max3_u32 v98, v36, v37, v98
v_dot2_f32_bf16 v100, v36, s51, v100
v_dot2_f32_bf16 v101, v36, s52, v101
v_dot2_f32_bf16 v102, v37, s51, v102
v_dot2_f32_bf16 v103, v37, s52, v103
v_max3_u32 v98, v38, v39, v98
v_dot2_f32_bf16 v100, v38, s51, v100
v_dot2_f32_bf16 v101, v38, s52, v101
v_dot2_f32_bf16 v102, v39, s51, v102
v_dot2_f32_bf16 v103, v39, s52, v103
s_waitcnt vmcnt(8)
v_max3_u32 v98, v40, v41, v98
v_dot2_f32_bf16 v100, v40, s51, v100
v_dot2_f32_bf16 v101, v40, s52, v101
v_dot2_f32_bf16 v102, v41, s51, v102
v_dot2_f32_bf16 v103, v41, s52, v103
v_max3_u32 v98, v42, v43, v98
v_dot2_f32_bf16 v100, v42, s51, v100
v_dot2_f32_bf16 v101, v42, s52, v101
v_dot2_f32_bf16 v102, v43, s51, v102
v_dot2_f32_bf16 v103, v43, s52, v103
v_max3_u32 v98, v44, v45, v98
v_dot2_f32_bf16 v100, v44, s51, v100
v_dot2_f32_bf16 v101, v44, s52, v101
v_dot2_f32_bf16 v102, v45, s51, v102
v_dot2_f32_bf16 v103, v45, s52, v103
v_max3_u32 v98, v46, v47, v98
v_dot2_f32_bf16 v100, v46, s51, v100
v_dot2_f32_bf16 v101, v46, s52, v101
v_dot2_f32_bf16 v102, v47, s51, v102
v_dot2_f32_bf16 v103, v47, s52, v103
s_waitcnt vmcnt(4)
v_max3_u32 v98, v48, v49, v98
v_dot2_f32_bf16 v100, v48, s51, v100
v_dot2_f32_bf16 v101, v48, s52, v101
v_dot2_f32_bf16 v102, v49, s51, v102
v_dot2_f32_bf16 v103, v49, s52, v103
v_max3_u32 v98, v50, v51, v98
v_dot2_f32_bf16 v100, v50, s51, v100
v_dot2_f32_bf16 v101, v50, s52, v101
v_dot2_f32_bf16 v102, v51, s51, v102
v_dot2_f32_bf16 v103, v51, s52, v103
v_max3_u32 v98, v52, v53, v98
v_dot2_f32_bf16 v100, v52, s51, v100
v_dot2_f32_bf16 v101, v52, s52, v101
v_dot2_f32_bf16 v102, v53, s51, v102
v_dot2_f32_bf16 v103, v53, s52, v103
v_max3_u32 v98, v54, v55, v98
v_dot2_f32_bf16 v100, v54, s51, v100
v_dot2_f32_bf16 v101, v54, s52, v101
v_dot2_f32_bf16 v102, v55, s51, v102
v_dot2_f32_bf16 v103, v55, s52, v103
s_waitcnt vmcnt(0)
v_max3_u32 v98, v56, v57, v98
v_dot2_f32_bf16 v100, v56, s51, v100
v_dot2_f32_bf16 v101, v56, s52, v101
v_dot2_f32_bf16 v102, v57, s51, v102
v_dot2_f32_bf16 v103, v57, s52, v103
v_max3_u32 v98, v58, v59, v98
v_dot2_f32_bf16 v100, v58, s51, v100
v_dot2_f32_bf16 v101, v58, s52, v101
v_dot2_f32_bf16 v102, v59, s51, v102
v_dot2_f32_bf16 v103, v59, s52, v103
v_max3_u32 v98, v60, v61, v98
v_dot2_f32_bf16 v100, v60, s51, v100
v_dot2_f32_bf16 v101, v60, s52, v101
v_dot2_f32_bf16 v102, v61, s51, v102
v_dot2_f32_bf16 v103, v61, s52, v103
v_max3_u32 v98, v62, v63, v98
v_dot2_f32_bf16 v100, v62, s51, v100
v_dot2_f32_bf16 v101, v62, s52, v101
v_dot2_f32_bf16 v102, v63, s51, v102
v_dot2_f32_bf16 v103, v63, s52, v103
v_cmp_eq_u32 vcc, -1, v98
s_cbranch_vccnz L_c_gsl_89
L_c_gok_90:
s_nop 1
v_cvt_pk_bf16_f32 v100, v100, v101
v_cvt_pk_bf16_f32 v101, v102, v103
ds_write_b64 v96, v[100:101]
s_lshl_b32 s51, s38, 2
v_mov_b32 v59, 2
v_mov_b32 v56, 0x26200
v_add_u32 v58, s51, v56
ds_write_b32 v58, v59
L_c_sa_91:
ds_read_b128 v[48:51], v56
ds_read_b128 v[52:55], v56 offset:16
s_add_u32 s66, s66, 1
s_cmp_lt_u32 s66, 0x800000
s_waitcnt lgkmcnt(0)
v_min3_u32 v48, v48, v49, v50
v_min3_u32 v52, v52, v53, v54
v_min3_u32 v48, v48, v51, v55
v_min_u32 v48, v48, v52
v_cmp_gt_u32 vcc, 2, v48
s_cbranch_scc0 L_c_sa_91_x
s_cbranch_vccnz L_c_sa_91
L_c_sa_91_x:
ds_read_b64 v[64:65], v97 offset:0
ds_read_b64 v[70:71], v97 offset:512
ds_read_b64 v[72:73], v97 offset:1024
ds_read_b64 v[78:79], v97 offset:1536
s_waitcnt lgkmcnt(0)
v_mfma_f32_16x16x32_bf16 v[40:43], v[72:75], v[116:119], 0
v_mfma_f32_16x16x32_bf16 v[44:47], v[76:79], v[116:119], 0
v_mfma_f32_16x16x32_bf16 v[32:35], v[64:67], v[116:119], 0
v_mfma_f32_16x16x32_bf16 v[36:39], v[68:71], v[116:119], 0
v_mfma_f32_16x16x32_bf16 v[56:59], v[72:75], v[120:123], 0
v_mfma_f32_16x16x32_bf16 v[60:63], v[76:79], v[120:123], 0
v_mfma_f32_16x16x32_bf16 v[48:51], v[64:67], v[120:123], 0
v_mfma_f32_16x16x32_bf16 v[52:55], v[68:71], v[120:123], 0
s_nop 0
v_add_f32 v40, s74, v40
v_add_f32 v44, s74, v44
v_rcp_f32 v40, v40
v_rcp_f32 v44, v44
v_pk_mul_f32 v[32:33], v[32:33], v[40:41] op_sel_hi:[1,0]
v_pk_mul_f32 v[34:35], v[34:35], v[40:41] op_sel_hi:[1,0]
v_pk_mul_f32 v[36:37], v[36:37], v[44:45] op_sel_hi:[1,0]
v_pk_mul_f32 v[38:39], v[38:39], v[44:45] op_sel_hi:[1,0]
v_cvt_pk_bf16_f32 v116, v32, v33
v_cvt_pk_bf16_f32 v117, v34, v35
v_cvt_pk_bf16_f32 v118, v36, v37
v_cvt_pk_bf16_f32 v119, v38, v39
v_add_f32 v56, s74, v56
v_add_f32 v60, s74, v60
v_rcp_f32 v56, v56
v_rcp_f32 v60, v60
v_pk_mul_f32 v[48:49], v[48:49], v[56:57] op_sel_hi:[1,0]
v_pk_mul_f32 v[50:51], v[50:51], v[56:57] op_sel_hi:[1,0]
v_pk_mul_f32 v[52:53], v[52:53], v[60:61] op_sel_hi:[1,0]
v_pk_mul_f32 v[54:55], v[54:55], v[60:61] op_sel_hi:[1,0]
v_cvt_pk_bf16_f32 v120, v48, v49
v_cvt_pk_bf16_f32 v121, v50, v51
v_cvt_pk_bf16_f32 v122, v52, v53
v_cvt_pk_bf16_f32 v123, v54, v55
s_cmp_lg_u32 s39, 0
s_cbranch_scc1 L_c_stg_92
s_add_u32 s49, s68, 0x740000
buffer_store_dwordx4 v[116:119], v1, s[4:7], s49 offen offset:0
buffer_store_dwordx4 v[120:123], v1, s[4:7], s49 offen offset:1024
L_c_stb_93:
s_lshl_b32 s51, s46, 13
v_add_u32 v64, s51, v1
v_add_u32 v65, s51, v2
v_add_u32 v66, s51, v3
ds_read_b128 v[16:19], v65 offset:49152
ds_read_b128 v[20:23], v65 offset:50176
ds_read_b128 v[24:27], v65 offset:51200
s_waitcnt vmcnt(0)
v_mov_b32 v6, 6
s_mov_b64 exec, 1
s_cmp_lg_u32 s39, 0
s_cbranch_scc1 L_c_stg_94
buffer_store_dword v6, off, s[4:7], s81  offset:0
L_c_stb_95:
s_mov_b64 exec, -1
buffer_load_dword v98, v5, s[4:7], s57 offen nt
v_lshlrev_b32 v32, 16, v8
v_and_b32 v33, 0xffff0000, v8
v_lshlrev_b32 v34, 16, v9
v_and_b32 v35, 0xffff0000, v9
v_lshlrev_b32 v40, 16, v10
v_and_b32 v41, 0xffff0000, v10
v_lshlrev_b32 v42, 16, v11
v_and_b32 v43, 0xffff0000, v11
v_lshlrev_b32 v36, 16, v12
v_and_b32 v37, 0xffff0000, v12
v_lshlrev_b32 v38, 16, v13
v_and_b32 v39, 0xffff0000, v13
v_lshlrev_b32 v44, 16, v14
v_and_b32 v45, 0xffff0000, v14
v_lshlrev_b32 v46, 16, v15
v_and_b32 v47, 0xffff0000, v15
s_waitcnt vmcnt(0)
v_cmp_gt_u32 vcc, 6, v98
s_cbranch_vccnz L_c_psl_97
L_c_pok_96:
s_add_u32 s100, s55, 0x741000
s_add_u32 s100, s100, s4
s_addc_u32 s101, s5, 0
global_load_dwordx4 a[0:3], v1, s[100:101] offset:-4096 sc1
global_load_dwordx4 a[4:7], v1, s[100:101] offset:-3072 sc1
global_load_dwordx4 a[8:11], v1, s[100:101] offset:-2048 sc1
global_load_dwordx4 a[12:15], v1, s[100:101] offset:-1024 sc1
global_load_dwordx4 a[16:19], v1, s[100:101] offset:0 sc1
global_load_dwordx4 a[20:23], v1, s[100:101] offset:1024 sc1
global_load_dwordx4 a[24:27], v1, s[100:101] offset:2048 sc1
global_load_dwordx4 a[28:31], v1, s[100:101] offset:3072 sc1
s_add_u32 s100, s100, 0x2000
s_addc_u32 s101, s101, 0
global_load_dwordx4 a[32:35], v1, s[100:101] offset:-4096 sc1
global_load_dwordx4 a[36:39], v1, s[100:101] offset:-3072 sc1
global_load_dwordx4 a[40:43], v1, s[100:101] offset:-2048 sc1
global_load_dwordx4 a[44:47], v1, s[100:101] offset:-1024 sc1
s_waitcnt vmcnt(10)
s_waitcnt lgkmcnt(1)
v_mfma_f32_16x16x32_bf16 v[32:35], v[16:19], a[0:3], v[32:35]
ds_read_b128 v[28:31], v65 offset:52224
v_mfma_f32_16x16x32_bf16 v[36:39], v[16:19], a[4:7], v[36:39]
global_load_dwordx4 a[48:51], v1, s[100:101] offset:0 sc1
v_mfma_f32_16x16x32_bf16 v[44:47], v[20:23], a[4:7], v[44:47]
ds_read_b128 v[16:19], v65 offset:53248
v_mfma_f32_16x16x32_bf16 v[40:43], v[20:23], a[0:3], v[40:43]
global_load_dwordx4 a[52:55], v1, s[100:101] offset:1024 sc1
s_waitcnt lgkmcnt(1)
v_mfma_f32_16x16x32_bf16 v[48:51], v[24:27], a[0:3], 0
ds_read_b128 v[20:23], v65 offset:54272
v_mfma_f32_16x16x32_bf16 v[52:55], v[24:27], a[4:7], 0
v_mfma_f32_16x16x32_bf16 v[60:63], v[28:31], a[4:7], 0
ds_read_b128 v[24:27], v65 offset:55296
v_mfma_f32_16x16x32_bf16 v[56:59], v[28:31], a[0:3], 0
s_waitcnt vmcnt(10)
s_waitcnt lgkmcnt(1)
v_mfma_f32_16x16x32_bf16 v[32:35], v[16:19], a[8:11], v[32:35]
ds_read_b128 v[28:31], v65 offset:56320
v_mfma_f32_16x16x32_bf16 v[36:39], v[16:19], a[12:15], v[36:39]
global_load_dwordx4 a[56:59], v1, s[100:101] offset:2048 sc1
v_mfma_f32_16x16x32_bf16 v[44:47], v[20:23], a[12:15], v[44:47]
ds_read_b128 v[16:19], v66 offset:0
v_mfma_f32_16x16x32_bf16 v[40:43], v[20:23], a[8:11], v[40:43]
global_load_dwordx4 a[60:63], v1, s[100:101] offset:3072 sc1
s_waitcnt lgkmcnt(1)
v_mfma_f32_16x16x32_bf16 v[48:51], v[24:27], a[8:11], v[48:51]
ds_read_b128 v[20:23], v66 offset:1024
v_mfma_f32_16x16x32_bf16 v[52:55], v[24:27], a[12:15], v[52:55]
v_mfma_f32_16x16x32_bf16 v[60:63], v[28:31], a[12:15], v[60:63]
ds_read_b128 v[24:27], v66 offset:2048
v_mfma_f32_16x16x32_bf16 v[56:59], v[28:31], a[8:11], v[56:59]
s_waitcnt vmcnt(10)
s_waitcnt lgkmcnt(1)
v_mfma_f32_16x16x32_bf16 v[32:35], v[16:19], a[16:19], v[32:35]
ds_read_b128 v[28:31], v66 offset:3072
v_mfma_f32_16x16x32_bf16 v[36:39], v[16:19], a[20:23], v[36:39]
v_mfma_f32_16x16x32_bf16 v[44:47], v[20:23], a[20:23], v[44:47]
ds_read_b128 v[16:19], v66 offset:4096
v_mfma_f32_16x16x32_bf16 v[40:43], v[20:23], a[16:19], v[40:43]
s_waitcnt lgkmcnt(1)
v_mfma_f32_16x16x32_bf16 v[48:51], v[24:27], a[16:19], v[48:51]
ds_read_b128 v[20:23], v66 offset:5120
v_mfma_f32_16x16x32_bf16 v[52:55], v[24:27], a[20:23], v[52:55]
v_mfma_f32_16x16x32_bf16 v[60:63], v[28:31], a[20:23], v[60:63]
ds_read_b128 v[24:27], v66 offset:6144
v_mfma_f32_16x16x32_bf16 v[56:59], v[28:31], a[16:19], v[56:59]
s_barrier
s_waitcnt vmcnt(8)
s_waitcnt lgkmcnt(1)
v_mfma_f32_16x16x32_bf16 v[32:35], v[16:19], a[24:27], v[32:35]
ds_read_b128 v[28:31], v66 offset:7168
v_mfma_f32_16x16x32_bf16 v[36:39], v[16:19], a[28:31], v[36:39]
v_mfma_f32_16x16x32_bf16 v[44:47], v[20:23], a[28:31], v[44:47]
ds_read_b128 v[16:19], v64 offset:0
v_mfma_f32_16x16x32_bf16 v[40:43], v[20:23], a[24:27], v[40:43]
s_waitcnt lgkmcnt(1)
v_mfma_f32_16x16x32_bf16 v[48:51], v[24:27], a[24:27], v[48:51]
ds_read_b128 v[20:23], v64 offset:1024
v_mfma_f32_16x16x32_bf16 v[52:55], v[24:27], a[28:31], v[52:55]
v_mfma_f32_16x16x32_bf16 v[60:63], v[28:31], a[28:31], v[60:63]
ds_read_b128 v[24:27], v64 offset:2048
v_mfma_f32_16x16x32_bf16 v[56:59], v[28:31], a[24:27], v[56:59]
s_waitcnt vmcnt(6)
s_waitcnt lgkmcnt(1)
v_mfma_f32_16x16x32_bf16 v[32:35], v[16:19], a[32:35], v[32:35]
ds_read_b128 v[28:31], v64 offset:3072
v_mfma_f32_16x16x32_bf16 v[36:39], v[16:19], a[36:39], v[36:39]
v_mfma_f32_16x16x32_bf16 v[44:47], v[20:23], a[36:39], v[44:47]
ds_read_b128 v[16:19], v64 offset:4096
v_mfma_f32_16x16x32_bf16 v[40:43], v[20:23], a[32:35], v[40:43]
s_waitcnt lgkmcnt(1)
v_mfma_f32_16x16x32_bf16 v[48:51], v[24:27], a[32:35], v[48:51]
ds_read_b128 v[20:23], v64 offset:5120
v_mfma_f32_16x16x32_bf16 v[52:55], v[24:27], a[36:39], v[52:55]
v_mfma_f32_16x16x32_bf16 v[60:63], v[28:31], a[36:39], v[60:63]
ds_read_b128 v[24:27], v64 offset:6144
v_mfma_f32_16x16x32_bf16 v[56:59], v[28:31], a[32:35], v[56:59]
s_waitcnt vmcnt(4)
s_waitcnt lgkmcnt(1)
v_mfma_f32_16x16x32_bf16 v[32:35], v[16:19], a[40:43], v[32:35]
ds_read_b128 v[28:31], v64 offset:7168
v_mfma_f32_16x16x32_bf16 v[36:39], v[16:19], a[44:47], v[36:39]
v_mfma_f32_16x16x32_bf16 v[44:47], v[20:23], a[44:47], v[44:47]
ds_read_b128 v[16:19], v64 offset:18432
v_mfma_f32_16x16x32_bf16 v[40:43], v[20:23], a[40:43], v[40:43]
s_waitcnt lgkmcnt(1)
v_mfma_f32_16x16x32_bf16 v[48:51], v[24:27], a[40:43], v[48:51]
ds_read_b128 v[20:23], v64 offset:19456
v_mfma_f32_16x16x32_bf16 v[52:55], v[24:27], a[44:47], v[52:55]
v_mfma_f32_16x16x32_bf16 v[60:63], v[28:31], a[44:47], v[60:63]
ds_read_b128 v[24:27], v64 offset:22528
v_mfma_f32_16x16x32_bf16 v[56:59], v[28:31], a[40:43], v[56:59]
s_waitcnt vmcnt(2)
s_waitcnt lgkmcnt(1)
v_mfma_f32_16x16x32_bf16 v[48:51], v[16:19], a[48:51], v[48:51]
ds_read_b128 v[28:31], v64 offset:23552
v_mfma_f32_16x16x32_bf16 v[52:55], v[16:19], a[52:55], v[52:55]
v_mfma_f32_16x16x32_bf16 v[60:63], v[20:23], a[52:55], v[60:63]
ds_read_b128 v[16:19], v64 offset:16384
v_mfma_f32_16x16x32_bf16 v[56:59], v[20:23], a[48:51], v[56:59]
v_add_u32 v120, s73, v1
s_xor_b32 s51, s73, 0x2000
v_add_u32 v121, s51, v1
s_waitcnt vmcnt(0)
s_waitcnt lgkmcnt(1)
v_mfma_f32_16x16x32_bf16 v[48:51], v[24:27], a[56:59], v[48:51]
ds_read_b128 v[20:23], v64 offset:17408
v_mfma_f32_16x16x32_bf16 v[52:55], v[24:27], a[60:63], v[52:55]
v_mfma_f32_16x16x32_bf16 v[60:63], v[28:31], a[60:63], v[60:63]
ds_read_b128 v[24:27], v64 offset:20480
v_mfma_f32_16x16x32_bf16 v[56:59], v[28:31], a[56:59], v[56:59]
s_waitcnt lgkmcnt(1)
v_mfma_f32_16x16x32_bf16 v[32:35], v[16:19], a[48:51], v[32:35]
ds_read_b128 v[28:31], v64 offset:21504
v_mfma_f32_16x16x32_bf16 v[36:39], v[16:19], a[52:55], v[36:39]
ds_write_b128 v120, v[48:51] offset:0
ds_write_b128 v120, v[52:55] offset:1024
v_mfma_f32_16x16x32_bf16 v[44:47], v[20:23], a[52:55], v[44:47]
v_mfma_f32_16x16x32_bf16 v[40:43], v[20:23], a[48:51], v[40:43]
ds_write_b128 v120, v[56:59] offset:2048
ds_write_b128 v120, v[60:63] offset:3072
s_waitcnt lgkmcnt(4)
v_mfma_f32_16x16x32_bf16 v[32:35], v[24:27], a[56:59], v[32:35]
v_mfma_f32_16x16x32_bf16 v[36:39], v[24:27], a[60:63], v[36:39]
s_waitcnt lgkmcnt(0)
s_barrier
ds_read_b128 v[48:51], v121 offset:0
ds_read_b128 v[52:55], v121 offset:1024
ds_read_b128 v[56:59], v121 offset:2048
ds_read_b128 v[60:63], v121 offset:3072
v_mfma_f32_16x16x32_bf16 v[44:47], v[28:31], a[60:63], v[44:47]
v_mfma_f32_16x16x32_bf16 v[40:43], v[28:31], a[56:59], v[40:43]
s_waitcnt lgkmcnt(1)
v_pk_add_f32 v[32:33], v[32:33], v[48:49]
v_pk_add_f32 v[34:35], v[34:35], v[50:51]
s_nop 4
v_pk_add_f32 v[40:41], v[40:41], v[56:57]
v_pk_add_f32 v[42:43], v[42:43], v[58:59]
v_cvt_pk_bf16_f32 v8, v32, v33
v_cvt_pk_bf16_f32 v9, v34, v35
v_cvt_pk_bf16_f32 v10, v40, v41
v_cvt_pk_bf16_f32 v11, v42, v43
s_waitcnt lgkmcnt(0)
v_pk_add_f32 v[36:37], v[36:37], v[52:53]
v_pk_add_f32 v[38:39], v[38:39], v[54:55]
v_pk_add_f32 v[44:45], v[44:45], v[60:61]
v_pk_add_f32 v[46:47], v[46:47], v[62:63]
v_cvt_pk_bf16_f32 v12, v36, v37
v_cvt_pk_bf16_f32 v13, v38, v39
v_cvt_pk_bf16_f32 v14, v44, v45
v_cvt_pk_bf16_f32 v15, v46, v47
s_cmp_lg_u32 s39, 0
s_cbranch_scc1 L_c_stg_100
s_add_u32 s49, s69, 0x940000
buffer_store_dwordx4 v[8:11], v1, s[4:7], s49 offen offset:0
buffer_store_dwordx4 v[12:15], v1, s[4:7], s49 offen offset:1024
L_c_stb_101:
v_pk_add_f32 v[48:49], v[32:33], v[34:35]
v_pk_mul_f32 v[50:51], v[32:33], v[32:33]
v_pk_add_f32 v[48:49], v[48:49], v[40:41]
v_pk_fma_f32 v[50:51], v[34:35], v[34:35], v[50:51]
v_pk_add_f32 v[48:49], v[48:49], v[42:43]
v_pk_fma_f32 v[50:51], v[40:41], v[40:41], v[50:51]
v_pk_fma_f32 v[50:51], v[42:43], v[42:43], v[50:51]
v_pk_add_f32 v[52:53], v[36:37], v[38:39]
v_pk_mul_f32 v[54:55], v[36:37], v[36:37]
v_pk_add_f32 v[52:53], v[52:53], v[44:45]
v_pk_fma_f32 v[54:55], v[38:39], v[38:39], v[54:55]
v_pk_add_f32 v[52:53], v[52:53], v[46:47]
v_pk_fma_f32 v[54:55], v[44:45], v[44:45], v[54:55]
v_pk_fma_f32 v[54:55], v[46:47], v[46:47], v[54:55]
v_add_f32 v48, v48, v49
v_add_f32 v50, v50, v51
v_add_f32 v52, v52, v53
v_add_f32 v54, v54, v55
s_nop 0
v_permlane32_swap_b32 v48, v52
v_permlane32_swap_b32 v50, v54
v_add_f32 v48, v48, v52
v_add_f32 v50, v50, v54
s_nop 1
v_permlane16_swap_b32 v48, v50
v_add_f32 v48, v48, v50
v_min_u32 v48, -2, v48
s_cmp_lg_u32 s39, 0
s_cbranch_scc1 L_c_stg_102
s_add_u32 s49, s61, 0x1380000
buffer_store_dword v48, v1, s[4:7], s49 offen offset:0
L_c_stb_103:
L_ph3_1:
ds_read_b128 v[16:19], v1 offset:32768
ds_read_b128 v[20:23], v1 offset:33792
ds_read_b128 v[24:27], v1 offset:34816
s_waitcnt vmcnt(1)
v_mov_b32 v6, 3
s_mov_b64 exec, 1
s_cmp_lg_u32 s39, 0
s_cbranch_scc1 L_c_stg_104
buffer_store_dword v6, off, s[4:7], s82  offset:0
L_c_stb_105:
s_mov_b64 exec, -1
buffer_load_dword v96, v4, s[4:7], s56 offen nt
s_waitcnt vmcnt(0)
v_cmp_gt_u32 vcc, 3, v96
s_cbranch_vccnz L_c_psl_107
L_c_pok_106:
s_add_u32 s100, s54, 0x941000
s_add_u32 s100, s100, s4
s_addc_u32 s101, s5, 0
global_load_dwordx4 a[0:3], v1, s[100:101] offset:-4096 sc1
global_load_dwordx4 a[4:7], v1, s[100:101] offset:-3072 sc1
global_load_dwordx4 a[8:11], v1, s[100:101] offset:-2048 sc1
global_load_dwordx4 a[12:15], v1, s[100:101] offset:-1024 sc1
global_load_dwordx4 a[16:19], v1, s[100:101] offset:0 sc1
global_load_dwordx4 a[20:23], v1, s[100:101] offset:1024 sc1
global_load_dwordx4 a[24:27], v1, s[100:101] offset:2048 sc1
global_load_dwordx4 a[28:31], v1, s[100:101] offset:3072 sc1
s_add_u32 s100, s100, 0x2000
s_addc_u32 s101, s101, 0
global_load_dwordx4 a[32:35], v1, s[100:101] offset:-4096 sc1
global_load_dwordx4 a[36:39], v1, s[100:101] offset:-3072 sc1
global_load_dwordx4 a[40:43], v1, s[100:101] offset:-2048 sc1
global_load_dwordx4 a[44:47], v1, s[100:101] offset:-1024 sc1
s_waitcnt vmcnt(10)
s_waitcnt lgkmcnt(1)
v_mfma_f32_16x16x32_bf16 v[32:35], v[16:19], a[0:3], 0
ds_read_b128 v[28:31], v1 offset:35840
v_mfma_f32_16x16x32_bf16 v[36:39], v[16:19], a[4:7], 0
global_load_dwordx4 a[48:51], v1, s[100:101] offset:0 sc1
v_mfma_f32_16x16x32_bf16 v[44:47], v[20:23], a[4:7], 0
ds_read_b128 v[16:19], v1 offset:36864
v_mfma_f32_16x16x32_bf16 v[40:43], v[20:23], a[0:3], 0
global_load_dwordx4 a[52:55], v1, s[100:101] offset:1024 sc1
s_waitcnt lgkmcnt(1)
v_mfma_f32_16x16x32_bf16 v[48:51], v[24:27], a[0:3], 0
ds_read_b128 v[20:23], v1 offset:37888
v_mfma_f32_16x16x32_bf16 v[52:55], v[24:27], a[4:7], 0
v_mfma_f32_16x16x32_bf16 v[60:63], v[28:31], a[4:7], 0
ds_read_b128 v[24:27], v1 offset:38912
v_mfma_f32_16x16x32_bf16 v[56:59], v[28:31], a[0:3], 0
s_waitcnt vmcnt(10)
s_waitcnt lgkmcnt(1)
v_mfma_f32_16x16x32_bf16 v[32:35], v[16:19], a[8:11], v[32:35]
ds_read_b128 v[28:31], v1 offset:39936
v_mfma_f32_16x16x32_bf16 v[36:39], v[16:19], a[12:15], v[36:39]
global_load_dwordx4 a[56:59], v1, s[100:101] offset:2048 sc1
v_mfma_f32_16x16x32_bf16 v[44:47], v[20:23], a[12:15], v[44:47]
ds_read_b128 v[16:19], v1 offset:40960
v_mfma_f32_16x16x32_bf16 v[40:43], v[20:23], a[8:11], v[40:43]
global_load_dwordx4 a[60:63], v1, s[100:101] offset:3072 sc1
s_waitcnt lgkmcnt(1)
v_mfma_f32_16x16x32_bf16 v[48:51], v[24:27], a[8:11], v[48:51]
ds_read_b128 v[20:23], v1 offset:41984
v_mfma_f32_16x16x32_bf16 v[52:55], v[24:27], a[12:15], v[52:55]
v_mfma_f32_16x16x32_bf16 v[60:63], v[28:31], a[12:15], v[60:63]
ds_read_b128 v[24:27], v1 offset:43008
v_mfma_f32_16x16x32_bf16 v[56:59], v[28:31], a[8:11], v[56:59]
s_waitcnt vmcnt(10)
s_waitcnt lgkmcnt(1)
v_mfma_f32_16x16x32_bf16 v[32:35], v[16:19], a[16:19], v[32:35]
ds_read_b128 v[28:31], v1 offset:44032
v_mfma_f32_16x16x32_bf16 v[36:39], v[16:19], a[20:23], v[36:39]
s_add_u32 s100, s100, 0x2000
s_addc_u32 s101, s101, 0
global_load_dwordx4 a[64:67], v1, s[100:101] offset:-4096 sc1
v_mfma_f32_16x16x32_bf16 v[44:47], v[20:23], a[20:23], v[44:47]
ds_read_b128 v[16:19], v1 offset:45056
v_mfma_f32_16x16x32_bf16 v[40:43], v[20:23], a[16:19], v[40:43]
global_load_dwordx4 a[68:71], v1, s[100:101] offset:-3072 sc1
s_waitcnt lgkmcnt(1)
v_mfma_f32_16x16x32_bf16 v[48:51], v[24:27], a[16:19], v[48:51]
ds_read_b128 v[20:23], v1 offset:46080
v_mfma_f32_16x16x32_bf16 v[52:55], v[24:27], a[20:23], v[52:55]
v_mfma_f32_16x16x32_bf16 v[60:63], v[28:31], a[20:23], v[60:63]
ds_read_b128 v[24:27], v1 offset:47104
v_mfma_f32_16x16x32_bf16 v[56:59], v[28:31], a[16:19], v[56:59]
s_barrier
s_waitcnt vmcnt(10)
s_waitcnt lgkmcnt(1)
v_mfma_f32_16x16x32_bf16 v[32:35], v[16:19], a[24:27], v[32:35]
ds_read_b128 v[28:31], v1 offset:48128
v_mfma_f32_16x16x32_bf16 v[36:39], v[16:19], a[28:31], v[36:39]
global_load_dwordx4 a[72:75], v1, s[100:101] offset:-2048 sc1
v_mfma_f32_16x16x32_bf16 v[44:47], v[20:23], a[28:31], v[44:47]
ds_read_b128 v[16:19], v1 offset:49152
v_mfma_f32_16x16x32_bf16 v[40:43], v[20:23], a[24:27], v[40:43]
global_load_dwordx4 a[76:79], v1, s[100:101] offset:-1024 sc1
s_waitcnt lgkmcnt(1)
v_mfma_f32_16x16x32_bf16 v[48:51], v[24:27], a[24:27], v[48:51]
ds_read_b128 v[20:23], v1 offset:50176
v_mfma_f32_16x16x32_bf16 v[52:55], v[24:27], a[28:31], v[52:55]
v_mfma_f32_16x16x32_bf16 v[60:63], v[28:31], a[28:31], v[60:63]
ds_read_b128 v[24:27], v1 offset:51200
v_mfma_f32_16x16x32_bf16 v[56:59], v[28:31], a[24:27], v[56:59]
s_waitcnt vmcnt(10)
s_waitcnt lgkmcnt(1)
v_mfma_f32_16x16x32_bf16 v[32:35], v[16:19], a[32:35], v[32:35]
ds_read_b128 v[28:31], v1 offset:52224
v_mfma_f32_16x16x32_bf16 v[36:39], v[16:19], a[36:39], v[36:39]
global_load_dwordx4 a[80:83], v1, s[100:101] offset:0 sc1
v_mfma_f32_16x16x32_bf16 v[44:47], v[20:23], a[36:39], v[44:47]
ds_read_b128 v[16:19], v1 offset:53248
v_mfma_f32_16x16x32_bf16 v[40:43], v[20:23], a[32:35], v[40:43]
global_load_dwordx4 a[84:87], v1, s[100:101] offset:1024 sc1
s_waitcnt lgkmcnt(1)
v_mfma_f32_16x16x32_bf16 v[48:51], v[24:27], a[32:35], v[48:51]
ds_read_b128 v[20:23], v1 offset:54272
v_mfma_f32_16x16x32_bf16 v[52:55], v[24:27], a[36:39], v[52:55]
v_mfma_f32_16x16x32_bf16 v[60:63], v[28:31], a[36:39], v[60:63]
ds_read_b128 v[24:27], v1 offset:55296
v_mfma_f32_16x16x32_bf16 v[56:59], v[28:31], a[32:35], v[56:59]
s_waitcnt vmcnt(10)
s_waitcnt lgkmcnt(1)
v_mfma_f32_16x16x32_bf16 v[32:35], v[16:19], a[40:43], v[32:35]
ds_read_b128 v[28:31], v1 offset:56320
v_mfma_f32_16x16x32_bf16 v[36:39], v[16:19], a[44:47], v[36:39]
global_load_dwordx4 a[88:91], v1, s[100:101] offset:2048 sc1
v_mfma_f32_16x16x32_bf16 v[44:47], v[20:23], a[44:47], v[44:47]
ds_read_b128 v[16:19], v1 offset:57344
v_mfma_f32_16x16x32_bf16 v[40:43], v[20:23], a[40:43], v[40:43]
global_load_dwordx4 a[92:95], v1, s[100:101] offset:3072 sc1
s_waitcnt lgkmcnt(1)
v_mfma_f32_16x16x32_bf16 v[48:51], v[24:27], a[40:43], v[48:51]
ds_read_b128 v[20:23], v1 offset:58368
v_mfma_f32_16x16x32_bf16 v[52:55], v[24:27], a[44:47], v[52:55]
s_add_u32 s100, s60, 0x1381000
s_add_u32 s100, s100, s4
s_addc_u32 s101, s5, 0
global_load_dwordx4 v[80:83], v1, s[100:101] offset:-4096 sc1
v_mfma_f32_16x16x32_bf16 v[60:63], v[28:31], a[44:47], v[60:63]
ds_read_b128 v[24:27], v1 offset:59392
v_mfma_f32_16x16x32_bf16 v[56:59], v[28:31], a[40:43], v[56:59]
s_waitcnt vmcnt(11)
s_waitcnt lgkmcnt(1)
v_mfma_f32_16x16x32_bf16 v[32:35], v[16:19], a[48:51], v[32:35]
ds_read_b128 v[28:31], v1 offset:60416
v_mfma_f32_16x16x32_bf16 v[36:39], v[16:19], a[52:55], v[36:39]
global_load_dwordx4 v[84:87], v1, s[100:101] offset:-3072 sc1
v_mfma_f32_16x16x32_bf16 v[44:47], v[20:23], a[52:55], v[44:47]
ds_read_b128 v[16:19], v1 offset:61440
v_mfma_f32_16x16x32_bf16 v[40:43], v[20:23], a[48:51], v[40:43]
global_load_dwordx4 v[88:91], v1, s[100:101] offset:-2048 sc1
s_waitcnt lgkmcnt(1)
v_mfma_f32_16x16x32_bf16 v[48:51], v[24:27], a[48:51], v[48:51]
ds_read_b128 v[20:23], v1 offset:62464
v_mfma_f32_16x16x32_bf16 v[52:55], v[24:27], a[52:55], v[52:55]
global_load_dwordx4 v[92:95], v1, s[100:101] offset:-1024 sc1
v_mfma_f32_16x16x32_bf16 v[60:63], v[28:31], a[52:55], v[60:63]
ds_read_b128 v[24:27], v1 offset:63488
v_mfma_f32_16x16x32_bf16 v[56:59], v[28:31], a[48:51], v[56:59]
s_barrier
s_waitcnt vmcnt(12)
s_waitcnt lgkmcnt(1)
v_mfma_f32_16x16x32_bf16 v[32:35], v[16:19], a[56:59], v[32:35]
ds_read_b128 v[28:31], v1 offset:64512
v_mfma_f32_16x16x32_bf16 v[36:39], v[16:19], a[60:63], v[36:39]
s_add_u32 s100, s54, 0x947000
s_add_u32 s100, s100, s4
s_addc_u32 s101, s5, 0
global_load_dwordx4 a[96:99], v1, s[100:101] offset:-4096 sc1
v_mfma_f32_16x16x32_bf16 v[44:47], v[20:23], a[60:63], v[44:47]
ds_read_b128 v[16:19], v2 offset:0
v_mfma_f32_16x16x32_bf16 v[40:43], v[20:23], a[56:59], v[40:43]
global_load_dwordx4 a[100:103], v1, s[100:101] offset:-3072 sc1
s_waitcnt lgkmcnt(1)
v_mfma_f32_16x16x32_bf16 v[48:51], v[24:27], a[56:59], v[48:51]
ds_read_b128 v[20:23], v2 offset:1024
v_mfma_f32_16x16x32_bf16 v[52:55], v[24:27], a[60:63], v[52:55]
v_mfma_f32_16x16x32_bf16 v[60:63], v[28:31], a[60:63], v[60:63]
ds_read_b128 v[24:27], v2 offset:2048
v_mfma_f32_16x16x32_bf16 v[56:59], v[28:31], a[56:59], v[56:59]
s_waitcnt vmcnt(12)
s_waitcnt lgkmcnt(1)
v_mfma_f32_16x16x32_bf16 v[32:35], v[16:19], a[64:67], v[32:35]
ds_read_b128 v[28:31], v2 offset:3072
v_mfma_f32_16x16x32_bf16 v[36:39], v[16:19], a[68:71], v[36:39]
global_load_dwordx4 a[104:107], v1, s[100:101] offset:-2048 sc1
v_mfma_f32_16x16x32_bf16 v[44:47], v[20:23], a[68:71], v[44:47]
ds_read_b128 v[16:19], v2 offset:4096
v_mfma_f32_16x16x32_bf16 v[40:43], v[20:23], a[64:67], v[40:43]
global_load_dwordx4 a[108:111], v1, s[100:101] offset:-1024 sc1
s_waitcnt lgkmcnt(1)
v_mfma_f32_16x16x32_bf16 v[48:51], v[24:27], a[64:67], v[48:51]
ds_read_b128 v[20:23], v2 offset:5120
v_mfma_f32_16x16x32_bf16 v[52:55], v[24:27], a[68:71], v[52:55]
v_mfma_f32_16x16x32_bf16 v[60:63], v[28:31], a[68:71], v[60:63]
ds_read_b128 v[24:27], v2 offset:6144
v_mfma_f32_16x16x32_bf16 v[56:59], v[28:31], a[64:67], v[56:59]
s_waitcnt vmcnt(12)
s_waitcnt lgkmcnt(1)
v_mfma_f32_16x16x32_bf16 v[32:35], v[16:19], a[72:75], v[32:35]
ds_read_b128 v[28:31], v2 offset:7168
v_mfma_f32_16x16x32_bf16 v[36:39], v[16:19], a[76:79], v[36:39]
global_load_dwordx4 a[112:115], v1, s[100:101] offset:0 sc1
v_mfma_f32_16x16x32_bf16 v[44:47], v[20:23], a[76:79], v[44:47]
ds_read_b128 v[16:19], v2 offset:8192
v_mfma_f32_16x16x32_bf16 v[40:43], v[20:23], a[72:75], v[40:43]
global_load_dwordx4 a[116:119], v1, s[100:101] offset:1024 sc1
s_waitcnt lgkmcnt(1)
v_mfma_f32_16x16x32_bf16 v[48:51], v[24:27], a[72:75], v[48:51]
ds_read_b128 v[20:23], v2 offset:9216
v_mfma_f32_16x16x32_bf16 v[52:55], v[24:27], a[76:79], v[52:55]
v_mfma_f32_16x16x32_bf16 v[60:63], v[28:31], a[76:79], v[60:63]
ds_read_b128 v[24:27], v2 offset:10240
v_mfma_f32_16x16x32_bf16 v[56:59], v[28:31], a[72:75], v[56:59]
s_waitcnt vmcnt(12)
s_waitcnt lgkmcnt(1)
v_mfma_f32_16x16x32_bf16 v[32:35], v[16:19], a[80:83], v[32:35]
ds_read_b128 v[28:31], v2 offset:11264
v_mfma_f32_16x16x32_bf16 v[36:39], v[16:19], a[84:87], v[36:39]
global_load_dwordx4 a[120:123], v1, s[100:101] offset:2048 sc1
v_mfma_f32_16x16x32_bf16 v[44:47], v[20:23], a[84:87], v[44:47]
ds_read_b128 v[16:19], v2 offset:12288
v_mfma_f32_16x16x32_bf16 v[40:43], v[20:23], a[80:83], v[40:43]
global_load_dwordx4 a[124:127], v1, s[100:101] offset:3072 sc1
s_waitcnt lgkmcnt(1)
v_mfma_f32_16x16x32_bf16 v[48:51], v[24:27], a[80:83], v[48:51]
ds_read_b128 v[20:23], v2 offset:13312
v_mfma_f32_16x16x32_bf16 v[52:55], v[24:27], a[84:87], v[52:55]
v_mfma_f32_16x16x32_bf16 v[60:63], v[28:31], a[84:87], v[60:63]
ds_read_b128 v[24:27], v2 offset:14336
v_mfma_f32_16x16x32_bf16 v[56:59], v[28:31], a[80:83], v[56:59]
s_barrier
s_waitcnt vmcnt(12)
s_waitcnt lgkmcnt(1)
v_mfma_f32_16x16x32_bf16 v[32:35], v[16:19], a[88:91], v[32:35]
ds_read_b128 v[28:31], v2 offset:15360
v_mfma_f32_16x16x32_bf16 v[36:39], v[16:19], a[92:95], v[36:39]
v_mfma_f32_16x16x32_bf16 v[44:47], v[20:23], a[92:95], v[44:47]
ds_read_b128 v[16:19], v2 offset:16384
v_mfma_f32_16x16x32_bf16 v[40:43], v[20:23], a[88:91], v[40:43]
s_waitcnt lgkmcnt(1)
v_mfma_f32_16x16x32_bf16 v[48:51], v[24:27], a[88:91], v[48:51]
ds_read_b128 v[20:23], v2 offset:17408
v_mfma_f32_16x16x32_bf16 v[52:55], v[24:27], a[92:95], v[52:55]
v_mfma_f32_16x16x32_bf16 v[60:63], v[28:31], a[92:95], v[60:63]
ds_read_b128 v[24:27], v2 offset:18432
v_mfma_f32_16x16x32_bf16 v[56:59], v[28:31], a[88:91], v[56:59]
s_waitcnt vmcnt(6)
s_waitcnt lgkmcnt(1)
v_mfma_f32_16x16x32_bf16 v[32:35], v[16:19], a[96:99], v[32:35]
ds_read_b128 v[28:31], v2 offset:19456
v_max3_u32 v96, v80, v81, v82
v_mfma_f32_16x16x32_bf16 v[36:39], v[16:19], a[100:103], v[36:39]
v_max3_u32 v96, v96, v83, v84
v_mfma_f32_16x16x32_bf16 v[44:47], v[20:23], a[100:103], v[44:47]
ds_read_b128 v[16:19], v2 offset:20480
v_max3_u32 v96, v96, v85, v86
v_mfma_f32_16x16x32_bf16 v[40:43], v[20:23], a[96:99], v[40:43]
v_max3_u32 v96, v96, v87, v88
s_waitcnt lgkmcnt(1)
v_mfma_f32_16x16x32_bf16 v[48:51], v[24:27], a[96:99], v[48:51]
ds_read_b128 v[20:23], v2 offset:21504
v_max3_u32 v96, v96, v89, v90
v_mfma_f32_16x16x32_bf16 v[52:55], v[24:27], a[100:103], v[52:55]
v_max3_u32 v96, v96, v91, v92
v_mfma_f32_16x16x32_bf16 v[60:63], v[28:31], a[100:103], v[60:63]
ds_read_b128 v[24:27], v2 offset:22528
v_max3_u32 v96, v96, v93, v94
v_mfma_f32_16x16x32_bf16 v[56:59], v[28:31], a[96:99], v[56:59]
v_max_u32 v96, v96, v95
v_cmp_eq_u32 vcc, -1, v96
s_cbranch_vccnz L_c_tsl_110
L_c_tok_111:
v_pk_add_f32 v[80:81], v[80:81], v[84:85]
s_waitcnt vmcnt(4)
s_waitcnt lgkmcnt(1)
v_mfma_f32_16x16x32_bf16 v[32:35], v[16:19], a[104:107], v[32:35]
ds_read_b128 v[28:31], v2 offset:23552
v_pk_add_f32 v[88:89], v[88:89], v[92:93]
v_mfma_f32_16x16x32_bf16 v[36:39], v[16:19], a[108:111], v[36:39]
v_pk_add_f32 v[82:83], v[82:83], v[86:87]
v_pk_add_f32 v[90:91], v[90:91], v[94:95]
v_mfma_f32_16x16x32_bf16 v[44:47], v[20:23], a[108:111], v[44:47]
ds_read_b128 v[16:19], v2 offset:24576
v_pk_add_f32 v[80:81], v[80:81], v[82:83]
v_mfma_f32_16x16x32_bf16 v[40:43], v[20:23], a[104:107], v[40:43]
v_pk_add_f32 v[88:89], v[88:89], v[90:91]
s_waitcnt lgkmcnt(1)
v_mfma_f32_16x16x32_bf16 v[48:51], v[24:27], a[104:107], v[48:51]
ds_read_b128 v[20:23], v2 offset:25600
v_pk_add_f32 v[80:81], v[80:81], v[88:89]
v_mfma_f32_16x16x32_bf16 v[52:55], v[24:27], a[108:111], v[52:55]
v_add_f32 v80, v80, v81
v_mfma_f32_16x16x32_bf16 v[60:63], v[28:31], a[108:111], v[60:63]
ds_read_b128 v[24:27], v2 offset:26624
v_mul_f32 v80, 0x3b000000, v80
v_mfma_f32_16x16x32_bf16 v[56:59], v[28:31], a[104:107], v[56:59]
v_mov_b32 v81, v80
s_waitcnt vmcnt(2)
s_waitcnt lgkmcnt(1)
v_mfma_f32_16x16x32_bf16 v[32:35], v[16:19], a[112:115], v[32:35]
ds_read_b128 v[28:31], v2 offset:27648
s_nop 1
v_mfma_f32_16x16x32_bf16 v[36:39], v[16:19], a[116:119], v[36:39]
v_permlane16_swap_b32 v80, v81
v_mfma_f32_16x16x32_bf16 v[44:47], v[20:23], a[116:119], v[44:47]
ds_read_b128 v[16:19], v2 offset:28672
v_fma_f32 v81, -v80, v80, v81
v_mfma_f32_16x16x32_bf16 v[40:43], v[20:23], a[112:115], v[40:43]
v_max_f32 v81, 0, v81
s_waitcnt lgkmcnt(1)
v_mfma_f32_16x16x32_bf16 v[48:51], v[24:27], a[112:115], v[48:51]
ds_read_b128 v[20:23], v2 offset:29696
v_add_f32 v81, 0x3727c5ac, v81
v_mfma_f32_16x16x32_bf16 v[52:55], v[24:27], a[116:119], v[52:55]
v_rsq_f32 v96, v81
v_mfma_f32_16x16x32_bf16 v[60:63], v[28:31], a[116:119], v[60:63]
ds_read_b128 v[24:27], v2 offset:30720
v_mfma_f32_16x16x32_bf16 v[56:59], v[28:31], a[112:115], v[56:59]
s_barrier
s_waitcnt vmcnt(0)
s_waitcnt lgkmcnt(1)
v_mfma_f32_16x16x32_bf16 v[32:35], v[16:19], a[120:123], v[32:35]
ds_read_b128 v[28:31], v2 offset:31744
v_mfma_f32_16x16x32_bf16 v[36:39], v[16:19], a[124:127], v[36:39]
v_sqrt_f32 v98, v81
s_nop 0
v_mfma_f32_16x16x32_bf16 v[44:47], v[20:23], a[124:127], v[44:47]
ds_read_b128 v[16:19], v2 offset:32768
v_mov_b32 v99, v98
v_mfma_f32_16x16x32_bf16 v[40:43], v[20:23], a[120:123], v[40:43]
v_mul_f32 v96, 0xbfb8aa3b, v96
s_waitcnt lgkmcnt(1)
v_mfma_f32_16x16x32_bf16 v[48:51], v[24:27], a[120:123], v[48:51]
ds_read_b128 v[20:23], v2 offset:33792
v_mov_b32 v97, v96
v_mfma_f32_16x16x32_bf16 v[52:55], v[24:27], a[124:127], v[52:55]
s_nop 1
v_permlane32_swap_b32 v96, v97
v_permlane32_swap_b32 v98, v99
v_mfma_f32_16x16x32_bf16 v[60:63], v[28:31], a[124:127], v[60:63]
ds_read_b128 v[24:27], v2 offset:34816
v_mfma_f32_16x16x32_bf16 v[56:59], v[28:31], a[120:123], v[56:59]
s_waitcnt lgkmcnt(1)
v_mfma_f32_16x16x32_bf16 v[64:67], v[16:19], a[0:3], 0
ds_read_b128 v[28:31], v2 offset:35840
v_mfma_f32_16x16x32_bf16 v[68:71], v[16:19], a[4:7], 0
v_mfma_f32_16x16x32_bf16 v[76:79], v[20:23], a[4:7], 0
ds_read_b128 v[16:19], v2 offset:36864
v_mul_f32 v32, v32, v96
v_mfma_f32_16x16x32_bf16 v[72:75], v[20:23], a[0:3], 0
v_exp_f32 v32, v32
s_waitcnt lgkmcnt(1)
v_mfma_f32_16x16x32_bf16 v[80:83], v[24:27], a[0:3], 0
ds_read_b128 v[20:23], v2 offset:37888
v_mul_f32 v33, v33, v96
v_mfma_f32_16x16x32_bf16 v[84:87], v[24:27], a[4:7], 0
v_fma_f32 v32, v32, v98, v98
v_exp_f32 v33, v33
v_mfma_f32_16x16x32_bf16 v[92:95], v[28:31], a[4:7], 0
ds_read_b128 v[24:27], v2 offset:38912
v_mul_f32 v34, v34, v96
v_mfma_f32_16x16x32_bf16 v[88:91], v[28:31], a[0:3], 0
v_fma_f32 v33, v33, v98, v98
s_waitcnt lgkmcnt(1)
v_mfma_f32_16x16x32_bf16 v[64:67], v[16:19], a[8:11], v[64:67]
ds_read_b128 v[28:31], v2 offset:39936
v_mul_f32 v35, v35, v96
v_mfma_f32_16x16x32_bf16 v[68:71], v[16:19], a[12:15], v[68:71]
v_rcp_f32 v32, v32
v_mfma_f32_16x16x32_bf16 v[76:79], v[20:23], a[12:15], v[76:79]
ds_read_b128 v[16:19], v2 offset:40960
v_mul_f32 v40, v40, v32
v_mfma_f32_16x16x32_bf16 v[72:75], v[20:23], a[8:11], v[72:75]
v_mul_f32 v48, v48, v96
s_waitcnt lgkmcnt(1)
v_mfma_f32_16x16x32_bf16 v[80:83], v[24:27], a[8:11], v[80:83]
ds_read_b128 v[20:23], v2 offset:41984
v_mfma_f32_16x16x32_bf16 v[84:87], v[24:27], a[12:15], v[84:87]
v_exp_f32 v34, v34
v_mfma_f32_16x16x32_bf16 v[92:95], v[28:31], a[12:15], v[92:95]
ds_read_b128 v[24:27], v2 offset:43008
v_fma_f32 v34, v34, v98, v98
v_mfma_f32_16x16x32_bf16 v[88:91], v[28:31], a[8:11], v[88:91]
s_waitcnt lgkmcnt(1)
v_mfma_f32_16x16x32_bf16 v[64:67], v[16:19], a[16:19], v[64:67]
ds_read_b128 v[28:31], v2 offset:44032
v_mfma_f32_16x16x32_bf16 v[68:71], v[16:19], a[20:23], v[68:71]
v_rcp_f32 v33, v33
v_mfma_f32_16x16x32_bf16 v[76:79], v[20:23], a[20:23], v[76:79]
ds_read_b128 v[16:19], v2 offset:45056
v_mul_f32 v41, v41, v33
v_mfma_f32_16x16x32_bf16 v[72:75], v[20:23], a[16:19], v[72:75]
v_mul_f32 v49, v49, v96
s_waitcnt lgkmcnt(1)
v_mfma_f32_16x16x32_bf16 v[80:83], v[24:27], a[16:19], v[80:83]
ds_read_b128 v[20:23], v2 offset:46080
v_cvt_pk_bf16_f32 v104, v40, v41
v_mfma_f32_16x16x32_bf16 v[84:87], v[24:27], a[20:23], v[84:87]
v_exp_f32 v35, v35
v_mfma_f32_16x16x32_bf16 v[92:95], v[28:31], a[20:23], v[92:95]
ds_read_b128 v[24:27], v2 offset:47104
v_fma_f32 v35, v35, v98, v98
v_mfma_f32_16x16x32_bf16 v[88:91], v[28:31], a[16:19], v[88:91]
s_waitcnt lgkmcnt(1)
v_mfma_f32_16x16x32_bf16 v[64:67], v[16:19], a[24:27], v[64:67]
ds_read_b128 v[28:31], v2 offset:48128
v_mfma_f32_16x16x32_bf16 v[68:71], v[16:19], a[28:31], v[68:71]
v_rcp_f32 v34, v34
v_mfma_f32_16x16x32_bf16 v[76:79], v[20:23], a[28:31], v[76:79]
ds_read_b128 v[16:19], v2 offset:49152
v_mul_f32 v42, v42, v34
v_mfma_f32_16x16x32_bf16 v[72:75], v[20:23], a[24:27], v[72:75]
v_mul_f32 v50, v50, v96
s_waitcnt lgkmcnt(1)
v_mfma_f32_16x16x32_bf16 v[80:83], v[24:27], a[24:27], v[80:83]
ds_read_b128 v[20:23], v2 offset:50176
v_mfma_f32_16x16x32_bf16 v[84:87], v[24:27], a[28:31], v[84:87]
v_exp_f32 v48, v48
v_mfma_f32_16x16x32_bf16 v[92:95], v[28:31], a[28:31], v[92:95]
ds_read_b128 v[24:27], v2 offset:51200
v_fma_f32 v48, v48, v98, v98
v_mfma_f32_16x16x32_bf16 v[88:91], v[28:31], a[24:27], v[88:91]
s_waitcnt lgkmcnt(1)
v_mfma_f32_16x16x32_bf16 v[64:67], v[16:19], a[32:35], v[64:67]
ds_read_b128 v[28:31], v2 offset:52224
v_mfma_f32_16x16x32_bf16 v[68:71], v[16:19], a[36:39], v[68:71]
v_rcp_f32 v35, v35
v_mfma_f32_16x16x32_bf16 v[76:79], v[20:23], a[36:39], v[76:79]
ds_read_b128 v[16:19], v2 offset:53248
v_mul_f32 v43, v43, v35
v_mfma_f32_16x16x32_bf16 v[72:75], v[20:23], a[32:35], v[72:75]
v_mul_f32 v51, v51, v96
s_waitcnt lgkmcnt(1)
v_mfma_f32_16x16x32_bf16 v[80:83], v[24:27], a[32:35], v[80:83]
ds_read_b128 v[20:23], v2 offset:54272
v_cvt_pk_bf16_f32 v105, v42, v43
v_mfma_f32_16x16x32_bf16 v[84:87], v[24:27], a[36:39], v[84:87]
v_exp_f32 v49, v49
v_mfma_f32_16x16x32_bf16 v[92:95], v[28:31], a[36:39], v[92:95]
ds_read_b128 v[24:27], v2 offset:55296
v_fma_f32 v49, v49, v98, v98
v_mfma_f32_16x16x32_bf16 v[88:91], v[28:31], a[32:35], v[88:91]
s_waitcnt lgkmcnt(1)
v_mfma_f32_16x16x32_bf16 v[64:67], v[16:19], a[40:43], v[64:67]
ds_read_b128 v[28:31], v2 offset:56320
v_mfma_f32_16x16x32_bf16 v[68:71], v[16:19], a[44:47], v[68:71]
v_rcp_f32 v48, v48
v_mfma_f32_16x16x32_bf16 v[76:79], v[20:23], a[44:47], v[76:79]
ds_read_b128 v[16:19], v2 offset:57344
v_mul_f32 v56, v56, v48
v_mfma_f32_16x16x32_bf16 v[72:75], v[20:23], a[40:43], v[72:75]
v_mul_f32 v36, v36, v97
s_waitcnt lgkmcnt(1)
v_mfma_f32_16x16x32_bf16 v[80:83], v[24:27], a[40:43], v[80:83]
ds_read_b128 v[20:23], v2 offset:58368
v_mfma_f32_16x16x32_bf16 v[84:87], v[24:27], a[44:47], v[84:87]
v_exp_f32 v50, v50
v_mfma_f32_16x16x32_bf16 v[92:95], v[28:31], a[44:47], v[92:95]
ds_read_b128 v[24:27], v2 offset:59392
v_fma_f32 v50, v50, v98, v98
v_mfma_f32_16x16x32_bf16 v[88:91], v[28:31], a[40:43], v[88:91]
s_waitcnt lgkmcnt(1)
v_mfma_f32_16x16x32_bf16 v[64:67], v[16:19], a[48:51], v[64:67]
ds_read_b128 v[28:31], v2 offset:60416
v_mfma_f32_16x16x32_bf16 v[68:71], v[16:19], a[52:55], v[68:71]
v_rcp_f32 v49, v49
v_mul_f32 v37, v37, v97
v_mfma_f32_16x16x32_bf16 v[76:79], v[20:23], a[52:55], v[76:79]
ds_read_b128 v[16:19], v2 offset:61440
v_mul_f32 v57, v57, v49
v_mfma_f32_16x16x32_bf16 v[72:75], v[20:23], a[48:51], v[72:75]
v_cvt_pk_bf16_f32 v106, v56, v57
s_waitcnt lgkmcnt(1)
v_mfma_f32_16x16x32_bf16 v[80:83], v[24:27], a[48:51], v[80:83]
ds_read_b128 v[20:23], v2 offset:62464
v_mfma_f32_16x16x32_bf16 v[84:87], v[24:27], a[52:55], v[84:87]
v_exp_f32 v51, v51
v_mfma_f32_16x16x32_bf16 v[92:95], v[28:31], a[52:55], v[92:95]
ds_read_b128 v[24:27], v2 offset:63488
v_fma_f32 v51, v51, v98, v98
v_mfma_f32_16x16x32_bf16 v[88:91], v[28:31], a[48:51], v[88:91]
s_barrier
s_waitcnt lgkmcnt(1)
v_mfma_f32_16x16x32_bf16 v[64:67], v[16:19], a[56:59], v[64:67]
ds_read_b128 v[28:31], v2 offset:64512
v_mfma_f32_16x16x32_bf16 v[68:71], v[16:19], a[60:63], v[68:71]
v_rcp_f32 v50, v50
v_mul_f32 v38, v38, v97
v_mfma_f32_16x16x32_bf16 v[76:79], v[20:23], a[60:63], v[76:79]
ds_read_b128 v[16:19], v3 offset:0
v_mul_f32 v58, v58, v50
v_mfma_f32_16x16x32_bf16 v[72:75], v[20:23], a[56:59], v[72:75]
s_waitcnt lgkmcnt(1)
v_mfma_f32_16x16x32_bf16 v[80:83], v[24:27], a[56:59], v[80:83]
ds_read_b128 v[20:23], v3 offset:1024
v_mfma_f32_16x16x32_bf16 v[84:87], v[24:27], a[60:63], v[84:87]
v_exp_f32 v36, v36
v_mfma_f32_16x16x32_bf16 v[92:95], v[28:31], a[60:63], v[92:95]
ds_read_b128 v[24:27], v3 offset:2048
v_fma_f32 v36, v36, v99, v99
v_mfma_f32_16x16x32_bf16 v[88:91], v[28:31], a[56:59], v[88:91]
v_rcp_f32 v51, v51
s_waitcnt lgkmcnt(1)
v_mfma_f32_16x16x32_bf16 v[64:67], v[16:19], a[64:67], v[64:67]
ds_read_b128 v[28:31], v3 offset:3072
v_mul_f32 v59, v59, v51
v_mfma_f32_16x16x32_bf16 v[68:71], v[16:19], a[68:71], v[68:71]
v_exp_f32 v37, v37
v_mul_f32 v39, v39, v97
v_mfma_f32_16x16x32_bf16 v[76:79], v[20:23], a[68:71], v[76:79]
ds_read_b128 v[16:19], v3 offset:4096
v_fma_f32 v37, v37, v99, v99
v_mfma_f32_16x16x32_bf16 v[72:75], v[20:23], a[64:67], v[72:75]
v_cvt_pk_bf16_f32 v107, v58, v59
s_waitcnt lgkmcnt(1)
v_mfma_f32_16x16x32_bf16 v[80:83], v[24:27], a[64:67], v[80:83]
ds_read_b128 v[20:23], v3 offset:5120
v_mfma_f32_16x16x32_bf16 v[84:87], v[24:27], a[68:71], v[84:87]
v_rcp_f32 v36, v36
v_mfma_f32_16x16x32_bf16 v[92:95], v[28:31], a[68:71], v[92:95]
ds_read_b128 v[24:27], v3 offset:6144
v_mul_f32 v44, v44, v36
v_mfma_f32_16x16x32_bf16 v[88:91], v[28:31], a[64:67], v[88:91]
v_mul_f32 v52, v52, v97
s_waitcnt lgkmcnt(1)
v_mfma_f32_16x16x32_bf16 v[64:67], v[16:19], a[72:75], v[64:67]
ds_read_b128 v[28:31], v3 offset:7168
v_mfma_f32_16x16x32_bf16 v[68:71], v[16:19], a[76:79], v[68:71]
v_exp_f32 v38, v38
v_mfma_f32_16x16x32_bf16 v[76:79], v[20:23], a[76:79], v[76:79]
ds_read_b128 v[16:19], v3 offset:8192
v_fma_f32 v38, v38, v99, v99
v_mfma_f32_16x16x32_bf16 v[72:75], v[20:23], a[72:75], v[72:75]
s_waitcnt lgkmcnt(1)
v_mfma_f32_16x16x32_bf16 v[80:83], v[24:27], a[72:75], v[80:83]
ds_read_b128 v[20:23], v3 offset:9216
v_mfma_f32_16x16x32_bf16 v[84:87], v[24:27], a[76:79], v[84:87]
v_rcp_f32 v37, v37
v_mfma_f32_16x16x32_bf16 v[92:95], v[28:31], a[76:79], v[92:95]
ds_read_b128 v[24:27], v3 offset:10240
v_mul_f32 v45, v45, v37
v_mfma_f32_16x16x32_bf16 v[88:91], v[28:31], a[72:75], v[88:91]
v_mul_f32 v53, v53, v97
s_waitcnt lgkmcnt(1)
v_mfma_f32_16x16x32_bf16 v[64:67], v[16:19], a[80:83], v[64:67]
ds_read_b128 v[28:31], v3 offset:11264
v_cvt_pk_bf16_f32 v108, v44, v45
v_mfma_f32_16x16x32_bf16 v[68:71], v[16:19], a[84:87], v[68:71]
v_exp_f32 v39, v39
v_mfma_f32_16x16x32_bf16 v[76:79], v[20:23], a[84:87], v[76:79]
ds_read_b128 v[16:19], v3 offset:12288
v_fma_f32 v39, v39, v99, v99
v_mfma_f32_16x16x32_bf16 v[72:75], v[20:23], a[80:83], v[72:75]
s_waitcnt lgkmcnt(1)
v_mfma_f32_16x16x32_bf16 v[80:83], v[24:27], a[80:83], v[80:83]
ds_read_b128 v[20:23], v3 offset:13312
v_mfma_f32_16x16x32_bf16 v[84:87], v[24:27], a[84:87], v[84:87]
v_rcp_f32 v38, v38
v_mfma_f32_16x16x32_bf16 v[92:95], v[28:31], a[84:87], v[92:95]
ds_read_b128 v[24:27], v3 offset:14336
v_mul_f32 v46, v46, v38
v_mfma_f32_16x16x32_bf16 v[88:91], v[28:31], a[80:83], v[88:91]
v_mul_f32 v54, v54, v97
s_waitcnt lgkmcnt(1)
v_mfma_f32_16x16x32_bf16 v[64:67], v[16:19], a[88:91], v[64:67]
ds_read_b128 v[28:31], v3 offset:15360
v_mfma_f32_16x16x32_bf16 v[68:71], v[16:19], a[92:95], v[68:71]
v_exp_f32 v52, v52
v_mfma_f32_16x16x32_bf16 v[76:79], v[20:23], a[92:95], v[76:79]
ds_read_b128 v[16:19], v1 offset:0
v_fma_f32 v52, v52, v99, v99
v_mfma_f32_16x16x32_bf16 v[72:75], v[20:23], a[88:91], v[72:75]
s_waitcnt lgkmcnt(1)
v_mfma_f32_16x16x32_bf16 v[80:83], v[24:27], a[88:91], v[80:83]
ds_read_b128 v[20:23], v1 offset:1024
v_mfma_f32_16x16x32_bf16 v[84:87], v[24:27], a[92:95], v[84:87]
v_rcp_f32 v39, v39
v_mul_f32 v55, v55, v97
v_mfma_f32_16x16x32_bf16 v[92:95], v[28:31], a[92:95], v[92:95]
ds_read_b128 v[24:27], v1 offset:2048
v_mul_f32 v47, v47, v39
v_mfma_f32_16x16x32_bf16 v[88:91], v[28:31], a[88:91], v[88:91]
v_cvt_pk_bf16_f32 v109, v46, v47
s_waitcnt lgkmcnt(1)
v_mfma_f32_16x16x32_bf16 v[64:67], v[16:19], a[96:99], v[64:67]
ds_read_b128 v[28:31], v1 offset:3072
v_mfma_f32_16x16x32_bf16 v[68:71], v[16:19], a[100:103], v[68:71]
v_exp_f32 v53, v53
v_mfma_f32_16x16x32_bf16 v[76:79], v[20:23], a[100:103], v[76:79]
ds_read_b128 v[16:19], v1 offset:4096
v_fma_f32 v53, v53, v99, v99
v_mfma_f32_16x16x32_bf16 v[72:75], v[20:23], a[96:99], v[72:75]
s_waitcnt lgkmcnt(1)
v_mfma_f32_16x16x32_bf16 v[80:83], v[24:27], a[96:99], v[80:83]
ds_read_b128 v[20:23], v1 offset:5120
v_mfma_f32_16x16x32_bf16 v[84:87], v[24:27], a[100:103], v[84:87]
v_rcp_f32 v52, v52
v_mfma_f32_16x16x32_bf16 v[92:95], v[28:31], a[100:103], v[92:95]
ds_read_b128 v[24:27], v1 offset:6144
v_mul_f32 v60, v60, v52
v_mfma_f32_16x16x32_bf16 v[88:91], v[28:31], a[96:99], v[88:91]
v_exp_f32 v54, v54
s_waitcnt lgkmcnt(1)
v_mfma_f32_16x16x32_bf16 v[64:67], v[16:19], a[104:107], v[64:67]
ds_read_b128 v[28:31], v1 offset:7168
v_fma_f32 v54, v54, v99, v99
v_mfma_f32_16x16x32_bf16 v[68:71], v[16:19], a[108:111], v[68:71]
v_rcp_f32 v53, v53
v_mfma_f32_16x16x32_bf16 v[76:79], v[20:23], a[108:111], v[76:79]
ds_read_b128 v[16:19], v1 offset:8192
v_mul_f32 v61, v61, v53
v_mfma_f32_16x16x32_bf16 v[72:75], v[20:23], a[104:107], v[72:75]
v_cvt_pk_bf16_f32 v110, v60, v61
s_waitcnt lgkmcnt(1)
v_mfma_f32_16x16x32_bf16 v[80:83], v[24:27], a[104:107], v[80:83]
ds_read_b128 v[20:23], v1 offset:9216
v_mfma_f32_16x16x32_bf16 v[84:87], v[24:27], a[108:111], v[84:87]
v_exp_f32 v55, v55
v_mfma_f32_16x16x32_bf16 v[92:95], v[28:31], a[108:111], v[92:95]
ds_read_b128 v[24:27], v1 offset:10240
v_fma_f32 v55, v55, v99, v99
v_mfma_f32_16x16x32_bf16 v[88:91], v[28:31], a[104:107], v[88:91]
s_waitcnt lgkmcnt(1)
v_mfma_f32_16x16x32_bf16 v[64:67], v[16:19], a[112:115], v[64:67]
ds_read_b128 v[28:31], v1 offset:11264
v_mfma_f32_16x16x32_bf16 v[68:71], v[16:19], a[116:119], v[68:71]
v_rcp_f32 v54, v54
v_mfma_f32_16x16x32_bf16 v[76:79], v[20:23], a[116:119], v[76:79]
ds_read_b128 v[16:19], v1 offset:12288
v_mul_f32 v62, v62, v54
v_mfma_f32_16x16x32_bf16 v[72:75], v[20:23], a[112:115], v[72:75]
s_waitcnt lgkmcnt(1)
v_mfma_f32_16x16x32_bf16 v[80:83], v[24:27], a[112:115], v[80:83]
ds_read_b128 v[20:23], v1 offset:13312
v_mfma_f32_16x16x32_bf16 v[84:87], v[24:27], a[116:119], v[84:87]
v_rcp_f32 v55, v55
v_mfma_f32_16x16x32_bf16 v[92:95], v[28:31], a[116:119], v[92:95]
ds_read_b128 v[24:27], v1 offset:14336
v_mul_f32 v63, v63, v55
v_mfma_f32_16x16x32_bf16 v[88:91], v[28:31], a[112:115], v[88:91]
v_cvt_pk_bf16_f32 v111, v62, v63
s_add_u32 s49, s58, 0xb40000
buffer_store_dwordx4 v[104:107], v1, s[4:7], s49 offen offset:0 sc1
buffer_store_dwordx4 v[108:111], v1, s[4:7], s49 offen offset:1024 sc1
s_barrier
s_waitcnt lgkmcnt(1)
v_mfma_f32_16x16x32_bf16 v[64:67], v[16:19], a[120:123], v[64:67]
ds_read_b128 v[28:31], v1 offset:15360
v_mfma_f32_16x16x32_bf16 v[68:71], v[16:19], a[124:127], v[68:71]
v_mfma_f32_16x16x32_bf16 v[76:79], v[20:23], a[124:127], v[76:79]
ds_read_b128 v[16:19], v1 offset:16384
v_mfma_f32_16x16x32_bf16 v[72:75], v[20:23], a[120:123], v[72:75]
s_waitcnt lgkmcnt(1)
v_mfma_f32_16x16x32_bf16 v[80:83], v[24:27], a[120:123], v[80:83]
ds_read_b128 v[20:23], v1 offset:17408
v_mfma_f32_16x16x32_bf16 v[84:87], v[24:27], a[124:127], v[84:87]
v_mfma_f32_16x16x32_bf16 v[92:95], v[28:31], a[124:127], v[92:95]
ds_read_b128 v[24:27], v1 offset:18432
v_mfma_f32_16x16x32_bf16 v[88:91], v[28:31], a[120:123], v[88:91]
s_waitcnt lgkmcnt(1)
v_mfma_f32_16x16x32_bf16 v[32:35], v[16:19], a[0:3], 0
ds_read_b128 v[28:31], v1 offset:19456
v_mfma_f32_16x16x32_bf16 v[36:39], v[16:19], a[4:7], 0
v_mfma_f32_16x16x32_bf16 v[44:47], v[20:23], a[4:7], 0
ds_read_b128 v[16:19], v1 offset:20480
v_mul_f32 v64, v64, v96
v_mfma_f32_16x16x32_bf16 v[40:43], v[20:23], a[0:3], 0
v_exp_f32 v64, v64
s_waitcnt lgkmcnt(1)
v_mfma_f32_16x16x32_bf16 v[48:51], v[24:27], a[0:3], 0
ds_read_b128 v[20:23], v1 offset:21504
v_mul_f32 v65, v65, v96
v_mfma_f32_16x16x32_bf16 v[52:55], v[24:27], a[4:7], 0
v_fma_f32 v64, v64, v98, v98
v_exp_f32 v65, v65
v_mfma_f32_16x16x32_bf16 v[60:63], v[28:31], a[4:7], 0
ds_read_b128 v[24:27], v1 offset:22528
v_mul_f32 v66, v66, v96
v_mfma_f32_16x16x32_bf16 v[56:59], v[28:31], a[0:3], 0
v_fma_f32 v65, v65, v98, v98
s_waitcnt lgkmcnt(1)
v_mfma_f32_16x16x32_bf16 v[32:35], v[16:19], a[8:11], v[32:35]
ds_read_b128 v[28:31], v1 offset:23552
v_mul_f32 v67, v67, v96
v_mfma_f32_16x16x32_bf16 v[36:39], v[16:19], a[12:15], v[36:39]
v_rcp_f32 v64, v64
v_mfma_f32_16x16x32_bf16 v[44:47], v[20:23], a[12:15], v[44:47]
ds_read_b128 v[16:19], v1 offset:24576
v_mul_f32 v72, v72, v64
v_mfma_f32_16x16x32_bf16 v[40:43], v[20:23], a[8:11], v[40:43]
v_mul_f32 v80, v80, v96
s_waitcnt lgkmcnt(1)
v_mfma_f32_16x16x32_bf16 v[48:51], v[24:27], a[8:11], v[48:51]
ds_read_b128 v[20:23], v1 offset:25600
v_mfma_f32_16x16x32_bf16 v[52:55], v[24:27], a[12:15], v[52:55]
v_exp_f32 v66, v66
v_mfma_f32_16x16x32_bf16 v[60:63], v[28:31], a[12:15], v[60:63]
ds_read_b128 v[24:27], v1 offset:26624
v_fma_f32 v66, v66, v98, v98
v_mfma_f32_16x16x32_bf16 v[56:59], v[28:31], a[8:11], v[56:59]
s_waitcnt lgkmcnt(1)
v_mfma_f32_16x16x32_bf16 v[32:35], v[16:19], a[16:19], v[32:35]
ds_read_b128 v[28:31], v1 offset:27648
v_mfma_f32_16x16x32_bf16 v[36:39], v[16:19], a[20:23], v[36:39]
v_rcp_f32 v65, v65
v_mfma_f32_16x16x32_bf16 v[44:47], v[20:23], a[20:23], v[44:47]
ds_read_b128 v[16:19], v1 offset:28672
v_mul_f32 v73, v73, v65
v_mfma_f32_16x16x32_bf16 v[40:43], v[20:23], a[16:19], v[40:43]
v_mul_f32 v81, v81, v96
s_waitcnt lgkmcnt(1)
v_mfma_f32_16x16x32_bf16 v[48:51], v[24:27], a[16:19], v[48:51]
ds_read_b128 v[20:23], v1 offset:29696
v_cvt_pk_bf16_f32 v104, v72, v73
v_mfma_f32_16x16x32_bf16 v[52:55], v[24:27], a[20:23], v[52:55]
v_exp_f32 v67, v67
v_mfma_f32_16x16x32_bf16 v[60:63], v[28:31], a[20:23], v[60:63]
ds_read_b128 v[24:27], v1 offset:30720
v_fma_f32 v67, v67, v98, v98
v_mfma_f32_16x16x32_bf16 v[56:59], v[28:31], a[16:19], v[56:59]
s_waitcnt lgkmcnt(1)
v_mfma_f32_16x16x32_bf16 v[32:35], v[16:19], a[24:27], v[32:35]
ds_read_b128 v[28:31], v1 offset:31744
v_mfma_f32_16x16x32_bf16 v[36:39], v[16:19], a[28:31], v[36:39]
v_rcp_f32 v66, v66
v_mfma_f32_16x16x32_bf16 v[44:47], v[20:23], a[28:31], v[44:47]
ds_read_b128 v[16:19], v1 offset:32768
v_mul_f32 v74, v74, v66
v_mfma_f32_16x16x32_bf16 v[40:43], v[20:23], a[24:27], v[40:43]
v_mul_f32 v82, v82, v96
s_waitcnt lgkmcnt(1)
v_mfma_f32_16x16x32_bf16 v[48:51], v[24:27], a[24:27], v[48:51]
ds_read_b128 v[20:23], v1 offset:33792
v_mfma_f32_16x16x32_bf16 v[52:55], v[24:27], a[28:31], v[52:55]
v_exp_f32 v80, v80
v_mfma_f32_16x16x32_bf16 v[60:63], v[28:31], a[28:31], v[60:63]
ds_read_b128 v[24:27], v1 offset:34816
v_fma_f32 v80, v80, v98, v98
v_mfma_f32_16x16x32_bf16 v[56:59], v[28:31], a[24:27], v[56:59]
s_waitcnt lgkmcnt(1)
v_mfma_f32_16x16x32_bf16 v[32:35], v[16:19], a[32:35], v[32:35]
ds_read_b128 v[28:31], v1 offset:35840
v_mfma_f32_16x16x32_bf16 v[36:39], v[16:19], a[36:39], v[36:39]
v_rcp_f32 v67, v67
v_mfma_f32_16x16x32_bf16 v[44:47], v[20:23], a[36:39], v[44:47]
ds_read_b128 v[16:19], v1 offset:36864
v_mul_f32 v75, v75, v67
v_mfma_f32_16x16x32_bf16 v[40:43], v[20:23], a[32:35], v[40:43]
v_mul_f32 v83, v83, v96
s_waitcnt lgkmcnt(1)
v_mfma_f32_16x16x32_bf16 v[48:51], v[24:27], a[32:35], v[48:51]
ds_read_b128 v[20:23], v1 offset:37888
v_cvt_pk_bf16_f32 v105, v74, v75
v_mfma_f32_16x16x32_bf16 v[52:55], v[24:27], a[36:39], v[52:55]
v_exp_f32 v81, v81
v_mfma_f32_16x16x32_bf16 v[60:63], v[28:31], a[36:39], v[60:63]
ds_read_b128 v[24:27], v1 offset:38912
v_fma_f32 v81, v81, v98, v98
v_mfma_f32_16x16x32_bf16 v[56:59], v[28:31], a[32:35], v[56:59]
s_waitcnt lgkmcnt(1)
v_mfma_f32_16x16x32_bf16 v[32:35], v[16:19], a[40:43], v[32:35]
ds_read_b128 v[28:31], v1 offset:39936
v_mfma_f32_16x16x32_bf16 v[36:39], v[16:19], a[44:47], v[36:39]
v_rcp_f32 v80, v80
v_mfma_f32_16x16x32_bf16 v[44:47], v[20:23], a[44:47], v[44:47]
ds_read_b128 v[16:19], v1 offset:40960
v_mul_f32 v88, v88, v80
v_mfma_f32_16x16x32_bf16 v[40:43], v[20:23], a[40:43], v[40:43]
v_mul_f32 v68, v68, v97
s_waitcnt lgkmcnt(1)
v_mfma_f32_16x16x32_bf16 v[48:51], v[24:27], a[40:43], v[48:51]
ds_read_b128 v[20:23], v1 offset:41984
v_mfma_f32_16x16x32_bf16 v[52:55], v[24:27], a[44:47], v[52:55]
v_exp_f32 v82, v82
v_mfma_f32_16x16x32_bf16 v[60:63], v[28:31], a[44:47], v[60:63]
ds_read_b128 v[24:27], v1 offset:43008
v_fma_f32 v82, v82, v98, v98
v_mfma_f32_16x16x32_bf16 v[56:59], v[28:31], a[40:43], v[56:59]
s_waitcnt lgkmcnt(1)
v_mfma_f32_16x16x32_bf16 v[32:35], v[16:19], a[48:51], v[32:35]
ds_read_b128 v[28:31], v1 offset:44032
v_mfma_f32_16x16x32_bf16 v[36:39], v[16:19], a[52:55], v[36:39]
s_waitcnt vmcnt(0)
v_mov_b32 v6, 7
s_mov_b64 exec, 1
s_cmp_lg_u32 s39, 0
s_cbranch_scc1 L_c_stg_114
buffer_store_dword v6, off, s[4:7], s81  offset:0
L_c_stb_115:
s_mov_b64 exec, -1
v_mfma_f32_16x16x32_bf16 v[44:47], v[20:23], a[52:55], v[44:47]
ds_read_b128 v[16:19], v1 offset:45056
v_rcp_f32 v81, v81
v_mfma_f32_16x16x32_bf16 v[40:43], v[20:23], a[48:51], v[40:43]
v_exp_f32 v83, v83
s_waitcnt lgkmcnt(1)
v_mfma_f32_16x16x32_bf16 v[48:51], v[24:27], a[48:51], v[48:51]
ds_read_b128 v[20:23], v1 offset:46080
v_mul_f32 v89, v89, v81
v_mfma_f32_16x16x32_bf16 v[52:55], v[24:27], a[52:55], v[52:55]
v_rcp_f32 v82, v82
v_fma_f32 v83, v83, v98, v98
v_mfma_f32_16x16x32_bf16 v[60:63], v[28:31], a[52:55], v[60:63]
ds_read_b128 v[24:27], v1 offset:47104
v_mul_f32 v69, v69, v97
v_mfma_f32_16x16x32_bf16 v[56:59], v[28:31], a[48:51], v[56:59]
v_cvt_pk_bf16_f32 v106, v88, v89
s_barrier
s_waitcnt lgkmcnt(1)
v_mfma_f32_16x16x32_bf16 v[32:35], v[16:19], a[56:59], v[32:35]
ds_read_b128 v[28:31], v1 offset:48128
v_mul_f32 v90, v90, v82
v_mfma_f32_16x16x32_bf16 v[36:39], v[16:19], a[60:63], v[36:39]
v_exp_f32 v68, v68
v_mfma_f32_16x16x32_bf16 v[44:47], v[20:23], a[60:63], v[44:47]
ds_read_b128 v[16:19], v1 offset:49152
v_fma_f32 v68, v68, v99, v99
v_mfma_f32_16x16x32_bf16 v[40:43], v[20:23], a[56:59], v[40:43]
v_mul_f32 v70, v70, v97
s_waitcnt lgkmcnt(1)
v_mfma_f32_16x16x32_bf16 v[48:51], v[24:27], a[56:59], v[48:51]
ds_read_b128 v[20:23], v1 offset:50176
v_mfma_f32_16x16x32_bf16 v[52:55], v[24:27], a[60:63], v[52:55]
v_rcp_f32 v83, v83
v_mfma_f32_16x16x32_bf16 v[60:63], v[28:31], a[60:63], v[60:63]
ds_read_b128 v[24:27], v1 offset:51200
v_mul_f32 v91, v91, v83
v_mfma_f32_16x16x32_bf16 v[56:59], v[28:31], a[56:59], v[56:59]
v_mul_f32 v71, v71, v97
s_waitcnt lgkmcnt(1)
v_mfma_f32_16x16x32_bf16 v[32:35], v[16:19], a[64:67], v[32:35]
ds_read_b128 v[28:31], v1 offset:52224
v_cvt_pk_bf16_f32 v107, v90, v91
v_mfma_f32_16x16x32_bf16 v[36:39], v[16:19], a[68:71], v[36:39]
v_exp_f32 v69, v69
v_mfma_f32_16x16x32_bf16 v[44:47], v[20:23], a[68:71], v[44:47]
ds_read_b128 v[16:19], v1 offset:53248
v_fma_f32 v69, v69, v99, v99
v_mfma_f32_16x16x32_bf16 v[40:43], v[20:23], a[64:67], v[40:43]
s_waitcnt lgkmcnt(1)
v_mfma_f32_16x16x32_bf16 v[48:51], v[24:27], a[64:67], v[48:51]
ds_read_b128 v[20:23], v1 offset:54272
v_mfma_f32_16x16x32_bf16 v[52:55], v[24:27], a[68:71], v[52:55]
v_rcp_f32 v68, v68
v_mfma_f32_16x16x32_bf16 v[60:63], v[28:31], a[68:71], v[60:63]
ds_read_b128 v[24:27], v1 offset:55296
v_mul_f32 v76, v76, v68
v_mfma_f32_16x16x32_bf16 v[56:59], v[28:31], a[64:67], v[56:59]
v_mul_f32 v84, v84, v97
s_waitcnt lgkmcnt(1)
v_mfma_f32_16x16x32_bf16 v[32:35], v[16:19], a[72:75], v[32:35]
ds_read_b128 v[28:31], v1 offset:56320
v_mfma_f32_16x16x32_bf16 v[36:39], v[16:19], a[76:79], v[36:39]
v_exp_f32 v70, v70
v_mfma_f32_16x16x32_bf16 v[44:47], v[20:23], a[76:79], v[44:47]
ds_read_b128 v[16:19], v1 offset:57344
v_fma_f32 v70, v70, v99, v99
v_mfma_f32_16x16x32_bf16 v[40:43], v[20:23], a[72:75], v[40:43]
s_waitcnt lgkmcnt(1)
v_mfma_f32_16x16x32_bf16 v[48:51], v[24:27], a[72:75], v[48:51]
ds_read_b128 v[20:23], v1 offset:58368
v_mfma_f32_16x16x32_bf16 v[52:55], v[24:27], a[76:79], v[52:55]
v_rcp_f32 v69, v69
v_mfma_f32_16x16x32_bf16 v[60:63], v[28:31], a[76:79], v[60:63]
ds_read_b128 v[24:27], v1 offset:59392
v_mul_f32 v77, v77, v69
v_mfma_f32_16x16x32_bf16 v[56:59], v[28:31], a[72:75], v[56:59]
v_mul_f32 v85, v85, v97
s_waitcnt lgkmcnt(1)
v_mfma_f32_16x16x32_bf16 v[32:35], v[16:19], a[80:83], v[32:35]
ds_read_b128 v[28:31], v1 offset:60416
v_cvt_pk_bf16_f32 v108, v76, v77
v_mfma_f32_16x16x32_bf16 v[36:39], v[16:19], a[84:87], v[36:39]
v_exp_f32 v71, v71
v_mfma_f32_16x16x32_bf16 v[44:47], v[20:23], a[84:87], v[44:47]
ds_read_b128 v[16:19], v1 offset:61440
v_fma_f32 v71, v71, v99, v99
v_mfma_f32_16x16x32_bf16 v[40:43], v[20:23], a[80:83], v[40:43]
s_waitcnt lgkmcnt(1)
v_mfma_f32_16x16x32_bf16 v[48:51], v[24:27], a[80:83], v[48:51]
ds_read_b128 v[20:23], v1 offset:62464
v_mfma_f32_16x16x32_bf16 v[52:55], v[24:27], a[84:87], v[52:55]
v_rcp_f32 v70, v70
v_mfma_f32_16x16x32_bf16 v[60:63], v[28:31], a[84:87], v[60:63]
ds_read_b128 v[24:27], v1 offset:63488
v_mul_f32 v78, v78, v70
v_mfma_f32_16x16x32_bf16 v[56:59], v[28:31], a[80:83], v[56:59]
v_mul_f32 v86, v86, v97
s_waitcnt lgkmcnt(1)
v_mfma_f32_16x16x32_bf16 v[32:35], v[16:19], a[88:91], v[32:35]
ds_read_b128 v[28:31], v1 offset:64512
v_mfma_f32_16x16x32_bf16 v[36:39], v[16:19], a[92:95], v[36:39]
v_exp_f32 v84, v84
v_mfma_f32_16x16x32_bf16 v[44:47], v[20:23], a[92:95], v[44:47]
ds_read_b128 v[16:19], v2 offset:0
v_fma_f32 v84, v84, v99, v99
v_mfma_f32_16x16x32_bf16 v[40:43], v[20:23], a[88:91], v[40:43]
s_waitcnt lgkmcnt(1)
v_mfma_f32_16x16x32_bf16 v[48:51], v[24:27], a[88:91], v[48:51]
ds_read_b128 v[20:23], v2 offset:1024
v_mfma_f32_16x16x32_bf16 v[52:55], v[24:27], a[92:95], v[52:55]
v_rcp_f32 v71, v71
v_mul_f32 v87, v87, v97
v_mfma_f32_16x16x32_bf16 v[60:63], v[28:31], a[92:95], v[60:63]
ds_read_b128 v[24:27], v2 offset:2048
v_mul_f32 v79, v79, v71
v_mfma_f32_16x16x32_bf16 v[56:59], v[28:31], a[88:91], v[56:59]
v_cvt_pk_bf16_f32 v109, v78, v79
s_waitcnt lgkmcnt(1)
v_mfma_f32_16x16x32_bf16 v[32:35], v[16:19], a[96:99], v[32:35]
ds_read_b128 v[28:31], v2 offset:3072
v_mfma_f32_16x16x32_bf16 v[36:39], v[16:19], a[100:103], v[36:39]
v_exp_f32 v85, v85
v_mfma_f32_16x16x32_bf16 v[44:47], v[20:23], a[100:103], v[44:47]
ds_read_b128 v[16:19], v2 offset:4096
v_fma_f32 v85, v85, v99, v99
v_mfma_f32_16x16x32_bf16 v[40:43], v[20:23], a[96:99], v[40:43]
s_waitcnt lgkmcnt(1)
v_mfma_f32_16x16x32_bf16 v[48:51], v[24:27], a[96:99], v[48:51]
ds_read_b128 v[20:23], v2 offset:5120
v_mfma_f32_16x16x32_bf16 v[52:55], v[24:27], a[100:103], v[52:55]
buffer_load_dword v114, v5, s[4:7], s57 offen nt
v_rcp_f32 v84, v84
v_mfma_f32_16x16x32_bf16 v[60:63], v[28:31], a[100:103], v[60:63]
ds_read_b128 v[24:27], v2 offset:6144
v_mul_f32 v92, v92, v84
v_mfma_f32_16x16x32_bf16 v[56:59], v[28:31], a[96:99], v[56:59]
v_exp_f32 v86, v86
s_waitcnt lgkmcnt(1)
v_mfma_f32_16x16x32_bf16 v[32:35], v[16:19], a[104:107], v[32:35]
ds_read_b128 v[28:31], v2 offset:7168
v_fma_f32 v86, v86, v99, v99
v_mfma_f32_16x16x32_bf16 v[36:39], v[16:19], a[108:111], v[36:39]
v_rcp_f32 v85, v85
v_mfma_f32_16x16x32_bf16 v[44:47], v[20:23], a[108:111], v[44:47]
ds_read_b128 v[16:19], v2 offset:8192
v_mul_f32 v93, v93, v85
v_mfma_f32_16x16x32_bf16 v[40:43], v[20:23], a[104:107], v[40:43]
v_cvt_pk_bf16_f32 v110, v92, v93
s_waitcnt lgkmcnt(1)
v_mfma_f32_16x16x32_bf16 v[48:51], v[24:27], a[104:107], v[48:51]
ds_read_b128 v[20:23], v2 offset:9216
v_mfma_f32_16x16x32_bf16 v[52:55], v[24:27], a[108:111], v[52:55]
v_exp_f32 v87, v87
v_mfma_f32_16x16x32_bf16 v[60:63], v[28:31], a[108:111], v[60:63]
ds_read_b128 v[24:27], v2 offset:10240
v_fma_f32 v87, v87, v99, v99
v_mfma_f32_16x16x32_bf16 v[56:59], v[28:31], a[104:107], v[56:59]
s_waitcnt lgkmcnt(1)
v_mfma_f32_16x16x32_bf16 v[32:35], v[16:19], a[112:115], v[32:35]
ds_read_b128 v[28:31], v2 offset:11264
v_mfma_f32_16x16x32_bf16 v[36:39], v[16:19], a[116:119], v[36:39]
v_rcp_f32 v86, v86
v_mfma_f32_16x16x32_bf16 v[44:47], v[20:23], a[116:119], v[44:47]
ds_read_b128 v[16:19], v2 offset:12288
v_mul_f32 v94, v94, v86
v_mfma_f32_16x16x32_bf16 v[40:43], v[20:23], a[112:115], v[40:43]
s_waitcnt lgkmcnt(1)
v_mfma_f32_16x16x32_bf16 v[48:51], v[24:27], a[112:115], v[48:51]
ds_read_b128 v[20:23], v2 offset:13312
v_mfma_f32_16x16x32_bf16 v[52:55], v[24:27], a[116:119], v[52:55]
v_rcp_f32 v87, v87
v_mfma_f32_16x16x32_bf16 v[60:63], v[28:31], a[116:119], v[60:63]
ds_read_b128 v[24:27], v2 offset:14336
v_mul_f32 v95, v95, v87
v_mfma_f32_16x16x32_bf16 v[56:59], v[28:31], a[112:115], v[56:59]
v_cvt_pk_bf16_f32 v111, v94, v95
s_add_u32 s49, s58, 0xb44000
buffer_store_dwordx4 v[104:107], v1, s[4:7], s49 offen offset:0 sc1
buffer_store_dwordx4 v[108:111], v1, s[4:7], s49 offen offset:1024 sc1
s_barrier
s_waitcnt lgkmcnt(1)
v_mfma_f32_16x16x32_bf16 v[32:35], v[16:19], a[120:123], v[32:35]
ds_read_b128 v[28:31], v2 offset:15360
v_mfma_f32_16x16x32_bf16 v[36:39], v[16:19], a[124:127], v[36:39]
v_mfma_f32_16x16x32_bf16 v[44:47], v[20:23], a[124:127], v[44:47]
ds_read_b128 v[16:19], v2 offset:16384
v_mfma_f32_16x16x32_bf16 v[40:43], v[20:23], a[120:123], v[40:43]
s_waitcnt lgkmcnt(1)
v_mfma_f32_16x16x32_bf16 v[48:51], v[24:27], a[120:123], v[48:51]
ds_read_b128 v[20:23], v2 offset:17408
v_mfma_f32_16x16x32_bf16 v[52:55], v[24:27], a[124:127], v[52:55]
v_mfma_f32_16x16x32_bf16 v[60:63], v[28:31], a[124:127], v[60:63]
ds_read_b128 v[24:27], v2 offset:18432
v_mfma_f32_16x16x32_bf16 v[56:59], v[28:31], a[120:123], v[56:59]
s_waitcnt lgkmcnt(1)
v_mfma_f32_16x16x32_bf16 v[64:67], v[16:19], a[0:3], 0
ds_read_b128 v[28:31], v2 offset:19456
v_mfma_f32_16x16x32_bf16 v[68:71], v[16:19], a[4:7], 0
v_mfma_f32_16x16x32_bf16 v[76:79], v[20:23], a[4:7], 0
ds_read_b128 v[16:19], v2 offset:20480
s_lshl_b32 s51, s46, 13
v_mul_f32 v32, v32, v96
v_mfma_f32_16x16x32_bf16 v[72:75], v[20:23], a[0:3], 0
v_add_u32 v80, s51, v1
v_add_u32 v81, s51, v2
s_waitcnt lgkmcnt(1)
v_mfma_f32_16x16x32_bf16 v[64:67], v[24:27], a[8:11], v[64:67]
ds_read_b128 v[20:23], v2 offset:21504
v_add_u32 v82, s51, v3
v_mul_f32 v33, v33, v96
v_mfma_f32_16x16x32_bf16 v[68:71], v[24:27], a[12:15], v[68:71]
v_exp_f32 v32, v32
v_mul_f32 v34, v34, v96
v_mfma_f32_16x16x32_bf16 v[76:79], v[28:31], a[12:15], v[76:79]
ds_read_b128 v[24:27], v2 offset:22528
v_fma_f32 v32, v32, v98, v98
v_mfma_f32_16x16x32_bf16 v[72:75], v[28:31], a[8:11], v[72:75]
v_exp_f32 v33, v33
s_waitcnt lgkmcnt(1)
v_mfma_f32_16x16x32_bf16 v[64:67], v[16:19], a[16:19], v[64:67]
ds_read_b128 v[28:31], v2 offset:23552
v_rcp_f32 v32, v32
v_mfma_f32_16x16x32_bf16 v[68:71], v[16:19], a[20:23], v[68:71]
v_fma_f32 v33, v33, v98, v98
v_exp_f32 v34, v34
v_mfma_f32_16x16x32_bf16 v[76:79], v[20:23], a[20:23], v[76:79]
ds_read_b128 v[16:19], v2 offset:24576
v_mul_f32 v35, v35, v96
v_mfma_f32_16x16x32_bf16 v[72:75], v[20:23], a[16:19], v[72:75]
v_mul_f32 v40, v40, v32
v_fma_f32 v34, v34, v98, v98
s_waitcnt lgkmcnt(1)
v_mfma_f32_16x16x32_bf16 v[64:67], v[24:27], a[24:27], v[64:67]
ds_read_b128 v[20:23], v2 offset:25600
v_rcp_f32 v33, v33
v_mfma_f32_16x16x32_bf16 v[68:71], v[24:27], a[28:31], v[68:71]
v_exp_f32 v35, v35
v_mul_f32 v48, v48, v96
v_mfma_f32_16x16x32_bf16 v[76:79], v[28:31], a[28:31], v[76:79]
ds_read_b128 v[24:27], v2 offset:26624
v_mul_f32 v41, v41, v33
v_mfma_f32_16x16x32_bf16 v[72:75], v[28:31], a[24:27], v[72:75]
v_rcp_f32 v34, v34
s_waitcnt lgkmcnt(1)
v_mfma_f32_16x16x32_bf16 v[64:67], v[16:19], a[32:35], v[64:67]
ds_read_b128 v[28:31], v2 offset:27648
v_fma_f32 v35, v35, v98, v98
v_mul_f32 v49, v49, v96
v_mfma_f32_16x16x32_bf16 v[68:71], v[16:19], a[36:39], v[68:71]
v_exp_f32 v48, v48
v_cvt_pk_bf16_f32 v104, v40, v41
v_mfma_f32_16x16x32_bf16 v[76:79], v[20:23], a[36:39], v[76:79]
ds_read_b128 v[16:19], v2 offset:28672
v_mul_f32 v42, v42, v34
v_mfma_f32_16x16x32_bf16 v[72:75], v[20:23], a[32:35], v[72:75]
v_rcp_f32 v35, v35
s_waitcnt lgkmcnt(1)
v_mfma_f32_16x16x32_bf16 v[64:67], v[24:27], a[40:43], v[64:67]
ds_read_b128 v[20:23], v2 offset:29696
v_fma_f32 v48, v48, v98, v98
v_mul_f32 v50, v50, v96
v_mfma_f32_16x16x32_bf16 v[68:71], v[24:27], a[44:47], v[68:71]
v_exp_f32 v49, v49
v_mul_f32 v43, v43, v35
v_mfma_f32_16x16x32_bf16 v[76:79], v[28:31], a[44:47], v[76:79]
ds_read_b128 v[24:27], v2 offset:30720
v_fma_f32 v49, v49, v98, v98
v_mfma_f32_16x16x32_bf16 v[72:75], v[28:31], a[40:43], v[72:75]
v_rcp_f32 v48, v48
s_waitcnt lgkmcnt(1)
v_mfma_f32_16x16x32_bf16 v[64:67], v[16:19], a[48:51], v[64:67]
ds_read_b128 v[28:31], v2 offset:31744
v_exp_f32 v50, v50
v_mfma_f32_16x16x32_bf16 v[68:71], v[16:19], a[52:55], v[68:71]
v_mul_f32 v51, v51, v96
v_cvt_pk_bf16_f32 v105, v42, v43
v_mul_f32 v56, v56, v48
v_mfma_f32_16x16x32_bf16 v[76:79], v[20:23], a[52:55], v[76:79]
ds_read_b128 v[16:19], v2 offset:32768
v_fma_f32 v50, v50, v98, v98
v_mfma_f32_16x16x32_bf16 v[72:75], v[20:23], a[48:51], v[72:75]
v_rcp_f32 v49, v49
s_waitcnt lgkmcnt(1)
v_mfma_f32_16x16x32_bf16 v[64:67], v[24:27], a[56:59], v[64:67]
ds_read_b128 v[20:23], v2 offset:33792
v_exp_f32 v51, v51
v_mfma_f32_16x16x32_bf16 v[68:71], v[24:27], a[60:63], v[68:71]
v_mul_f32 v36, v36, v97
v_mul_f32 v57, v57, v49
v_fma_f32 v51, v51, v98, v98
v_mfma_f32_16x16x32_bf16 v[76:79], v[28:31], a[60:63], v[76:79]
ds_read_b128 v[24:27], v2 offset:34816
v_mul_f32 v37, v37, v97
v_mfma_f32_16x16x32_bf16 v[72:75], v[28:31], a[56:59], v[72:75]
v_rcp_f32 v50, v50
s_waitcnt lgkmcnt(1)
v_mfma_f32_16x16x32_bf16 v[64:67], v[16:19], a[64:67], v[64:67]
ds_read_b128 v[28:31], v2 offset:35840
v_exp_f32 v36, v36
v_mfma_f32_16x16x32_bf16 v[68:71], v[16:19], a[68:71], v[68:71]
v_cvt_pk_bf16_f32 v106, v56, v57
v_mul_f32 v58, v58, v50
v_fma_f32 v36, v36, v99, v99
v_mfma_f32_16x16x32_bf16 v[76:79], v[20:23], a[68:71], v[76:79]
ds_read_b128 v[16:19], v2 offset:36864
v_mul_f32 v38, v38, v97
v_mfma_f32_16x16x32_bf16 v[72:75], v[20:23], a[64:67], v[72:75]
v_rcp_f32 v51, v51
s_waitcnt lgkmcnt(1)
v_mfma_f32_16x16x32_bf16 v[64:67], v[24:27], a[72:75], v[64:67]
ds_read_b128 v[20:23], v2 offset:37888
v_exp_f32 v37, v37
v_mfma_f32_16x16x32_bf16 v[68:71], v[24:27], a[76:79], v[68:71]
s_waitcnt vmcnt(0)
v_mov_b32 v6, 8
s_mov_b64 exec, 1
s_cmp_lg_u32 s39, 0
s_cbranch_scc1 L_c_stg_118
buffer_store_dword v6, off, s[4:7], s81  offset:0
L_c_stb_119:
s_mov_b64 exec, -1
v_mfma_f32_16x16x32_bf16 v[76:79], v[28:31], a[76:79], v[76:79]
ds_read_b128 v[24:27], v2 offset:38912
v_mul_f32 v59, v59, v51
v_fma_f32 v37, v37, v99, v99
v_mfma_f32_16x16x32_bf16 v[72:75], v[28:31], a[72:75], v[72:75]
v_cmp_gt_u32 vcc, 7, v114
s_cbranch_vccnz L_c_psl_121
L_c_pok_120:
s_waitcnt lgkmcnt(1)
v_mfma_f32_16x16x32_bf16 v[64:67], v[16:19], a[80:83], v[64:67]
ds_read_b128 v[28:31], v2 offset:39936
v_rcp_f32 v36, v36
v_mfma_f32_16x16x32_bf16 v[68:71], v[16:19], a[84:87], v[68:71]
s_add_u32 s100, s83, 0xb41000
s_add_u32 s100, s100, s4
s_addc_u32 s101, s5, 0
global_load_dwordx4 a[0:3], v1, s[100:101] offset:-4096 sc1
v_mfma_f32_16x16x32_bf16 v[76:79], v[20:23], a[84:87], v[76:79]
ds_read_b128 v[16:19], v2 offset:40960
v_exp_f32 v38, v38
v_mfma_f32_16x16x32_bf16 v[72:75], v[20:23], a[80:83], v[72:75]
global_load_dwordx4 a[4:7], v1, s[100:101] offset:-3072 sc1
v_mul_f32 v39, v39, v97
v_cvt_pk_bf16_f32 v107, v58, v59
s_waitcnt lgkmcnt(1)
v_mfma_f32_16x16x32_bf16 v[64:67], v[24:27], a[88:91], v[64:67]
ds_read_b128 v[20:23], v2 offset:41984
v_mul_f32 v44, v44, v36
v_fma_f32 v38, v38, v99, v99
v_mfma_f32_16x16x32_bf16 v[68:71], v[24:27], a[92:95], v[68:71]
global_load_dwordx4 a[8:11], v1, s[100:101] offset:-2048 sc1
v_rcp_f32 v37, v37
v_mul_f32 v52, v52, v97
v_mfma_f32_16x16x32_bf16 v[76:79], v[28:31], a[92:95], v[76:79]
ds_read_b128 v[24:27], v2 offset:43008
v_exp_f32 v39, v39
v_mfma_f32_16x16x32_bf16 v[72:75], v[28:31], a[88:91], v[72:75]
global_load_dwordx4 a[12:15], v1, s[100:101] offset:-1024 sc1
v_mul_f32 v45, v45, v37
v_fma_f32 v39, v39, v99, v99
s_waitcnt lgkmcnt(1)
v_mfma_f32_16x16x32_bf16 v[64:67], v[16:19], a[96:99], v[64:67]
ds_read_b128 v[28:31], v2 offset:44032
v_rcp_f32 v38, v38
v_mfma_f32_16x16x32_bf16 v[68:71], v[16:19], a[100:103], v[68:71]
global_load_dwordx4 a[16:19], v1, s[100:101] offset:0 sc1
v_exp_f32 v52, v52
v_mul_f32 v53, v53, v97
v_mfma_f32_16x16x32_bf16 v[76:79], v[20:23], a[100:103], v[76:79]
ds_read_b128 v[16:19], v2 offset:45056
v_cvt_pk_bf16_f32 v108, v44, v45
v_mul_f32 v46, v46, v38
v_mfma_f32_16x16x32_bf16 v[72:75], v[20:23], a[96:99], v[72:75]
global_load_dwordx4 a[20:23], v1, s[100:101] offset:1024 sc1
v_rcp_f32 v39, v39
s_waitcnt lgkmcnt(1)
v_mfma_f32_16x16x32_bf16 v[64:67], v[24:27], a[104:107], v[64:67]
ds_read_b128 v[20:23], v2 offset:46080
v_fma_f32 v52, v52, v99, v99
v_mul_f32 v54, v54, v97
v_mfma_f32_16x16x32_bf16 v[68:71], v[24:27], a[108:111], v[68:71]
global_load_dwordx4 a[24:27], v1, s[100:101] offset:2048 sc1
v_exp_f32 v53, v53
v_mul_f32 v47, v47, v39
v_mfma_f32_16x16x32_bf16 v[76:79], v[28:31], a[108:111], v[76:79]
ds_read_b128 v[24:27], v2 offset:47104
v_rcp_f32 v52, v52
v_mfma_f32_16x16x32_bf16 v[72:75], v[28:31], a[104:107], v[72:75]
global_load_dwordx4 a[28:31], v1, s[100:101] offset:3072 sc1
v_fma_f32 v53, v53, v99, v99
v_mul_f32 v55, v55, v97
s_barrier
s_waitcnt lgkmcnt(1)
v_mfma_f32_16x16x32_bf16 v[64:67], v[16:19], a[112:115], v[64:67]
ds_read_b128 v[28:31], v2 offset:48128
v_exp_f32 v54, v54
v_mfma_f32_16x16x32_bf16 v[68:71], v[16:19], a[116:119], v[68:71]
s_add_u32 s100, s100, 0x2000
s_addc_u32 s101, s101, 0
global_load_dwordx4 a[32:35], v1, s[100:101] offset:-4096 sc1
v_cvt_pk_bf16_f32 v109, v46, v47
v_mfma_f32_16x16x32_bf16 v[76:79], v[20:23], a[116:119], v[76:79]
ds_read_b128 v[16:19], v81 offset:49152
v_mul_f32 v60, v60, v52
v_fma_f32 v54, v54, v99, v99
v_mfma_f32_16x16x32_bf16 v[72:75], v[20:23], a[112:115], v[72:75]
buffer_load_dword v114, v5, s[4:7], s57 offen nt
global_load_dwordx4 a[36:39], v1, s[100:101] offset:-3072 sc1
s_waitcnt lgkmcnt(1)
v_mfma_f32_16x16x32_bf16 v[64:67], v[24:27], a[120:123], v[64:67]
ds_read_b128 v[20:23], v81 offset:50176
v_rcp_f32 v53, v53
v_mfma_f32_16x16x32_bf16 v[68:71], v[24:27], a[124:127], v[68:71]
global_load_dwordx4 a[40:43], v1, s[100:101] offset:-2048 sc1
v_exp_f32 v55, v55
v_mul_f32 v61, v61, v53
v_mfma_f32_16x16x32_bf16 v[76:79], v[28:31], a[124:127], v[76:79]
ds_read_b128 v[24:27], v81 offset:51200
v_rcp_f32 v54, v54
v_mfma_f32_16x16x32_bf16 v[72:75], v[28:31], a[120:123], v[72:75]
global_load_dwordx4 a[44:47], v1, s[100:101] offset:-1024 sc1
v_fma_f32 v55, v55, v99, v99
v_cvt_pk_bf16_f32 v110, v60, v61
v_mul_f32 v62, v62, v54
v_rcp_f32 v55, v55
s_nop 0
v_mul_f32 v63, v63, v55
v_cvt_pk_bf16_f32 v111, v62, v63
s_add_u32 s49, s58, 0xb48000
buffer_store_dwordx4 v[104:107], v1, s[4:7], s49 offen offset:0 sc1
buffer_store_dwordx4 v[108:111], v1, s[4:7], s49 offen offset:1024 sc1
L_ph4_1:
v_lshlrev_b32 v32, 16, v8
v_and_b32 v33, 0xffff0000, v8
v_lshlrev_b32 v34, 16, v9
v_and_b32 v35, 0xffff0000, v9
v_lshlrev_b32 v40, 16, v10
v_and_b32 v41, 0xffff0000, v10
v_lshlrev_b32 v42, 16, v11
v_and_b32 v43, 0xffff0000, v11
v_lshlrev_b32 v36, 16, v12
v_and_b32 v37, 0xffff0000, v12
v_lshlrev_b32 v38, 16, v13
v_and_b32 v39, 0xffff0000, v13
v_lshlrev_b32 v44, 16, v14
v_and_b32 v45, 0xffff0000, v14
v_lshlrev_b32 v46, 16, v15
v_and_b32 v47, 0xffff0000, v15
s_waitcnt vmcnt(13)
s_waitcnt lgkmcnt(1)
v_mfma_f32_16x16x32_bf16 v[32:35], v[16:19], a[0:3], v[32:35]
ds_read_b128 v[28:31], v81 offset:52224
v_mul_f32 v64, v64, v96
v_mfma_f32_16x16x32_bf16 v[36:39], v[16:19], a[4:7], v[36:39]
global_load_dwordx4 a[48:51], v1, s[100:101] offset:0 sc1
v_exp_f32 v64, v64
v_mfma_f32_16x16x32_bf16 v[44:47], v[20:23], a[4:7], v[44:47]
ds_read_b128 v[16:19], v81 offset:53248
v_mul_f32 v65, v65, v96
v_mfma_f32_16x16x32_bf16 v[40:43], v[20:23], a[0:3], v[40:43]
global_load_dwordx4 a[52:55], v1, s[100:101] offset:1024 sc1
v_fma_f32 v64, v64, v98, v98
s_waitcnt lgkmcnt(1)
v_mfma_f32_16x16x32_bf16 v[48:51], v[24:27], a[0:3], 0
ds_read_b128 v[20:23], v81 offset:54272
v_mul_f32 v66, v66, v96
v_mfma_f32_16x16x32_bf16 v[52:55], v[24:27], a[4:7], 0
v_exp_f32 v65, v65
v_mul_f32 v67, v67, v96
v_mfma_f32_16x16x32_bf16 v[60:63], v[28:31], a[4:7], 0
ds_read_b128 v[24:27], v81 offset:55296
v_fma_f32 v65, v65, v98, v98
v_mfma_f32_16x16x32_bf16 v[56:59], v[28:31], a[0:3], 0
s_barrier
s_waitcnt vmcnt(13)
s_waitcnt lgkmcnt(1)
v_mfma_f32_16x16x32_bf16 v[32:35], v[16:19], a[8:11], v[32:35]
ds_read_b128 v[28:31], v81 offset:56320
v_mfma_f32_16x16x32_bf16 v[36:39], v[16:19], a[12:15], v[36:39]
global_load_dwordx4 a[56:59], v1, s[100:101] offset:2048 sc1
v_mfma_f32_16x16x32_bf16 v[44:47], v[20:23], a[12:15], v[44:47]
ds_read_b128 v[16:19], v82 offset:0
v_mfma_f32_16x16x32_bf16 v[40:43], v[20:23], a[8:11], v[40:43]
global_load_dwordx4 a[60:63], v1, s[100:101] offset:3072 sc1
s_waitcnt lgkmcnt(1)
v_mfma_f32_16x16x32_bf16 v[48:51], v[24:27], a[8:11], v[48:51]
ds_read_b128 v[20:23], v82 offset:1024
v_rcp_f32 v64, v64
v_mfma_f32_16x16x32_bf16 v[52:55], v[24:27], a[12:15], v[52:55]
v_exp_f32 v66, v66
v_mul_f32 v72, v72, v64
v_mfma_f32_16x16x32_bf16 v[60:63], v[28:31], a[12:15], v[60:63]
ds_read_b128 v[24:27], v82 offset:2048
v_fma_f32 v66, v66, v98, v98
v_mfma_f32_16x16x32_bf16 v[56:59], v[28:31], a[8:11], v[56:59]
v_rcp_f32 v65, v65
s_waitcnt vmcnt(13)
s_waitcnt lgkmcnt(1)
v_mfma_f32_16x16x32_bf16 v[32:35], v[16:19], a[16:19], v[32:35]
ds_read_b128 v[28:31], v82 offset:3072
v_mul_f32 v68, v68, v97
v_mfma_f32_16x16x32_bf16 v[36:39], v[16:19], a[20:23], v[36:39]
s_waitcnt vmcnt(9)
v_cmp_gt_u32 vcc, 8, v114
s_cbranch_vccnz L_c_psl_127
L_c_pok_126:
s_add_u32 s100, s100, 0x2000
s_addc_u32 s101, s101, 0
global_load_dwordx4 a[64:67], v1, s[100:101] offset:-4096 sc1
v_mfma_f32_16x16x32_bf16 v[44:47], v[20:23], a[20:23], v[44:47]
ds_read_b128 v[16:19], v82 offset:4096
v_mul_f32 v73, v73, v65
v_mfma_f32_16x16x32_bf16 v[40:43], v[20:23], a[16:19], v[40:43]
global_load_dwordx4 a[68:71], v1, s[100:101] offset:-3072 sc1
v_mul_f32 v69, v69, v97
s_waitcnt lgkmcnt(1)
v_mfma_f32_16x16x32_bf16 v[48:51], v[24:27], a[16:19], v[48:51]
ds_read_b128 v[20:23], v82 offset:5120
v_cvt_pk_bf16_f32 v104, v72, v73
v_mfma_f32_16x16x32_bf16 v[52:55], v[24:27], a[20:23], v[52:55]
v_exp_f32 v67, v67
v_mfma_f32_16x16x32_bf16 v[60:63], v[28:31], a[20:23], v[60:63]
ds_read_b128 v[24:27], v82 offset:6144
v_fma_f32 v67, v67, v98, v98
v_mfma_f32_16x16x32_bf16 v[56:59], v[28:31], a[16:19], v[56:59]
v_rcp_f32 v66, v66
s_waitcnt lgkmcnt(1)
v_mfma_f32_16x16x32_bf16 v[32:35], v[16:19], a[24:27], v[32:35]
ds_read_b128 v[28:31], v82 offset:7168
v_mul_f32 v74, v74, v66
v_mfma_f32_16x16x32_bf16 v[36:39], v[16:19], a[28:31], v[36:39]
global_load_dwordx4 a[72:75], v1, s[100:101] offset:-2048 sc1
v_mul_f32 v70, v70, v97
v_mfma_f32_16x16x32_bf16 v[44:47], v[20:23], a[28:31], v[44:47]
ds_read_b128 v[16:19], v80 offset:0
v_mfma_f32_16x16x32_bf16 v[40:43], v[20:23], a[24:27], v[40:43]
global_load_dwordx4 a[76:79], v1, s[100:101] offset:-1024 sc1
s_waitcnt lgkmcnt(1)
v_mfma_f32_16x16x32_bf16 v[48:51], v[24:27], a[24:27], v[48:51]
ds_read_b128 v[20:23], v80 offset:1024
v_exp_f32 v68, v68
v_mfma_f32_16x16x32_bf16 v[52:55], v[24:27], a[28:31], v[52:55]
v_rcp_f32 v67, v67
v_fma_f32 v68, v68, v99, v99
v_mfma_f32_16x16x32_bf16 v[60:63], v[28:31], a[28:31], v[60:63]
ds_read_b128 v[24:27], v80 offset:2048
v_mul_f32 v75, v75, v67
v_mfma_f32_16x16x32_bf16 v[56:59], v[28:31], a[24:27], v[56:59]
v_mul_f32 v71, v71, v97
s_waitcnt vmcnt(12)
s_waitcnt lgkmcnt(1)
v_mfma_f32_16x16x32_bf16 v[32:35], v[16:19], a[32:35], v[32:35]
ds_read_b128 v[28:31], v80 offset:3072
v_cvt_pk_bf16_f32 v105, v74, v75
v_mfma_f32_16x16x32_bf16 v[36:39], v[16:19], a[36:39], v[36:39]
global_load_dwordx4 a[80:83], v1, s[100:101] offset:0 sc1
v_mfma_f32_16x16x32_bf16 v[44:47], v[20:23], a[36:39], v[44:47]
ds_read_b128 v[16:19], v80 offset:4096
v_mfma_f32_16x16x32_bf16 v[40:43], v[20:23], a[32:35], v[40:43]
global_load_dwordx4 a[84:87], v1, s[100:101] offset:1024 sc1
s_waitcnt lgkmcnt(1)
v_mfma_f32_16x16x32_bf16 v[48:51], v[24:27], a[32:35], v[48:51]
ds_read_b128 v[20:23], v80 offset:5120
v_exp_f32 v69, v69
v_mfma_f32_16x16x32_bf16 v[52:55], v[24:27], a[36:39], v[52:55]
v_rcp_f32 v68, v68
v_fma_f32 v69, v69, v99, v99
v_mfma_f32_16x16x32_bf16 v[60:63], v[28:31], a[36:39], v[60:63]
ds_read_b128 v[24:27], v80 offset:6144
v_mul_f32 v76, v76, v68
v_mfma_f32_16x16x32_bf16 v[56:59], v[28:31], a[32:35], v[56:59]
s_barrier
s_waitcnt vmcnt(12)
s_waitcnt lgkmcnt(1)
v_mfma_f32_16x16x32_bf16 v[32:35], v[16:19], a[40:43], v[32:35]
ds_read_b128 v[28:31], v80 offset:7168
v_mfma_f32_16x16x32_bf16 v[36:39], v[16:19], a[44:47], v[36:39]
s_waitcnt vmcnt(10)
v_mov_b32 v6, 9
s_mov_b64 exec, 1
s_cmp_lg_u32 s39, 0
s_cbranch_scc1 L_c_stg_130
buffer_store_dword v6, off, s[4:7], s81  offset:0
L_c_stb_131:
s_mov_b64 exec, -1
global_load_dwordx4 a[88:91], v1, s[100:101] offset:2048 sc1
v_mfma_f32_16x16x32_bf16 v[44:47], v[20:23], a[44:47], v[44:47]
ds_read_b128 v[16:19], v80 offset:16384
v_exp_f32 v70, v70
v_mfma_f32_16x16x32_bf16 v[40:43], v[20:23], a[40:43], v[40:43]
global_load_dwordx4 a[92:95], v1, s[100:101] offset:3072 sc1
v_fma_f32 v70, v70, v99, v99
s_waitcnt lgkmcnt(1)
v_mfma_f32_16x16x32_bf16 v[48:51], v[24:27], a[40:43], v[48:51]
ds_read_b128 v[20:23], v80 offset:17408
v_rcp_f32 v69, v69
v_mfma_f32_16x16x32_bf16 v[52:55], v[24:27], a[44:47], v[52:55]
v_exp_f32 v71, v71
v_mul_f32 v77, v77, v69
v_mfma_f32_16x16x32_bf16 v[60:63], v[28:31], a[44:47], v[60:63]
ds_read_b128 v[24:27], v80 offset:18432
v_fma_f32 v71, v71, v99, v99
v_mfma_f32_16x16x32_bf16 v[56:59], v[28:31], a[40:43], v[56:59]
v_cvt_pk_bf16_f32 v106, v76, v77
s_waitcnt vmcnt(11)
s_waitcnt lgkmcnt(1)
v_mfma_f32_16x16x32_bf16 v[32:35], v[16:19], a[48:51], v[32:35]
ds_read_b128 v[28:31], v80 offset:19456
v_mfma_f32_16x16x32_bf16 v[36:39], v[16:19], a[52:55], v[36:39]
s_add_u32 s100, s100, 0x2000
s_addc_u32 s101, s101, 0
global_load_dwordx4 a[96:99], v1, s[100:101] offset:-4096 sc1
v_mfma_f32_16x16x32_bf16 v[44:47], v[20:23], a[52:55], v[44:47]
ds_read_b128 v[16:19], v80 offset:20480
v_mfma_f32_16x16x32_bf16 v[40:43], v[20:23], a[48:51], v[40:43]
global_load_dwordx4 a[100:103], v1, s[100:101] offset:-3072 sc1
s_waitcnt lgkmcnt(1)
v_mfma_f32_16x16x32_bf16 v[48:51], v[24:27], a[48:51], v[48:51]
ds_read_b128 v[20:23], v80 offset:21504
v_rcp_f32 v70, v70
v_mfma_f32_16x16x32_bf16 v[52:55], v[24:27], a[52:55], v[52:55]
v_mul_f32 v78, v78, v70
v_rcp_f32 v71, v71
v_mfma_f32_16x16x32_bf16 v[60:63], v[28:31], a[52:55], v[60:63]
ds_read_b128 v[24:27], v80 offset:22528
v_mul_f32 v79, v79, v71
v_mfma_f32_16x16x32_bf16 v[56:59], v[28:31], a[48:51], v[56:59]
v_cvt_pk_bf16_f32 v107, v78, v79
s_add_u32 s49, s59, 0xb40000
buffer_store_dwordx4 v[104:107], v1, s[4:7], s49 offen offset:0 sc1
s_waitcnt vmcnt(12)
s_waitcnt lgkmcnt(1)
v_mfma_f32_16x16x32_bf16 v[32:35], v[16:19], a[56:59], v[32:35]
ds_read_b128 v[28:31], v80 offset:23552
v_mfma_f32_16x16x32_bf16 v[36:39], v[16:19], a[60:63], v[36:39]
global_load_dwordx4 a[104:107], v1, s[100:101] offset:-2048 sc1
v_mfma_f32_16x16x32_bf16 v[44:47], v[20:23], a[60:63], v[44:47]
ds_read_b128 v[16:19], v80 offset:32768
v_mfma_f32_16x16x32_bf16 v[40:43], v[20:23], a[56:59], v[40:43]
buffer_load_dword v114, v5, s[4:7], s57 offen nt
global_load_dwordx4 a[108:111], v1, s[100:101] offset:-1024 sc1
s_waitcnt lgkmcnt(1)
v_mfma_f32_16x16x32_bf16 v[48:51], v[24:27], a[56:59], v[48:51]
ds_read_b128 v[20:23], v80 offset:33792
v_mfma_f32_16x16x32_bf16 v[52:55], v[24:27], a[60:63], v[52:55]
v_mfma_f32_16x16x32_bf16 v[60:63], v[28:31], a[60:63], v[60:63]
ds_read_b128 v[24:27], v80 offset:34816
v_mfma_f32_16x16x32_bf16 v[56:59], v[28:31], a[56:59], v[56:59]
s_waitcnt vmcnt(13)
s_waitcnt lgkmcnt(1)
v_mfma_f32_16x16x32_bf16 v[32:35], v[16:19], a[64:67], v[32:35]
ds_read_b128 v[28:31], v80 offset:35840
v_mfma_f32_16x16x32_bf16 v[36:39], v[16:19], a[68:71], v[36:39]
global_load_dwordx4 a[112:115], v1, s[100:101] offset:0 sc1
v_mfma_f32_16x16x32_bf16 v[44:47], v[20:23], a[68:71], v[44:47]
ds_read_b128 v[16:19], v80 offset:36864
v_mfma_f32_16x16x32_bf16 v[40:43], v[20:23], a[64:67], v[40:43]
global_load_dwordx4 a[116:119], v1, s[100:101] offset:1024 sc1
s_waitcnt lgkmcnt(1)
v_mfma_f32_16x16x32_bf16 v[48:51], v[24:27], a[64:67], v[48:51]
ds_read_b128 v[20:23], v80 offset:37888
v_mfma_f32_16x16x32_bf16 v[52:55], v[24:27], a[68:71], v[52:55]
v_mfma_f32_16x16x32_bf16 v[60:63], v[28:31], a[68:71], v[60:63]
ds_read_b128 v[24:27], v80 offset:38912
v_mfma_f32_16x16x32_bf16 v[56:59], v[28:31], a[64:67], v[56:59]
s_barrier
s_waitcnt vmcnt(13)
s_waitcnt lgkmcnt(1)
v_mfma_f32_16x16x32_bf16 v[32:35], v[16:19], a[72:75], v[32:35]
ds_read_b128 v[28:31], v80 offset:39936
v_mfma_f32_16x16x32_bf16 v[36:39], v[16:19], a[76:79], v[36:39]
global_load_dwordx4 a[120:123], v1, s[100:101] offset:2048 sc1
v_mfma_f32_16x16x32_bf16 v[44:47], v[20:23], a[76:79], v[44:47]
ds_read_b128 v[16:19], v80 offset:49152
v_mfma_f32_16x16x32_bf16 v[40:43], v[20:23], a[72:75], v[40:43]
global_load_dwordx4 a[124:127], v1, s[100:101] offset:3072 sc1
s_waitcnt lgkmcnt(1)
v_mfma_f32_16x16x32_bf16 v[48:51], v[24:27], a[72:75], v[48:51]
ds_read_b128 v[20:23], v80 offset:50176
v_mfma_f32_16x16x32_bf16 v[52:55], v[24:27], a[76:79], v[52:55]
v_mfma_f32_16x16x32_bf16 v[60:63], v[28:31], a[76:79], v[60:63]
ds_read_b128 v[24:27], v80 offset:51200
v_mfma_f32_16x16x32_bf16 v[56:59], v[28:31], a[72:75], v[56:59]
s_waitcnt vmcnt(13)
s_waitcnt lgkmcnt(1)
v_mfma_f32_16x16x32_bf16 v[32:35], v[16:19], a[80:83], v[32:35]
ds_read_b128 v[28:31], v80 offset:52224
v_mfma_f32_16x16x32_bf16 v[36:39], v[16:19], a[84:87], v[36:39]
s_waitcnt vmcnt(5)
v_cmp_gt_u32 vcc, 9, v114
s_cbranch_vccnz L_c_psl_135
L_c_pok_134:
s_add_u32 s100, s100, 0x2000
s_addc_u32 s101, s101, 0
global_load_dwordx4 a[0:3], v1, s[100:101] offset:-4096 sc1
v_mfma_f32_16x16x32_bf16 v[44:47], v[20:23], a[84:87], v[44:47]
ds_read_b128 v[16:19], v80 offset:53248
v_mfma_f32_16x16x32_bf16 v[40:43], v[20:23], a[80:83], v[40:43]
global_load_dwordx4 a[4:7], v1, s[100:101] offset:-3072 sc1
s_waitcnt lgkmcnt(1)
v_mfma_f32_16x16x32_bf16 v[48:51], v[24:27], a[80:83], v[48:51]
ds_read_b128 v[20:23], v80 offset:54272
v_mfma_f32_16x16x32_bf16 v[52:55], v[24:27], a[84:87], v[52:55]
v_mfma_f32_16x16x32_bf16 v[60:63], v[28:31], a[84:87], v[60:63]
ds_read_b128 v[24:27], v80 offset:55296
v_mfma_f32_16x16x32_bf16 v[56:59], v[28:31], a[80:83], v[56:59]
s_waitcnt lgkmcnt(1)
v_mfma_f32_16x16x32_bf16 v[32:35], v[16:19], a[88:91], v[32:35]
ds_read_b128 v[28:31], v80 offset:56320
v_mfma_f32_16x16x32_bf16 v[36:39], v[16:19], a[92:95], v[36:39]
global_load_dwordx4 a[8:11], v1, s[100:101] offset:-2048 sc1
v_mfma_f32_16x16x32_bf16 v[44:47], v[20:23], a[92:95], v[44:47]
ds_read_b128 v[16:19], v81 offset:0
v_mfma_f32_16x16x32_bf16 v[40:43], v[20:23], a[88:91], v[40:43]
global_load_dwordx4 a[12:15], v1, s[100:101] offset:-1024 sc1
s_waitcnt lgkmcnt(1)
v_mfma_f32_16x16x32_bf16 v[48:51], v[24:27], a[88:91], v[48:51]
ds_read_b128 v[20:23], v81 offset:1024
v_mfma_f32_16x16x32_bf16 v[52:55], v[24:27], a[92:95], v[52:55]
v_mfma_f32_16x16x32_bf16 v[60:63], v[28:31], a[92:95], v[60:63]
ds_read_b128 v[24:27], v81 offset:2048
v_mfma_f32_16x16x32_bf16 v[56:59], v[28:31], a[88:91], v[56:59]
s_waitcnt lgkmcnt(1)
v_mfma_f32_16x16x32_bf16 v[32:35], v[16:19], a[96:99], v[32:35]
ds_read_b128 v[28:31], v81 offset:3072
v_mfma_f32_16x16x32_bf16 v[36:39], v[16:19], a[100:103], v[36:39]
v_mov_b32 v6, 10
s_mov_b64 exec, 1
s_cmp_lg_u32 s39, 0
s_cbranch_scc1 L_c_stg_138
buffer_store_dword v6, off, s[4:7], s81  offset:0
L_c_stb_139:
s_mov_b64 exec, -1
global_load_dwordx4 a[16:19], v1, s[100:101] offset:0 sc1
v_mfma_f32_16x16x32_bf16 v[44:47], v[20:23], a[100:103], v[44:47]
ds_read_b128 v[16:19], v81 offset:4096
v_mfma_f32_16x16x32_bf16 v[40:43], v[20:23], a[96:99], v[40:43]
global_load_dwordx4 a[20:23], v1, s[100:101] offset:1024 sc1
s_waitcnt lgkmcnt(1)
v_mfma_f32_16x16x32_bf16 v[48:51], v[24:27], a[96:99], v[48:51]
ds_read_b128 v[20:23], v81 offset:5120
v_mfma_f32_16x16x32_bf16 v[52:55], v[24:27], a[100:103], v[52:55]
v_mfma_f32_16x16x32_bf16 v[60:63], v[28:31], a[100:103], v[60:63]
ds_read_b128 v[24:27], v81 offset:6144
v_mfma_f32_16x16x32_bf16 v[56:59], v[28:31], a[96:99], v[56:59]
s_barrier
s_waitcnt vmcnt(11)
s_waitcnt lgkmcnt(1)
v_mfma_f32_16x16x32_bf16 v[32:35], v[16:19], a[104:107], v[32:35]
ds_read_b128 v[28:31], v81 offset:7168
v_mfma_f32_16x16x32_bf16 v[36:39], v[16:19], a[108:111], v[36:39]
global_load_dwordx4 a[24:27], v1, s[100:101] offset:2048 sc1
v_mfma_f32_16x16x32_bf16 v[44:47], v[20:23], a[108:111], v[44:47]
ds_read_b128 v[16:19], v81 offset:16384
v_mfma_f32_16x16x32_bf16 v[40:43], v[20:23], a[104:107], v[40:43]
global_load_dwordx4 a[28:31], v1, s[100:101] offset:3072 sc1
s_waitcnt lgkmcnt(1)
v_mfma_f32_16x16x32_bf16 v[48:51], v[24:27], a[104:107], v[48:51]
ds_read_b128 v[20:23], v81 offset:17408
v_mfma_f32_16x16x32_bf16 v[52:55], v[24:27], a[108:111], v[52:55]
v_mfma_f32_16x16x32_bf16 v[60:63], v[28:31], a[108:111], v[60:63]
ds_read_b128 v[24:27], v81 offset:18432
v_mfma_f32_16x16x32_bf16 v[56:59], v[28:31], a[104:107], v[56:59]
s_waitcnt vmcnt(11)
s_waitcnt lgkmcnt(1)
v_mfma_f32_16x16x32_bf16 v[32:35], v[16:19], a[112:115], v[32:35]
ds_read_b128 v[28:31], v81 offset:19456
v_mfma_f32_16x16x32_bf16 v[36:39], v[16:19], a[116:119], v[36:39]
s_add_u32 s100, s100, 0x2000
s_addc_u32 s101, s101, 0
global_load_dwordx4 a[32:35], v1, s[100:101] offset:-4096 sc1
v_mfma_f32_16x16x32_bf16 v[44:47], v[20:23], a[116:119], v[44:47]
ds_read_b128 v[16:19], v81 offset:20480
v_mfma_f32_16x16x32_bf16 v[40:43], v[20:23], a[112:115], v[40:43]
buffer_load_dword v114, v5, s[4:7], s57 offen nt
global_load_dwordx4 a[36:39], v1, s[100:101] offset:-3072 sc1
s_waitcnt lgkmcnt(1)
v_mfma_f32_16x16x32_bf16 v[48:51], v[24:27], a[112:115], v[48:51]
ds_read_b128 v[20:23], v81 offset:21504
v_mfma_f32_16x16x32_bf16 v[52:55], v[24:27], a[116:119], v[52:55]
v_mfma_f32_16x16x32_bf16 v[60:63], v[28:31], a[116:119], v[60:63]
ds_read_b128 v[24:27], v81 offset:22528
v_mfma_f32_16x16x32_bf16 v[56:59], v[28:31], a[112:115], v[56:59]
s_waitcnt vmcnt(12)
s_waitcnt lgkmcnt(1)
v_mfma_f32_16x16x32_bf16 v[32:35], v[16:19], a[120:123], v[32:35]
ds_read_b128 v[28:31], v81 offset:23552
v_mfma_f32_16x16x32_bf16 v[36:39], v[16:19], a[124:127], v[36:39]
global_load_dwordx4 a[40:43], v1, s[100:101] offset:-2048 sc1
v_mfma_f32_16x16x32_bf16 v[44:47], v[20:23], a[124:127], v[44:47]
ds_read_b128 v[16:19], v81 offset:32768
v_mfma_f32_16x16x32_bf16 v[40:43], v[20:23], a[120:123], v[40:43]
global_load_dwordx4 a[44:47], v1, s[100:101] offset:-1024 sc1
s_waitcnt lgkmcnt(1)
v_mfma_f32_16x16x32_bf16 v[48:51], v[24:27], a[120:123], v[48:51]
ds_read_b128 v[20:23], v81 offset:33792
v_mfma_f32_16x16x32_bf16 v[52:55], v[24:27], a[124:127], v[52:55]
v_mfma_f32_16x16x32_bf16 v[60:63], v[28:31], a[124:127], v[60:63]
ds_read_b128 v[24:27], v81 offset:34816
v_mfma_f32_16x16x32_bf16 v[56:59], v[28:31], a[120:123], v[56:59]
s_waitcnt vmcnt(12)
s_waitcnt lgkmcnt(1)
v_mfma_f32_16x16x32_bf16 v[32:35], v[16:19], a[0:3], v[32:35]
ds_read_b128 v[28:31], v81 offset:35840
v_mfma_f32_16x16x32_bf16 v[36:39], v[16:19], a[4:7], v[36:39]
global_load_dwordx4 a[48:51], v1, s[100:101] offset:0 sc1
v_mfma_f32_16x16x32_bf16 v[44:47], v[20:23], a[4:7], v[44:47]
ds_read_b128 v[16:19], v81 offset:36864
v_mfma_f32_16x16x32_bf16 v[40:43], v[20:23], a[0:3], v[40:43]
global_load_dwordx4 a[52:55], v1, s[100:101] offset:1024 sc1
s_waitcnt lgkmcnt(1)
v_mfma_f32_16x16x32_bf16 v[48:51], v[24:27], a[0:3], v[48:51]
ds_read_b128 v[20:23], v81 offset:37888
v_mfma_f32_16x16x32_bf16 v[52:55], v[24:27], a[4:7], v[52:55]
v_mfma_f32_16x16x32_bf16 v[60:63], v[28:31], a[4:7], v[60:63]
ds_read_b128 v[24:27], v81 offset:38912
v_mfma_f32_16x16x32_bf16 v[56:59], v[28:31], a[0:3], v[56:59]
s_barrier
s_waitcnt vmcnt(12)
s_waitcnt lgkmcnt(1)
v_mfma_f32_16x16x32_bf16 v[32:35], v[16:19], a[8:11], v[32:35]
ds_read_b128 v[28:31], v81 offset:39936
v_mfma_f32_16x16x32_bf16 v[36:39], v[16:19], a[12:15], v[36:39]
global_load_dwordx4 a[56:59], v1, s[100:101] offset:2048 sc1
v_mfma_f32_16x16x32_bf16 v[44:47], v[20:23], a[12:15], v[44:47]
ds_read_b128 v[16:19], v81 offset:49152
v_mfma_f32_16x16x32_bf16 v[40:43], v[20:23], a[8:11], v[40:43]
global_load_dwordx4 a[60:63], v1, s[100:101] offset:3072 sc1
s_waitcnt lgkmcnt(1)
v_mfma_f32_16x16x32_bf16 v[48:51], v[24:27], a[8:11], v[48:51]
ds_read_b128 v[20:23], v81 offset:50176
v_mfma_f32_16x16x32_bf16 v[52:55], v[24:27], a[12:15], v[52:55]
v_mfma_f32_16x16x32_bf16 v[60:63], v[28:31], a[12:15], v[60:63]
ds_read_b128 v[24:27], v81 offset:51200
v_mfma_f32_16x16x32_bf16 v[56:59], v[28:31], a[8:11], v[56:59]
s_waitcnt vmcnt(11)
s_waitcnt lgkmcnt(1)
v_mfma_f32_16x16x32_bf16 v[32:35], v[16:19], a[16:19], v[32:35]
ds_read_b128 v[28:31], v81 offset:52224
v_mfma_f32_16x16x32_bf16 v[36:39], v[16:19], a[20:23], v[36:39]
s_waitcnt vmcnt(7)
v_cmp_gt_u32 vcc, 10, v114
s_cbranch_vccnz L_c_psl_141
L_c_pok_140:
s_add_u32 s100, s100, 0x2000
s_addc_u32 s101, s101, 0
global_load_dwordx4 v[64:67], v1, s[100:101] offset:-4096 sc1
v_mfma_f32_16x16x32_bf16 v[44:47], v[20:23], a[20:23], v[44:47]
ds_read_b128 v[16:19], v81 offset:53248
v_mfma_f32_16x16x32_bf16 v[40:43], v[20:23], a[16:19], v[40:43]
global_load_dwordx4 v[68:71], v1, s[100:101] offset:-3072 sc1
s_waitcnt lgkmcnt(1)
v_mfma_f32_16x16x32_bf16 v[48:51], v[24:27], a[16:19], v[48:51]
ds_read_b128 v[20:23], v81 offset:54272
v_mfma_f32_16x16x32_bf16 v[52:55], v[24:27], a[20:23], v[52:55]
v_mfma_f32_16x16x32_bf16 v[60:63], v[28:31], a[20:23], v[60:63]
ds_read_b128 v[24:27], v81 offset:55296
v_mfma_f32_16x16x32_bf16 v[56:59], v[28:31], a[16:19], v[56:59]
s_waitcnt lgkmcnt(1)
v_mfma_f32_16x16x32_bf16 v[32:35], v[16:19], a[24:27], v[32:35]
ds_read_b128 v[28:31], v81 offset:56320
v_mfma_f32_16x16x32_bf16 v[36:39], v[16:19], a[28:31], v[36:39]
global_load_dwordx4 v[72:75], v1, s[100:101] offset:-2048 sc1
v_mfma_f32_16x16x32_bf16 v[44:47], v[20:23], a[28:31], v[44:47]
ds_read_b128 v[16:19], v82 offset:0
v_mfma_f32_16x16x32_bf16 v[40:43], v[20:23], a[24:27], v[40:43]
global_load_dwordx4 v[76:79], v1, s[100:101] offset:-1024 sc1
s_waitcnt lgkmcnt(1)
v_mfma_f32_16x16x32_bf16 v[48:51], v[24:27], a[24:27], v[48:51]
ds_read_b128 v[20:23], v82 offset:1024
v_mfma_f32_16x16x32_bf16 v[52:55], v[24:27], a[28:31], v[52:55]
v_mfma_f32_16x16x32_bf16 v[60:63], v[28:31], a[28:31], v[60:63]
ds_read_b128 v[24:27], v82 offset:2048
v_mfma_f32_16x16x32_bf16 v[56:59], v[28:31], a[24:27], v[56:59]
s_waitcnt vmcnt(10)
s_waitcnt lgkmcnt(1)
v_mfma_f32_16x16x32_bf16 v[32:35], v[16:19], a[32:35], v[32:35]
ds_read_b128 v[28:31], v82 offset:3072
v_mfma_f32_16x16x32_bf16 v[36:39], v[16:19], a[36:39], v[36:39]
global_load_dwordx4 v[84:87], v1, s[100:101] offset:0 sc1
v_mfma_f32_16x16x32_bf16 v[44:47], v[20:23], a[36:39], v[44:47]
ds_read_b128 v[16:19], v82 offset:4096
v_mfma_f32_16x16x32_bf16 v[40:43], v[20:23], a[32:35], v[40:43]
global_load_dwordx4 v[88:91], v1, s[100:101] offset:1024 sc1
s_waitcnt lgkmcnt(1)
v_mfma_f32_16x16x32_bf16 v[48:51], v[24:27], a[32:35], v[48:51]
ds_read_b128 v[20:23], v82 offset:5120
v_mfma_f32_16x16x32_bf16 v[52:55], v[24:27], a[36:39], v[52:55]
v_mfma_f32_16x16x32_bf16 v[60:63], v[28:31], a[36:39], v[60:63]
ds_read_b128 v[24:27], v82 offset:6144
v_mfma_f32_16x16x32_bf16 v[56:59], v[28:31], a[32:35], v[56:59]
s_barrier
s_waitcnt vmcnt(10)
s_waitcnt lgkmcnt(1)
v_mfma_f32_16x16x32_bf16 v[32:35], v[16:19], a[40:43], v[32:35]
ds_read_b128 v[28:31], v82 offset:7168
v_mfma_f32_16x16x32_bf16 v[36:39], v[16:19], a[44:47], v[36:39]
global_load_dwordx4 v[92:95], v1, s[100:101] offset:2048 sc1
v_mfma_f32_16x16x32_bf16 v[44:47], v[20:23], a[44:47], v[44:47]
ds_read_b128 v[16:19], v80 offset:0
v_mfma_f32_16x16x32_bf16 v[40:43], v[20:23], a[40:43], v[40:43]
global_load_dwordx4 v[96:99], v1, s[100:101] offset:3072 sc1
s_waitcnt lgkmcnt(1)
v_mfma_f32_16x16x32_bf16 v[48:51], v[24:27], a[40:43], v[48:51]
ds_read_b128 v[20:23], v80 offset:1024
v_mfma_f32_16x16x32_bf16 v[52:55], v[24:27], a[44:47], v[52:55]
v_mfma_f32_16x16x32_bf16 v[60:63], v[28:31], a[44:47], v[60:63]
ds_read_b128 v[24:27], v80 offset:2048
v_mfma_f32_16x16x32_bf16 v[56:59], v[28:31], a[40:43], v[56:59]
s_waitcnt vmcnt(10)
s_waitcnt lgkmcnt(1)
v_mfma_f32_16x16x32_bf16 v[32:35], v[16:19], a[48:51], v[32:35]
ds_read_b128 v[28:31], v80 offset:3072
v_mfma_f32_16x16x32_bf16 v[36:39], v[16:19], a[52:55], v[36:39]
v_mfma_f32_16x16x32_bf16 v[44:47], v[20:23], a[52:55], v[44:47]
ds_read_b128 v[16:19], v80 offset:4096
v_mfma_f32_16x16x32_bf16 v[40:43], v[20:23], a[48:51], v[40:43]
s_waitcnt lgkmcnt(1)
v_mfma_f32_16x16x32_bf16 v[48:51], v[24:27], a[48:51], v[48:51]
ds_read_b128 v[20:23], v80 offset:5120
v_mfma_f32_16x16x32_bf16 v[52:55], v[24:27], a[52:55], v[52:55]
v_mfma_f32_16x16x32_bf16 v[60:63], v[28:31], a[52:55], v[60:63]
ds_read_b128 v[24:27], v80 offset:6144
v_mfma_f32_16x16x32_bf16 v[56:59], v[28:31], a[48:51], v[56:59]
s_waitcnt vmcnt(8)
s_waitcnt lgkmcnt(1)
v_mfma_f32_16x16x32_bf16 v[32:35], v[16:19], a[56:59], v[32:35]
ds_read_b128 v[28:31], v80 offset:7168
v_mfma_f32_16x16x32_bf16 v[36:39], v[16:19], a[60:63], v[36:39]
v_mfma_f32_16x16x32_bf16 v[44:47], v[20:23], a[60:63], v[44:47]
ds_read_b128 v[16:19], v80 offset:16384
v_mfma_f32_16x16x32_bf16 v[40:43], v[20:23], a[56:59], v[40:43]
s_waitcnt lgkmcnt(1)
v_mfma_f32_16x16x32_bf16 v[48:51], v[24:27], a[56:59], v[48:51]
ds_read_b128 v[20:23], v80 offset:17408
v_mfma_f32_16x16x32_bf16 v[52:55], v[24:27], a[60:63], v[52:55]
v_mfma_f32_16x16x32_bf16 v[60:63], v[28:31], a[60:63], v[60:63]
ds_read_b128 v[24:27], v80 offset:18432
v_mfma_f32_16x16x32_bf16 v[56:59], v[28:31], a[56:59], v[56:59]
s_waitcnt vmcnt(6)
v_swap_b32 v66, v68
v_swap_b32 v67, v69
s_waitcnt lgkmcnt(1)
s_nop 0
v_mfma_f32_16x16x32_bf16 v[32:35], v[16:19], v[64:67], v[32:35]
ds_read_b128 v[28:31], v80 offset:19456
v_mfma_f32_16x16x32_bf16 v[36:39], v[16:19], v[68:71], v[36:39]
v_mfma_f32_16x16x32_bf16 v[44:47], v[20:23], v[68:71], v[44:47]
ds_read_b128 v[16:19], v80 offset:20480
v_mfma_f32_16x16x32_bf16 v[40:43], v[20:23], v[64:67], v[40:43]
s_waitcnt lgkmcnt(1)
v_mfma_f32_16x16x32_bf16 v[48:51], v[24:27], v[64:67], v[48:51]
ds_read_b128 v[20:23], v80 offset:21504
v_mfma_f32_16x16x32_bf16 v[52:55], v[24:27], v[68:71], v[52:55]
v_mfma_f32_16x16x32_bf16 v[60:63], v[28:31], v[68:71], v[60:63]
ds_read_b128 v[24:27], v80 offset:22528
v_mfma_f32_16x16x32_bf16 v[56:59], v[28:31], v[64:67], v[56:59]
s_barrier
s_waitcnt vmcnt(4)
v_swap_b32 v74, v76
v_swap_b32 v75, v77
s_waitcnt lgkmcnt(1)
s_nop 0
v_mfma_f32_16x16x32_bf16 v[32:35], v[16:19], v[72:75], v[32:35]
ds_read_b128 v[28:31], v80 offset:23552
v_mfma_f32_16x16x32_bf16 v[36:39], v[16:19], v[76:79], v[36:39]
v_mfma_f32_16x16x32_bf16 v[44:47], v[20:23], v[76:79], v[44:47]
ds_read_b128 v[16:19], v80 offset:34816
v_mfma_f32_16x16x32_bf16 v[40:43], v[20:23], v[72:75], v[40:43]
s_waitcnt lgkmcnt(1)
v_mfma_f32_16x16x32_bf16 v[48:51], v[24:27], v[72:75], v[48:51]
ds_read_b128 v[20:23], v80 offset:35840
v_mfma_f32_16x16x32_bf16 v[52:55], v[24:27], v[76:79], v[52:55]
v_mfma_f32_16x16x32_bf16 v[60:63], v[28:31], v[76:79], v[60:63]
ds_read_b128 v[24:27], v80 offset:38912
v_mfma_f32_16x16x32_bf16 v[56:59], v[28:31], v[72:75], v[56:59]
s_waitcnt vmcnt(2)
v_swap_b32 v86, v88
v_swap_b32 v87, v89
s_waitcnt lgkmcnt(1)
s_nop 0
v_mfma_f32_16x16x32_bf16 v[48:51], v[16:19], v[84:87], v[48:51]
ds_read_b128 v[28:31], v80 offset:39936
v_mfma_f32_16x16x32_bf16 v[52:55], v[16:19], v[88:91], v[52:55]
v_mfma_f32_16x16x32_bf16 v[60:63], v[20:23], v[88:91], v[60:63]
ds_read_b128 v[16:19], v80 offset:32768
v_mfma_f32_16x16x32_bf16 v[56:59], v[20:23], v[84:87], v[56:59]
v_add_u32 v120, s73, v1
s_xor_b32 s51, s73, 0x2000
v_add_u32 v121, s51, v1
s_waitcnt vmcnt(0)
v_swap_b32 v94, v96
v_swap_b32 v95, v97
s_waitcnt lgkmcnt(1)
s_nop 0
v_mfma_f32_16x16x32_bf16 v[48:51], v[24:27], v[92:95], v[48:51]
ds_read_b128 v[20:23], v80 offset:33792
v_mfma_f32_16x16x32_bf16 v[52:55], v[24:27], v[96:99], v[52:55]
v_mfma_f32_16x16x32_bf16 v[60:63], v[28:31], v[96:99], v[60:63]
ds_read_b128 v[24:27], v80 offset:36864
v_mfma_f32_16x16x32_bf16 v[56:59], v[28:31], v[92:95], v[56:59]
s_waitcnt lgkmcnt(1)
v_mfma_f32_16x16x32_bf16 v[32:35], v[16:19], v[84:87], v[32:35]
ds_read_b128 v[28:31], v80 offset:37888
v_mfma_f32_16x16x32_bf16 v[36:39], v[16:19], v[88:91], v[36:39]
ds_write_b128 v120, v[48:51] offset:0
ds_write_b128 v120, v[52:55] offset:1024
v_mfma_f32_16x16x32_bf16 v[44:47], v[20:23], v[88:91], v[44:47]
v_mfma_f32_16x16x32_bf16 v[40:43], v[20:23], v[84:87], v[40:43]
ds_write_b128 v120, v[56:59] offset:2048
ds_write_b128 v120, v[60:63] offset:3072
s_waitcnt lgkmcnt(4)
v_mfma_f32_16x16x32_bf16 v[32:35], v[24:27], v[92:95], v[32:35]
v_mfma_f32_16x16x32_bf16 v[36:39], v[24:27], v[96:99], v[36:39]
s_waitcnt lgkmcnt(0)
s_barrier
ds_read_b128 v[48:51], v121 offset:0
ds_read_b128 v[52:55], v121 offset:1024
ds_read_b128 v[56:59], v121 offset:2048
ds_read_b128 v[60:63], v121 offset:3072
v_mfma_f32_16x16x32_bf16 v[44:47], v[28:31], v[96:99], v[44:47]
v_mfma_f32_16x16x32_bf16 v[40:43], v[28:31], v[92:95], v[40:43]
s_waitcnt lgkmcnt(1)
v_pk_add_f32 v[32:33], v[32:33], v[48:49]
v_pk_add_f32 v[34:35], v[34:35], v[50:51]
s_nop 4
v_pk_add_f32 v[40:41], v[40:41], v[56:57]
v_pk_add_f32 v[42:43], v[42:43], v[58:59]
v_cvt_pk_bf16_f32 v8, v32, v33
v_cvt_pk_bf16_f32 v9, v34, v35
v_cvt_pk_bf16_f32 v10, v40, v41
v_cvt_pk_bf16_f32 v11, v42, v43
s_waitcnt lgkmcnt(0)
v_pk_add_f32 v[36:37], v[36:37], v[52:53]
v_pk_add_f32 v[38:39], v[38:39], v[54:55]
v_pk_add_f32 v[44:45], v[44:45], v[60:61]
v_pk_add_f32 v[46:47], v[46:47], v[62:63]
v_cvt_pk_bf16_f32 v12, v36, v37
v_cvt_pk_bf16_f32 v13, v38, v39
v_cvt_pk_bf16_f32 v14, v44, v45
v_cvt_pk_bf16_f32 v15, v46, v47
s_add_u32 s49, s64, 16384
buffer_store_dwordx2 v[8:9], v127, s[20:23], s64 offen offset:0
buffer_store_dwordx2 v[10:11], v127, s[20:23], s64 offen offset:32
buffer_store_dwordx2 v[12:13], v127, s[20:23], s49 offen offset:0
buffer_store_dwordx2 v[14:15], v127, s[20:23], s49 offen offset:32
s_endpgm
L_c_gsl_19:
s_sleep 3
s_add_u32 s49, s62, 0x1280000
buffer_load_dwordx2 v[32:33], v126, s[4:7], s49 offen offset:0 sc1
buffer_load_dwordx2 v[34:35], v126, s[4:7], s49 offen offset:1280 sc1
buffer_load_dwordx2 v[36:37], v126, s[4:7], s49 offen offset:2560 sc1
s_add_u32 s49, s62, 0x1280f00
buffer_load_dwordx2 v[38:39], v126, s[4:7], s49 offen offset:0 sc1
buffer_load_dwordx2 v[40:41], v126, s[4:7], s49 offen offset:1280 sc1
buffer_load_dwordx2 v[42:43], v126, s[4:7], s49 offen offset:2560 sc1
s_add_u32 s49, s62, 0x1281e00
buffer_load_dwordx2 v[44:45], v126, s[4:7], s49 offen offset:0 sc1
buffer_load_dwordx2 v[46:47], v126, s[4:7], s49 offen offset:1280 sc1
buffer_load_dwordx2 v[48:49], v126, s[4:7], s49 offen offset:2560 sc1
s_add_u32 s49, s62, 0x1282d00
buffer_load_dwordx2 v[50:51], v126, s[4:7], s49 offen offset:0 sc1
buffer_load_dwordx2 v[52:53], v126, s[4:7], s49 offen offset:1280 sc1
buffer_load_dwordx2 v[54:55], v126, s[4:7], s49 offen offset:2560 sc1
s_add_u32 s49, s62, 0x1283c00
buffer_load_dwordx2 v[56:57], v126, s[4:7], s49 offen offset:0 sc1
buffer_load_dwordx2 v[58:59], v126, s[4:7], s49 offen offset:1280 sc1
buffer_load_dwordx2 v[60:61], v126, s[4:7], s49 offen offset:2560 sc1
s_add_u32 s49, s62, 0x1284b00
buffer_load_dwordx2 v[62:63], v126, s[4:7], s49 offen offset:0 sc1
s_add_u32 s66, s66, 1
s_waitcnt vmcnt(0)
v_max3_u32 v98, v32, v33, 0
v_dot2_f32_bf16 v100, v32, s51, 0
v_dot2_f32_bf16 v101, v32, s52, 0
v_dot2_f32_bf16 v102, v33, s51, 0
v_dot2_f32_bf16 v103, v33, s52, 0
v_max3_u32 v98, v34, v35, v98
v_dot2_f32_bf16 v100, v34, s51, v100
v_dot2_f32_bf16 v101, v34, s52, v101
v_dot2_f32_bf16 v102, v35, s51, v102
v_dot2_f32_bf16 v103, v35, s52, v103
v_max3_u32 v98, v36, v37, v98
v_dot2_f32_bf16 v100, v36, s51, v100
v_dot2_f32_bf16 v101, v36, s52, v101
v_dot2_f32_bf16 v102, v37, s51, v102
v_dot2_f32_bf16 v103, v37, s52, v103
v_max3_u32 v98, v38, v39, v98
v_dot2_f32_bf16 v100, v38, s51, v100
v_dot2_f32_bf16 v101, v38, s52, v101
v_dot2_f32_bf16 v102, v39, s51, v102
v_dot2_f32_bf16 v103, v39, s52, v103
v_max3_u32 v98, v40, v41, v98
v_dot2_f32_bf16 v100, v40, s51, v100
v_dot2_f32_bf16 v101, v40, s52, v101
v_dot2_f32_bf16 v102, v41, s51, v102
v_dot2_f32_bf16 v103, v41, s52, v103
v_max3_u32 v98, v42, v43, v98
v_dot2_f32_bf16 v100, v42, s51, v100
v_dot2_f32_bf16 v101, v42, s52, v101
v_dot2_f32_bf16 v102, v43, s51, v102
v_dot2_f32_bf16 v103, v43, s52, v103
v_max3_u32 v98, v44, v45, v98
v_dot2_f32_bf16 v100, v44, s51, v100
v_dot2_f32_bf16 v101, v44, s52, v101
v_dot2_f32_bf16 v102, v45, s51, v102
v_dot2_f32_bf16 v103, v45, s52, v103
v_max3_u32 v98, v46, v47, v98
v_dot2_f32_bf16 v100, v46, s51, v100
v_dot2_f32_bf16 v101, v46, s52, v101
v_dot2_f32_bf16 v102, v47, s51, v102
v_dot2_f32_bf16 v103, v47, s52, v103
v_max3_u32 v98, v48, v49, v98
v_dot2_f32_bf16 v100, v48, s51, v100
v_dot2_f32_bf16 v101, v48, s52, v101
v_dot2_f32_bf16 v102, v49, s51, v102
v_dot2_f32_bf16 v103, v49, s52, v103
v_max3_u32 v98, v50, v51, v98
v_dot2_f32_bf16 v100, v50, s51, v100
v_dot2_f32_bf16 v101, v50, s52, v101
v_dot2_f32_bf16 v102, v51, s51, v102
v_dot2_f32_bf16 v103, v51, s52, v103
v_max3_u32 v98, v52, v53, v98
v_dot2_f32_bf16 v100, v52, s51, v100
v_dot2_f32_bf16 v101, v52, s52, v101
v_dot2_f32_bf16 v102, v53, s51, v102
v_dot2_f32_bf16 v103, v53, s52, v103
v_max3_u32 v98, v54, v55, v98
v_dot2_f32_bf16 v100, v54, s51, v100
v_dot2_f32_bf16 v101, v54, s52, v101
v_dot2_f32_bf16 v102, v55, s51, v102
v_dot2_f32_bf16 v103, v55, s52, v103
v_max3_u32 v98, v56, v57, v98
v_dot2_f32_bf16 v100, v56, s51, v100
v_dot2_f32_bf16 v101, v56, s52, v101
v_dot2_f32_bf16 v102, v57, s51, v102
v_dot2_f32_bf16 v103, v57, s52, v103
v_max3_u32 v98, v58, v59, v98
v_dot2_f32_bf16 v100, v58, s51, v100
v_dot2_f32_bf16 v101, v58, s52, v101
v_dot2_f32_bf16 v102, v59, s51, v102
v_dot2_f32_bf16 v103, v59, s52, v103
v_max3_u32 v98, v60, v61, v98
v_dot2_f32_bf16 v100, v60, s51, v100
v_dot2_f32_bf16 v101, v60, s52, v101
v_dot2_f32_bf16 v102, v61, s51, v102
v_dot2_f32_bf16 v103, v61, s52, v103
v_max3_u32 v98, v62, v63, v98
v_dot2_f32_bf16 v100, v62, s51, v100
v_dot2_f32_bf16 v101, v62, s52, v101
v_dot2_f32_bf16 v102, v63, s51, v102
v_dot2_f32_bf16 v103, v63, s52, v103
v_cmp_eq_u32 vcc, -1, v98
s_nop 1
s_cbranch_vccz L_c_gok_20
s_cmp_lt_u32 s66, 0x800000
s_cbranch_scc1 L_c_gsl_19
s_branch L_c_gok_20
L_c_stg_22:
s_add_u32 s49, s68, 0x740000
buffer_store_dwordx4 v[116:119], v1, s[4:7], s49 offen offset:0 sc1
buffer_store_dwordx4 v[120:123], v1, s[4:7], s49 offen offset:1024 sc1
s_branch L_c_stb_23
L_c_stg_24:
buffer_store_dword v6, off, s[4:7], s81  offset:0 sc1
s_branch L_c_stb_25
L_c_psl_27:
L_c_psl_27_loop:
s_cmp_lg_u32 s39, 0
s_cbranch_scc1 L_c_pg_28
buffer_load_dword v98, v5, s[4:7], s57 offen nt
s_branch L_c_pck_29
L_c_pg_28:
s_sleep 4
buffer_load_dword v98, v5, s[4:7], s57 offen sc1
L_c_pck_29:
s_add_u32 s66, s66, 1
s_waitcnt vmcnt(0)
v_cmp_gt_u32 vcc, 1, v98
s_cbranch_vccz L_c_pok_26
s_cmp_lt_u32 s66, 0x800000
s_cbranch_scc1 L_c_psl_27_loop
s_branch L_c_pok_26
L_c_stg_30:
s_add_u32 s49, s69, 0x940000
buffer_store_dwordx4 v[8:11], v1, s[4:7], s49 offen offset:0 sc1
buffer_store_dwordx4 v[12:15], v1, s[4:7], s49 offen offset:1024 sc1
s_branch L_c_stb_31
L_c_stg_32:
s_add_u32 s49, s61, 0x1240000
buffer_store_dword v48, v1, s[4:7], s49 offen offset:0 sc1
s_branch L_c_stb_33
L_c_stg_34:
buffer_store_dword v6, off, s[4:7], s82  offset:0 sc1
s_branch L_c_stb_35
L_c_psl_37:
L_c_psl_37_loop:
s_cmp_lg_u32 s39, 0
s_cbranch_scc1 L_c_pg_38
buffer_load_dword v96, v4, s[4:7], s56 offen nt
s_branch L_c_pck_39
L_c_pg_38:
s_sleep 4
buffer_load_dword v96, v4, s[4:7], s56 offen sc1
L_c_pck_39:
s_add_u32 s66, s66, 1
s_waitcnt vmcnt(0)
v_cmp_gt_u32 vcc, 1, v96
s_cbranch_vccz L_c_pok_36
s_cmp_lt_u32 s66, 0x800000
s_cbranch_scc1 L_c_psl_37_loop
s_branch L_c_pok_36
L_c_tsl_40:
s_add_u32 s49, s60, 0x1240000
buffer_load_dwordx4 v[80:83], v1, s[4:7], s49 offen offset:0 sc1
buffer_load_dwordx4 v[84:87], v1, s[4:7], s49 offen offset:1024 sc1
buffer_load_dwordx4 v[88:91], v1, s[4:7], s49 offen offset:2048 sc1
buffer_load_dwordx4 v[92:95], v1, s[4:7], s49 offen offset:3072 sc1
s_add_u32 s66, s66, 1
s_waitcnt vmcnt(0)
v_max3_u32 v96, v80, v81, v82
v_max3_u32 v96, v96, v83, v84
v_max3_u32 v96, v96, v85, v86
v_max3_u32 v96, v96, v87, v88
v_max3_u32 v96, v96, v89, v90
v_max3_u32 v96, v96, v91, v92
v_max3_u32 v96, v96, v93, v94
v_max_u32 v96, v96, v95
v_cmp_eq_u32 vcc, -1, v96
s_cbranch_vccz L_c_tok_41
s_cmp_lt_u32 s66, 0x800000
s_cbranch_scc1 L_c_tsl_40
s_branch L_c_tok_41
L_c_stg_44:
buffer_store_dword v6, off, s[4:7], s81  offset:0 sc1
s_branch L_c_stb_45
L_c_stg_48:
buffer_store_dword v6, off, s[4:7], s81  offset:0 sc1
s_branch L_c_stb_49
L_c_psl_51:
L_c_psl_51_loop:
s_cmp_lg_u32 s39, 0
s_cbranch_scc1 L_c_pg_52
buffer_load_dword v114, v5, s[4:7], s57 offen nt
s_branch L_c_pck_53
L_c_pg_52:
s_sleep 4
buffer_load_dword v114, v5, s[4:7], s57 offen sc1
L_c_pck_53:
s_add_u32 s66, s66, 1
s_waitcnt vmcnt(0)
v_cmp_gt_u32 vcc, 2, v114
s_cbranch_vccz L_c_pok_50
s_cmp_lt_u32 s66, 0x800000
s_cbranch_scc1 L_c_psl_51_loop
s_branch L_c_pok_50
L_c_psl_57:
L_c_psl_57_loop:
s_cmp_lg_u32 s39, 0
s_cbranch_scc1 L_c_pg_58
buffer_load_dword v114, v5, s[4:7], s57 offen nt
s_branch L_c_pck_59
L_c_pg_58:
s_sleep 4
buffer_load_dword v114, v5, s[4:7], s57 offen sc1
L_c_pck_59:
s_add_u32 s66, s66, 1
s_waitcnt vmcnt(0)
v_cmp_gt_u32 vcc, 3, v114
s_cbranch_vccz L_c_pok_56
s_cmp_lt_u32 s66, 0x800000
s_cbranch_scc1 L_c_psl_57_loop
s_branch L_c_pok_56
L_c_stg_60:
buffer_store_dword v6, off, s[4:7], s81  offset:0 sc1
s_branch L_c_stb_61
L_c_psl_65:
L_c_psl_65_loop:
s_cmp_lg_u32 s39, 0
s_cbranch_scc1 L_c_pg_66
buffer_load_dword v114, v5, s[4:7], s57 offen nt
s_branch L_c_pck_67
L_c_pg_66:
s_sleep 4
buffer_load_dword v114, v5, s[4:7], s57 offen sc1
L_c_pck_67:
s_add_u32 s66, s66, 1
s_waitcnt vmcnt(0)
v_cmp_gt_u32 vcc, 4, v114
s_cbranch_vccz L_c_pok_64
s_cmp_lt_u32 s66, 0x800000
s_cbranch_scc1 L_c_psl_65_loop
s_branch L_c_pok_64
L_c_stg_68:
buffer_store_dword v6, off, s[4:7], s81  offset:0 sc1
s_branch L_c_stb_69
L_c_psl_71:
L_c_psl_71_loop:
s_cmp_lg_u32 s39, 0
s_cbranch_scc1 L_c_pg_72
buffer_load_dword v114, v5, s[4:7], s57 offen nt
s_branch L_c_pck_73
L_c_pg_72:
s_sleep 4
buffer_load_dword v114, v5, s[4:7], s57 offen sc1
L_c_pck_73:
s_add_u32 s66, s66, 1
s_waitcnt vmcnt(0)
v_cmp_gt_u32 vcc, 5, v114
s_cbranch_vccz L_c_pok_70
s_cmp_lt_u32 s66, 0x800000
s_cbranch_scc1 L_c_psl_71_loop
s_branch L_c_pok_70
L_c_stg_74:
s_add_u32 s49, s69, 0x940000
buffer_store_dwordx4 v[8:11], v1, s[4:7], s49 offen offset:0 sc1
buffer_store_dwordx4 v[12:15], v1, s[4:7], s49 offen offset:1024 sc1
s_branch L_c_stb_75
L_c_stg_76:
s_add_u32 s49, s61, 0x13c0000
buffer_store_dword v48, v1, s[4:7], s49 offen offset:0 sc1
s_branch L_c_stb_77
L_c_stg_78:
buffer_store_dword v6, off, s[4:7], s82  offset:0 sc1
s_branch L_c_stb_79
L_c_psl_81:
L_c_psl_81_loop:
s_cmp_lg_u32 s39, 0
s_cbranch_scc1 L_c_pg_82
buffer_load_dword v116, v4, s[4:7], s56 offen nt
s_branch L_c_pck_83
L_c_pg_82:
s_sleep 4
buffer_load_dword v116, v4, s[4:7], s56 offen sc1
L_c_pck_83:
s_add_u32 s66, s66, 1
s_waitcnt vmcnt(0)
v_cmp_gt_u32 vcc, 2, v116
s_cbranch_vccz L_c_pok_80
s_cmp_lt_u32 s66, 0x800000
s_cbranch_scc1 L_c_psl_81_loop
s_branch L_c_pok_80
L_c_tsl_84:
s_add_u32 s49, s60, 0x13c0000
buffer_load_dwordx4 v[80:83], v1, s[4:7], s49 offen offset:0 sc1
buffer_load_dwordx4 v[84:87], v1, s[4:7], s49 offen offset:1024 sc1
buffer_load_dwordx4 v[88:91], v1, s[4:7], s49 offen offset:2048 sc1
buffer_load_dwordx4 v[92:95], v1, s[4:7], s49 offen offset:3072 sc1
s_add_u32 s66, s66, 1
s_waitcnt vmcnt(0)
v_max3_u32 v112, v80, v81, v82
v_max3_u32 v112, v112, v83, v84
v_max3_u32 v112, v112, v85, v86
v_max3_u32 v112, v112, v87, v88
v_max3_u32 v112, v112, v89, v90
v_max3_u32 v112, v112, v91, v92
v_max3_u32 v112, v112, v93, v94
v_max_u32 v112, v112, v95
v_cmp_eq_u32 vcc, -1, v112
s_cbranch_vccz L_c_tok_85
s_cmp_lt_u32 s66, 0x800000
s_cbranch_scc1 L_c_tsl_84
s_branch L_c_tok_85
L_c_gsl_89:
s_sleep 3
s_add_u32 s49, s62, 0x1300000
buffer_load_dwordx2 v[32:33], v126, s[4:7], s49 offen offset:0 sc1
buffer_load_dwordx2 v[34:35], v126, s[4:7], s49 offen offset:1280 sc1
buffer_load_dwordx2 v[36:37], v126, s[4:7], s49 offen offset:2560 sc1
s_add_u32 s49, s62, 0x1300f00
buffer_load_dwordx2 v[38:39], v126, s[4:7], s49 offen offset:0 sc1
buffer_load_dwordx2 v[40:41], v126, s[4:7], s49 offen offset:1280 sc1
buffer_load_dwordx2 v[42:43], v126, s[4:7], s49 offen offset:2560 sc1
s_add_u32 s49, s62, 0x1301e00
buffer_load_dwordx2 v[44:45], v126, s[4:7], s49 offen offset:0 sc1
buffer_load_dwordx2 v[46:47], v126, s[4:7], s49 offen offset:1280 sc1
buffer_load_dwordx2 v[48:49], v126, s[4:7], s49 offen offset:2560 sc1
s_add_u32 s49, s62, 0x1302d00
buffer_load_dwordx2 v[50:51], v126, s[4:7], s49 offen offset:0 sc1
buffer_load_dwordx2 v[52:53], v126, s[4:7], s49 offen offset:1280 sc1
buffer_load_dwordx2 v[54:55], v126, s[4:7], s49 offen offset:2560 sc1
s_add_u32 s49, s62, 0x1303c00
buffer_load_dwordx2 v[56:57], v126, s[4:7], s49 offen offset:0 sc1
buffer_load_dwordx2 v[58:59], v126, s[4:7], s49 offen offset:1280 sc1
buffer_load_dwordx2 v[60:61], v126, s[4:7], s49 offen offset:2560 sc1
s_add_u32 s49, s62, 0x1304b00
buffer_load_dwordx2 v[62:63], v126, s[4:7], s49 offen offset:0 sc1
s_add_u32 s66, s66, 1
s_waitcnt vmcnt(0)
v_max3_u32 v98, v32, v33, 0
v_dot2_f32_bf16 v100, v32, s51, 0
v_dot2_f32_bf16 v101, v32, s52, 0
v_dot2_f32_bf16 v102, v33, s51, 0
v_dot2_f32_bf16 v103, v33, s52, 0
v_max3_u32 v98, v34, v35, v98
v_dot2_f32_bf16 v100, v34, s51, v100
v_dot2_f32_bf16 v101, v34, s52, v101
v_dot2_f32_bf16 v102, v35, s51, v102
v_dot2_f32_bf16 v103, v35, s52, v103
v_max3_u32 v98, v36, v37, v98
v_dot2_f32_bf16 v100, v36, s51, v100
v_dot2_f32_bf16 v101, v36, s52, v101
v_dot2_f32_bf16 v102, v37, s51, v102
v_dot2_f32_bf16 v103, v37, s52, v103
v_max3_u32 v98, v38, v39, v98
v_dot2_f32_bf16 v100, v38, s51, v100
v_dot2_f32_bf16 v101, v38, s52, v101
v_dot2_f32_bf16 v102, v39, s51, v102
v_dot2_f32_bf16 v103, v39, s52, v103
v_max3_u32 v98, v40, v41, v98
v_dot2_f32_bf16 v100, v40, s51, v100
v_dot2_f32_bf16 v101, v40, s52, v101
v_dot2_f32_bf16 v102, v41, s51, v102
v_dot2_f32_bf16 v103, v41, s52, v103
v_max3_u32 v98, v42, v43, v98
v_dot2_f32_bf16 v100, v42, s51, v100
v_dot2_f32_bf16 v101, v42, s52, v101
v_dot2_f32_bf16 v102, v43, s51, v102
v_dot2_f32_bf16 v103, v43, s52, v103
v_max3_u32 v98, v44, v45, v98
v_dot2_f32_bf16 v100, v44, s51, v100
v_dot2_f32_bf16 v101, v44, s52, v101
v_dot2_f32_bf16 v102, v45, s51, v102
v_dot2_f32_bf16 v103, v45, s52, v103
v_max3_u32 v98, v46, v47, v98
v_dot2_f32_bf16 v100, v46, s51, v100
v_dot2_f32_bf16 v101, v46, s52, v101
v_dot2_f32_bf16 v102, v47, s51, v102
v_dot2_f32_bf16 v103, v47, s52, v103
v_max3_u32 v98, v48, v49, v98
v_dot2_f32_bf16 v100, v48, s51, v100
v_dot2_f32_bf16 v101, v48, s52, v101
v_dot2_f32_bf16 v102, v49, s51, v102
v_dot2_f32_bf16 v103, v49, s52, v103
v_max3_u32 v98, v50, v51, v98
v_dot2_f32_bf16 v100, v50, s51, v100
v_dot2_f32_bf16 v101, v50, s52, v101
v_dot2_f32_bf16 v102, v51, s51, v102
v_dot2_f32_bf16 v103, v51, s52, v103
v_max3_u32 v98, v52, v53, v98
v_dot2_f32_bf16 v100, v52, s51, v100
v_dot2_f32_bf16 v101, v52, s52, v101
v_dot2_f32_bf16 v102, v53, s51, v102
v_dot2_f32_bf16 v103, v53, s52, v103
v_max3_u32 v98, v54, v55, v98
v_dot2_f32_bf16 v100, v54, s51, v100
v_dot2_f32_bf16 v101, v54, s52, v101
v_dot2_f32_bf16 v102, v55, s51, v102
v_dot2_f32_bf16 v103, v55, s52, v103
v_max3_u32 v98, v56, v57, v98
v_dot2_f32_bf16 v100, v56, s51, v100
v_dot2_f32_bf16 v101, v56, s52, v101
v_dot2_f32_bf16 v102, v57, s51, v102
v_dot2_f32_bf16 v103, v57, s52, v103
v_max3_u32 v98, v58, v59, v98
v_dot2_f32_bf16 v100, v58, s51, v100
v_dot2_f32_bf16 v101, v58, s52, v101
v_dot2_f32_bf16 v102, v59, s51, v102
v_dot2_f32_bf16 v103, v59, s52, v103
v_max3_u32 v98, v60, v61, v98
v_dot2_f32_bf16 v100, v60, s51, v100
v_dot2_f32_bf16 v101, v60, s52, v101
v_dot2_f32_bf16 v102, v61, s51, v102
v_dot2_f32_bf16 v103, v61, s52, v103
v_max3_u32 v98, v62, v63, v98
v_dot2_f32_bf16 v100, v62, s51, v100
v_dot2_f32_bf16 v101, v62, s52, v101
v_dot2_f32_bf16 v102, v63, s51, v102
v_dot2_f32_bf16 v103, v63, s52, v103
v_cmp_eq_u32 vcc, -1, v98
s_nop 1
s_cbranch_vccz L_c_gok_90
s_cmp_lt_u32 s66, 0x800000
s_cbranch_scc1 L_c_gsl_89
s_branch L_c_gok_90
L_c_stg_92:
s_add_u32 s49, s68, 0x740000
buffer_store_dwordx4 v[116:119], v1, s[4:7], s49 offen offset:0 sc1
buffer_store_dwordx4 v[120:123], v1, s[4:7], s49 offen offset:1024 sc1
s_branch L_c_stb_93
L_c_stg_94:
buffer_store_dword v6, off, s[4:7], s81  offset:0 sc1
s_branch L_c_stb_95
L_c_psl_97:
L_c_psl_97_loop:
s_cmp_lg_u32 s39, 0
s_cbranch_scc1 L_c_pg_98
buffer_load_dword v98, v5, s[4:7], s57 offen nt
s_branch L_c_pck_99
L_c_pg_98:
s_sleep 4
buffer_load_dword v98, v5, s[4:7], s57 offen sc1
L_c_pck_99:
s_add_u32 s66, s66, 1
s_waitcnt vmcnt(0)
v_cmp_gt_u32 vcc, 6, v98
s_cbranch_vccz L_c_pok_96
s_cmp_lt_u32 s66, 0x800000
s_cbranch_scc1 L_c_psl_97_loop
s_branch L_c_pok_96
L_c_stg_100:
s_add_u32 s49, s69, 0x940000
buffer_store_dwordx4 v[8:11], v1, s[4:7], s49 offen offset:0 sc1
buffer_store_dwordx4 v[12:15], v1, s[4:7], s49 offen offset:1024 sc1
s_branch L_c_stb_101
L_c_stg_102:
s_add_u32 s49, s61, 0x1380000
buffer_store_dword v48, v1, s[4:7], s49 offen offset:0 sc1
s_branch L_c_stb_103
L_c_stg_104:
buffer_store_dword v6, off, s[4:7], s82  offset:0 sc1
s_branch L_c_stb_105
L_c_psl_107:
L_c_psl_107_loop:
s_cmp_lg_u32 s39, 0
s_cbranch_scc1 L_c_pg_108
buffer_load_dword v96, v4, s[4:7], s56 offen nt
s_branch L_c_pck_109
L_c_pg_108:
s_sleep 4
buffer_load_dword v96, v4, s[4:7], s56 offen sc1
L_c_pck_109:
s_add_u32 s66, s66, 1
s_waitcnt vmcnt(0)
v_cmp_gt_u32 vcc, 3, v96
s_cbranch_vccz L_c_pok_106
s_cmp_lt_u32 s66, 0x800000
s_cbranch_scc1 L_c_psl_107_loop
s_branch L_c_pok_106
L_c_tsl_110:
s_add_u32 s49, s60, 0x1380000
buffer_load_dwordx4 v[80:83], v1, s[4:7], s49 offen offset:0 sc1
buffer_load_dwordx4 v[84:87], v1, s[4:7], s49 offen offset:1024 sc1
buffer_load_dwordx4 v[88:91], v1, s[4:7], s49 offen offset:2048 sc1
buffer_load_dwordx4 v[92:95], v1, s[4:7], s49 offen offset:3072 sc1
s_add_u32 s66, s66, 1
s_waitcnt vmcnt(0)
v_max3_u32 v96, v80, v81, v82
v_max3_u32 v96, v96, v83, v84
v_max3_u32 v96, v96, v85, v86
v_max3_u32 v96, v96, v87, v88
v_max3_u32 v96, v96, v89, v90
v_max3_u32 v96, v96, v91, v92
v_max3_u32 v96, v96, v93, v94
v_max_u32 v96, v96, v95
v_cmp_eq_u32 vcc, -1, v96
s_cbranch_vccz L_c_tok_111
s_cmp_lt_u32 s66, 0x800000
s_cbranch_scc1 L_c_tsl_110
s_branch L_c_tok_111
L_c_stg_114:
buffer_store_dword v6, off, s[4:7], s81  offset:0 sc1
s_branch L_c_stb_115
L_c_stg_118:
buffer_store_dword v6, off, s[4:7], s81  offset:0 sc1
s_branch L_c_stb_119
L_c_psl_121:
L_c_psl_121_loop:
s_cmp_lg_u32 s39, 0
s_cbranch_scc1 L_c_pg_122
buffer_load_dword v114, v5, s[4:7], s57 offen nt
s_branch L_c_pck_123
L_c_pg_122:
s_sleep 4
buffer_load_dword v114, v5, s[4:7], s57 offen sc1
L_c_pck_123:
s_add_u32 s66, s66, 1
s_waitcnt vmcnt(0)
v_cmp_gt_u32 vcc, 7, v114
s_cbranch_vccz L_c_pok_120
s_cmp_lt_u32 s66, 0x800000
s_cbranch_scc1 L_c_psl_121_loop
s_branch L_c_pok_120
L_c_psl_127:
L_c_psl_127_loop:
s_cmp_lg_u32 s39, 0
s_cbranch_scc1 L_c_pg_128
buffer_load_dword v114, v5, s[4:7], s57 offen nt
s_branch L_c_pck_129
L_c_pg_128:
s_sleep 4
buffer_load_dword v114, v5, s[4:7], s57 offen sc1
L_c_pck_129:
s_add_u32 s66, s66, 1
s_waitcnt vmcnt(0)
v_cmp_gt_u32 vcc, 8, v114
s_cbranch_vccz L_c_pok_126
s_cmp_lt_u32 s66, 0x800000
s_cbranch_scc1 L_c_psl_127_loop
s_branch L_c_pok_126
L_c_stg_130:
buffer_store_dword v6, off, s[4:7], s81  offset:0 sc1
s_branch L_c_stb_131
L_c_psl_135:
L_c_psl_135_loop:
s_cmp_lg_u32 s39, 0
s_cbranch_scc1 L_c_pg_136
buffer_load_dword v114, v5, s[4:7], s57 offen nt
s_branch L_c_pck_137
L_c_pg_136:
s_sleep 4
buffer_load_dword v114, v5, s[4:7], s57 offen sc1
L_c_pck_137:
s_add_u32 s66, s66, 1
s_waitcnt vmcnt(0)
v_cmp_gt_u32 vcc, 9, v114
s_cbranch_vccz L_c_pok_134
s_cmp_lt_u32 s66, 0x800000
s_cbranch_scc1 L_c_psl_135_loop
s_branch L_c_pok_134
L_c_stg_138:
buffer_store_dword v6, off, s[4:7], s81  offset:0 sc1
s_branch L_c_stb_139
L_c_psl_141:
L_c_psl_141_loop:
s_cmp_lg_u32 s39, 0
s_cbranch_scc1 L_c_pg_142
buffer_load_dword v114, v5, s[4:7], s57 offen nt
s_branch L_c_pck_143
L_c_pg_142:
s_sleep 4
buffer_load_dword v114, v5, s[4:7], s57 offen sc1
L_c_pck_143:
s_add_u32 s66, s66, 1
s_waitcnt vmcnt(0)
v_cmp_gt_u32 vcc, 10, v114
s_cbranch_vccz L_c_pok_140
s_cmp_lt_u32 s66, 0x800000
s_cbranch_scc1 L_c_psl_141_loop
s_branch L_c_pok_140
L_code_end:
.section .rodata,"a"
.p2align 6
.amdhsa_kernel interleave_layers__linear_attn_block__glu_gated_glu__prompt_kernel
  .amdhsa_next_free_vgpr 256
  .amdhsa_next_free_sgpr 102
  .amdhsa_accum_offset 128
  .amdhsa_group_segment_fixed_size 0
  .amdhsa_kernarg_size 80
  .amdhsa_user_sgpr_count 2
  .amdhsa_user_sgpr_kernarg_segment_ptr 1
  .amdhsa_system_sgpr_workgroup_id_x 1
.end_amdhsa_kernel
.text
```
